```python
import torch

def _softmax(x, axis=-1):
    return torch.softmax(x, dim=axis)
def _gelu(x):
    return torch.nn.functional.gelu(x, approximate="tanh")
def _silu(x):
    return torch.nn.functional.silu(x)
def _sigmoid(x):
    return torch.sigmoid(x)
def _layernorm(x, axis=-1, eps=1e-5):
    m = x.mean(dim=axis, keepdim=True)
    v = x.var(dim=axis, keepdim=True, unbiased=False)
    return (x - m) / torch.sqrt(v + eps)
def _scatter_add(tgt, idx, src, axis=0):
    return tgt.clone().index_add_(axis, idx, src)
def _segment_sum(src, seg, n):
    out = torch.zeros((n,) + src.shape[1:], dtype=src.dtype)
    return out.index_add_(0, seg, src)
def _pad(x, pw):
    flat = tuple(v for pair in reversed(pw) for v in pair)
    return torch.nn.functional.pad(x, flat)

kernel_name = 'recurrent_scan__linear_kernel_hedgehog__geglu_ffn__prompt'

def setup_inputs():

    _w = (lambda a: (lambda t: t.to(torch.bfloat16) if t.is_floating_point() else t)(torch.as_tensor(a)))
    def _A_setup():
        B, S, D, H = 1, 2048, 512, 32
        Dh = D // H
        return {
            "x": _w((lambda *s: torch.randn(*s, dtype=torch.bfloat16) * 0.05)(B, S, D)),
            "wqkv": _w((lambda *s: torch.randn(*s, dtype=torch.bfloat16) * 0.2)(D, 3 * D)),
            "w_phi": _w((lambda *s: torch.randn(*s, dtype=torch.bfloat16) * 0.2)(H, Dh, Dh) * (Dh ** -0.5)),
            "wo": _w((lambda *s: torch.randn(*s, dtype=torch.bfloat16) * 0.05)(D, D)),
        }
    _A_in = _A_setup()

    def _B_setup():
        B, S, D, F = 1, 2048, 512, 1376
        return {
            "x": _w((lambda *s: torch.randn(*s, dtype=torch.bfloat16) * 0.05)(B, S, D)),
            "w_gate": _w((lambda *s: torch.randn(*s, dtype=torch.bfloat16) * 0.05)(D, F)),
            "w_up": _w((lambda *s: torch.randn(*s, dtype=torch.bfloat16) * 0.05)(D, F)),
            "w_down": _w((lambda *s: torch.randn(*s, dtype=torch.bfloat16) * 0.05)(F, D)),
        }
    _B_in = _B_setup()

    return {
        "A_x": _A_in["x"],
        "A_wqkv": _A_in["wqkv"],
        "A_w_phi": _A_in["w_phi"],
        "A_wo": _A_in["wo"],
        "B_x": _B_in["x"],
        "B_w_gate": _B_in["w_gate"],
        "B_w_up": _B_in["w_up"],
        "B_w_down": _B_in["w_down"],
    }

def reference(A_x, A_wqkv, A_w_phi, A_wo, B_x, B_w_gate, B_w_up, B_w_down):
    def _A_ref(x, wqkv, w_phi, wo):
        B, S, D = x.shape
        H = 32; Dh = D // H
        qkv = (lambda x, *d: x.permute(*d))((x @ wqkv).reshape(B, S, 3, H, Dh), 2, 0, 3, 1, 4)
        q, k, v = qkv[0], qkv[1], qkv[2]
        pq = torch.einsum("bhsd,hdf->bhsf", q, w_phi)
        pk = torch.einsum("bhsd,hdf->bhsf", k, w_phi)
        phi_q = torch.concatenate([_softmax(pq, axis=-1), _softmax(-pq, axis=-1)], axis=-1)
        phi_k = torch.concatenate([_softmax(pk, axis=-1), _softmax(-pk, axis=-1)], axis=-1)
        kv = torch.einsum("bhsf,bhsd->bhfd", phi_k, v)
        z  = torch.einsum("bhsf->bhf", phi_k)
        num = torch.einsum("bhqf,bhfd->bhqd", phi_q, kv)
        den = torch.einsum("bhqf,bhf->bhq", phi_q, z)[..., None] + 1e-6
        o = num / den
        return (lambda x, *d: x.permute(*d))(o, 0, 2, 1, 3).reshape(B, S, D) @ wo

    def _B_ref(x, w_gate, w_up, w_down):
        return (_gelu(x @ w_gate) * (x @ w_up)) @ w_down

    x = A_x
    xn = _layernorm(x, axis=-1)
    s = _A_ref(xn, A_wqkv, A_w_phi, A_wo)
    g = _silu(_B_ref(xn, B_w_gate, B_w_up, B_w_down))
    return x + s * g
```

```asm
; @launch grid=(256,1,1) block=(512,1,1) lds=163840
.amdgcn_target "amdgcn-amd-amdhsa--gfx950"
.text
.globl recurrent_scan__linear_kernel_hedgehog__geglu_ffn__prompt_kernel
.p2align 8
.type recurrent_scan__linear_kernel_hedgehog__geglu_ffn__prompt_kernel,@function
recurrent_scan__linear_kernel_hedgehog__geglu_ffn__prompt_kernel:

  s_cmp_ge_u32 s2, 256
  s_cbranch_scc1 k1_exit
  s_load_dwordx16 s[8:23], s[0:1], 0
  s_getpc_b64 s[90:91]
  v_and_b32 v2, 63, v0
  v_lshrrev_b32 v3, 6, v0
  v_lshlrev_b32 v2, 7, v2
  v_lshl_add_u32 v2, v3, 13, v2
  v_min_u32 v2, 51520, v2
  global_load_dword v15, v2, s[90:91]
  s_load_dwordx4 s[24:27], s[0:1], 64
  s_load_dwordx2 s[28:29], s[0:1], 80
  v_and_b32 v1, 63, v0
  v_lshrrev_b32 v36, 6, v0
  s_and_b32 s56, s2, 7
  s_lshr_b32 s57, s2, 3
  v_readfirstlane_b32 s3, v36
  s_lshr_b32 s58, s56, 2
  s_and_b32 s59, s56, 3
  s_and_b32 s6, s57, 7
  s_lshl_b32 s58, s58, 3
  s_add_u32 s6, s6, s58
  s_lshr_b32 s57, s57, 3
  s_lshl_b32 s59, s59, 2
  s_add_u32 s7, s57, s59
  s_and_b32 s4, s3, 3
  s_lshr_b32 s5, s3, 2
  s_lshl_b32 s66, s3, 10
  v_lshrrev_b32 v38, 4, v1
  v_and_b32 v37, 15, v1
  v_xor_b32 v39, v37, v38
  v_lshlrev_b32 v39, 4, v39
  v_lshl_add_u32 v2, v38, 10, v39
  v_lshrrev_b32 v36, 3, v1
  v_and_b32 v37, 7, v1
  v_and_b32 v38, 1, v38
  v_lshlrev_b32 v38, 2, v38
  v_xor_b32 v39, v37, v38
  v_lshlrev_b32 v39, 4, v39
  v_mul_u32_u24 v40, 3072, v36
  v_add_u32 v4, v40, v39
  v_mul_u32_u24 v40, 2752, v36
  v_add_u32 v5, v40, v39
  s_lshl_b32 s65, s6, 17
  s_lshl_b32 s56, s3, 14
  s_add_u32 s65, s65, s56
  s_lshr_b32 s57, s7, 1
  s_mul_i32 s58, s3, 24576
  s_mul_i32 s59, s3, 22016
  s_waitcnt lgkmcnt(0)
  s_mov_b32 s32, s8
  s_mov_b32 s33, s9
  s_mov_b32 s34, 2097152
  s_mov_b32 s35, 0x00020000
  s_mov_b32 s36, s10
  s_mov_b32 s37, s11
  s_mov_b32 s38, 1572864
  s_mov_b32 s39, 0x00020000
  s_mov_b32 s52, s12
  s_mov_b32 s53, s13
  s_mov_b32 s54, 16384
  s_mov_b32 s55, 0x00020000
  s_mov_b32 s40, s18
  s_mov_b32 s41, s19
  s_mov_b32 s42, 1409024
  s_mov_b32 s43, 0x00020000
  s_mov_b32 s44, s20
  s_mov_b32 s45, s21
  s_mov_b32 s46, 1409024
  s_mov_b32 s47, 0x00020000
  s_mov_b32 s48, s28
  s_mov_b32 s49, s29
  s_mov_b32 s50, 268435456
  s_mov_b32 s51, 0x00020000
  s_mov_b32 s92, s26
  s_mov_b32 s93, s27
  s_mov_b32 s94, 256
  s_mov_b32 s95, 0x00020000
  s_bitcmp1_b32 s7, 0
  s_cbranch_scc1 k1_ffn_setup
  s_lshl_b32 s56, s57, 7
  s_add_u32 s62, s58, s56
  s_add_u32 s60, s62, 1024
  s_add_u32 s61, s62, 2048
  s_mov_b32 s68, s57
  s_branch k1_att
k1_ffn_setup:
  s_mul_i32 s68, s57, 3
  s_cmp_eq_u32 s57, 7
  s_cselect_b32 s56, 1, 0
  s_sub_u32 s68, s68, s56
  s_add_u32 s69, s68, 1
  s_add_u32 s77, s68, 2
  s_lshl_b32 s56, s68, 7
  s_add_u32 s60, s59, s56
  s_mov_b32 s61, s60
  s_add_u32 s62, s60, 128
  s_mov_b32 s63, s62
  s_add_u32 s64, s60, 256
  s_mov_b32 s73, s64
  s_cmp_ge_u32 s57, 6
  s_cbranch_scc1 k1_ffn4
  s_branch k1_ffn6
k1_att:
  s_cmp_lg_u32 s2, 0
  s_cbranch_scc1 k1_nn
  s_cmp_lg_u32 s3, 0
  s_cbranch_scc1 k1_nn
  s_memrealtime s[84:85]
  s_waitcnt lgkmcnt(0)
  s_or_b32 s84, s84, 1
  v_mov_b32 v36, 0
  v_mov_b32 v37, s84
  s_mov_b64 exec, 1
  buffer_store_dword v37, v36, s[92:95], 0 offen sc1
  s_mov_b64 exec, -1
k1_nn:
  s_cmp_ge_u32 s3, 4
  s_cbranch_scc1 pf_1_w
  s_lshr_b32 s56, s2, 3
  s_lshl_b32 s56, s56, 15
  s_lshl_b32 s57, s3, 13
  s_add_u32 s56, s56, s57
  s_bfe_u32 s57, s2, 0x10002
  s_lshl_b32 s57, s57, 20
  s_add_u32 s56, s56, s57
  v_lshlrev_b32 v36, 7, v1
  buffer_load_dword v15, v36, s[32:35], s56 offen
  s_branch pf_1_e
pf_1_w:
  s_cmp_lg_u32 s3, 4
  s_cbranch_scc1 pfw_2
  s_and_b32 s56, s6, 7
  s_mul_i32 s56, s56, 196608
  s_add_u32 s56, s56, s60
  s_sub_u32 s56, s56, 98304
  v_mul_u32_u24 v45, 3072, v1
  buffer_load_dword v15, v45, s[36:39], s56 offen
  buffer_load_dword v15, v45, s[36:39], s56 offen offset:124
pfw_2:
pf_1_e:
  s_lshl_b32 s59, s66, 2
  s_add_u32 m0, s59, 65536
  s_add_u32 s58, s65, 0
  buffer_load_dwordx4 v2, s[32:35], s58 offen lds
  s_lshl_b32 s59, s66, 2
  s_add_u32 m0, s59, 66560
  s_add_u32 s58, s65, 4096
  v_xor_b32 v3, 64, v2
  buffer_load_dwordx4 v3, s[32:35], s58 offen lds
  s_lshl_b32 s59, s66, 2
  s_add_u32 m0, s59, 67584
  s_add_u32 s58, s65, 8192
  v_xor_b32 v3, 128, v2
  buffer_load_dwordx4 v3, s[32:35], s58 offen lds
  s_lshl_b32 s59, s66, 2
  s_add_u32 m0, s59, 68608
  s_add_u32 s58, s65, 12288
  v_xor_b32 v3, 192, v2
  buffer_load_dwordx4 v3, s[32:35], s58 offen lds
  s_add_u32 m0, s66, 0
  s_add_u32 s58, s60, 0
  buffer_load_dwordx4 v4, s[36:39], s58 offen lds
  s_add_u32 m0, s66, 8192
  s_add_u32 s58, s60, 196608
  buffer_load_dwordx4 v4, s[36:39], s58 offen lds
  v_bfe_u32 v36, v1, 2, 1
  v_bfe_u32 v37, v1, 3, 2
  v_and_b32 v38, 3, v1
  v_lshl_add_u32 v37, v37, 2, v38
  v_lshrrev_b32 v38, 5, v1
  v_lshlrev_b32 v38, 2, v38
  v_lshl_add_u32 v38, v36, 4, v38
  v_lshl_add_u32 v37, v38, 4, v37
  v_lshlrev_b32 v37, 1, v37
  s_lshl_b32 s56, s68, 1
  s_add_u32 s56, s56, s5
  s_lshl_b32 s56, s56, 10
  buffer_load_ushort v100, v37, s[52:55], s56 offen offset:0
  buffer_load_ushort v101, v37, s[52:55], s56 offen offset:32
  buffer_load_ushort v102, v37, s[52:55], s56 offen offset:64
  buffer_load_ushort v103, v37, s[52:55], s56 offen offset:96
  buffer_load_ushort v104, v37, s[52:55], s56 offen offset:256
  buffer_load_ushort v105, v37, s[52:55], s56 offen offset:288
  buffer_load_ushort v106, v37, s[52:55], s56 offen offset:320
  buffer_load_ushort v107, v37, s[52:55], s56 offen offset:352
  v_lshlrev_b32 v23, 4, v1
  v_and_b32 v36, 31, v1
  v_lshrrev_b32 v37, 5, v1
  v_and_b32 v38, 15, v1
  v_xor_b32 v38, v38, v37
  s_lshl_b32 s56, s4, 13
  s_add_u32 s56, s56, 65536
  v_lshlrev_b32 v39, 8, v36
  v_add_u32 v39, s56, v39
  s_add_u32 s57, s4, 0
  s_and_b32 s57, s57, 3
  s_add_u32 s57, s57, 0
  s_lshl_b32 s57, s57, 1
  v_xor_b32 v40, s57, v38
  v_lshl_add_u32 v6, v40, 4, v39
  s_add_u32 s57, s4, 1
  s_and_b32 s57, s57, 3
  s_add_u32 s57, s57, 0
  s_lshl_b32 s57, s57, 1
  v_xor_b32 v40, s57, v38
  v_lshl_add_u32 v7, v40, 4, v39
  s_add_u32 s57, s4, 2
  s_and_b32 s57, s57, 3
  s_add_u32 s57, s57, 0
  s_lshl_b32 s57, s57, 1
  v_xor_b32 v40, s57, v38
  v_lshl_add_u32 v8, v40, 4, v39
  s_add_u32 s57, s4, 3
  s_and_b32 s57, s57, 3
  s_add_u32 s57, s57, 0
  s_lshl_b32 s57, s57, 1
  v_xor_b32 v40, s57, v38
  v_lshl_add_u32 v9, v40, 4, v39
  s_add_u32 s57, s4, 4
  s_and_b32 s57, s57, 3
  s_add_u32 s57, s57, 4
  s_lshl_b32 s57, s57, 1
  v_xor_b32 v40, s57, v38
  v_lshl_add_u32 v48, v40, 4, v39
  s_add_u32 s57, s4, 5
  s_and_b32 s57, s57, 3
  s_add_u32 s57, s57, 4
  s_lshl_b32 s57, s57, 1
  v_xor_b32 v40, s57, v38
  v_lshl_add_u32 v49, v40, 4, v39
  s_add_u32 s57, s4, 6
  s_and_b32 s57, s57, 3
  s_add_u32 s57, s57, 4
  s_lshl_b32 s57, s57, 1
  v_xor_b32 v40, s57, v38
  v_lshl_add_u32 v50, v40, 4, v39
  s_add_u32 s57, s4, 7
  s_and_b32 s57, s57, 3
  s_add_u32 s57, s57, 4
  s_lshl_b32 s57, s57, 1
  v_xor_b32 v40, s57, v38
  v_lshl_add_u32 v51, v40, 4, v39
  v_bfe_u32 v40, v1, 2, 2
  v_lshl_add_u32 v41, v37, 3, v40
  v_lshlrev_b32 v41, 7, v41
  v_bfe_u32 v42, v1, 4, 1
  v_lshlrev_b32 v42, 1, v42
  v_bfe_u32 v43, v1, 1, 1
  v_add_u32 v42, v42, v43
  s_lshl_b32 s56, s5, 2
  v_add_u32 v42, s56, v42
  v_lshrrev_b32 v43, 1, v40
  v_lshlrev_b32 v43, 2, v43
  v_xor_b32 v42, v42, v43
  v_lshl_add_u32 v41, v42, 4, v41
  v_and_b32 v43, 1, v1
  v_lshl_add_u32 v41, v43, 3, v41
  s_add_u32 s57, s4, 0
  s_and_b32 s57, s57, 3
  s_lshl_b32 s57, s57, 11
  v_add_u32 v10, s57, v41
  s_add_u32 s57, s4, 1
  s_and_b32 s57, s57, 3
  s_lshl_b32 s57, s57, 11
  v_add_u32 v11, s57, v41
  s_add_u32 s57, s4, 2
  s_and_b32 s57, s57, 3
  s_lshl_b32 s57, s57, 11
  v_add_u32 v12, s57, v41
  s_add_u32 s57, s4, 3
  s_and_b32 s57, s57, 3
  s_lshl_b32 s57, s57, 11
  v_add_u32 v13, s57, v41
  v_and_b32 v40, 15, v1
  v_bfe_u32 v42, v1, 4, 1
  v_cmp_eq_u32 vcc, v40, v42
  v_mov_b32 v43, 0x3f803f80
  v_lshrrev_b32 v42, 4, v1
  v_cndmask_b32 v24, 0, v43, vcc
  v_mov_b32 v25, v24
  v_mov_b32 v26, v24
  v_mov_b32 v27, v24
  v_mov_b32 v46, 0x3f803f80
  v_mov_b32 v47, 0x3f803f80
  v_lshlrev_b32 v42, 6, v42
  v_lshl_add_u32 v42, v40, 8, v42
  s_lshl_b32 s56, s5, 9
  s_lshl_b32 s57, s4, 2
  s_add_u32 s57, s56, s57
  s_add_u32 s57, s57, 131072
  v_add_u32 v22, s57, v42
  v_lshlrev_b32 v42, 4, v37
  s_lshl_b32 s57, s3, 7
  s_add_u32 s57, s57, 136192
  v_add_u32 v21, s57, v42
  v_lshlrev_b32 v42, 2, v36
  v_add_u32 v14, s57, v42
  s_mov_b32 s74, 0x00030003
  s_mov_b32 s75, 0x00030003
  s_mov_b32 s78, 0x0001ffff
  s_mov_b32 s80, 0xffff0001
  s_lshl_b32 s76, s6, 2
  s_add_u32 s76, s76, s4
  s_mul_i32 s67, s76, 88064
  s_waitcnt vmcnt(0)
  s_lshl_b32 s59, s66, 2
  s_add_u32 m0, s59, 98304
  s_add_u32 s58, s65, 256
  buffer_load_dwordx4 v2, s[32:35], s58 offen lds
  s_lshl_b32 s59, s66, 2
  s_add_u32 m0, s59, 99328
  s_add_u32 s58, s65, 4352
  v_xor_b32 v3, 64, v2
  buffer_load_dwordx4 v3, s[32:35], s58 offen lds
  s_lshl_b32 s59, s66, 2
  s_add_u32 m0, s59, 100352
  s_add_u32 s58, s65, 8448
  v_xor_b32 v3, 128, v2
  buffer_load_dwordx4 v3, s[32:35], s58 offen lds
  s_lshl_b32 s59, s66, 2
  s_add_u32 m0, s59, 101376
  s_add_u32 s58, s65, 12544
  v_xor_b32 v3, 192, v2
  buffer_load_dwordx4 v3, s[32:35], s58 offen lds
  s_add_u32 m0, s66, 16384
  s_add_u32 s58, s60, 393216
  buffer_load_dwordx4 v4, s[36:39], s58 offen lds
  s_add_u32 m0, s66, 24576
  s_add_u32 s58, s60, 589824
  buffer_load_dwordx4 v4, s[36:39], s58 offen lds
  s_cmp_eq_u32 s5, 0
  s_cbranch_scc1 su_3_A
  s_barrier
  s_cmp_lg_u32 s3, 5
  s_cbranch_scc1 pfw_4
  s_and_b32 s56, s6, 7
  s_mul_i32 s56, s56, 196608
  s_add_u32 s56, s56, s61
  s_sub_u32 s56, s56, 122880
  v_mul_u32_u24 v45, 3072, v1
  buffer_load_dword v15, v45, s[36:39], s56 offen
  buffer_load_dword v15, v45, s[36:39], s56 offen offset:124
pfw_4:
  ds_read_b128 v[128:131], v6 offset:0
  ds_read_b64_tr_b16 v[80:81], v10 offset:0
  ds_read_b64_tr_b16 v[82:83], v10 offset:512
  ds_read_b128 v[132:135], v7 offset:0
  ds_read_b64_tr_b16 v[84:85], v11 offset:0
  ds_read_b64_tr_b16 v[86:87], v11 offset:512
  ds_read_b128 v[136:139], v8 offset:0
  ds_read_b64_tr_b16 v[88:89], v12 offset:0
  ds_read_b64_tr_b16 v[90:91], v12 offset:512
  ds_read_b128 v[140:143], v9 offset:0
  ds_read_b64_tr_b16 v[92:93], v13 offset:0
  ds_read_b64_tr_b16 v[94:95], v13 offset:512
  s_waitcnt lgkmcnt(9)
  v_mfma_f32_32x32x16_bf16 v[112:127], v[80:83], v[128:131], 0
  v_mfma_f32_16x16x32_bf16 v[28:31], v[80:83], v[24:27], 0
  v_mfma_f32_4x4x4_16b_bf16 v[32:35], v[128:129], v[128:129], 0
  v_mfma_f32_4x4x4_16b_bf16 v[40:43], v[130:131], v[130:131], 0
  s_lshl_b32 s59, s66, 2
  s_add_u32 m0, s59, 131072
  s_add_u32 s58, s65, 512
  buffer_load_dwordx4 v2, s[32:35], s58 offen lds
  ds_read_b128 v[144:147], v48 offset:0
  ds_read_b64_tr_b16 v[80:81], v10 offset:8192
  ds_read_b64_tr_b16 v[82:83], v10 offset:8704
  s_waitcnt lgkmcnt(9)
  v_mfma_f32_32x32x16_bf16 v[112:127], v[84:87], v[132:135], v[112:127]
  v_mfma_f32_4x4x4_16b_bf16 v[32:35], v[132:133], v[132:133], v[32:35]
  v_mfma_f32_4x4x4_16b_bf16 v[40:43], v[134:135], v[134:135], v[40:43]
  s_lshl_b32 s59, s66, 2
  s_add_u32 m0, s59, 132096
  s_add_u32 s58, s65, 4608
  v_xor_b32 v3, 64, v2
  buffer_load_dwordx4 v3, s[32:35], s58 offen lds
  ds_read_b128 v[148:151], v49 offset:0
  ds_read_b64_tr_b16 v[84:85], v11 offset:8192
  ds_read_b64_tr_b16 v[86:87], v11 offset:8704
  s_waitcnt lgkmcnt(9)
  v_mfma_f32_32x32x16_bf16 v[112:127], v[88:91], v[136:139], v[112:127]
  v_mfma_f32_4x4x4_16b_bf16 v[32:35], v[136:137], v[136:137], v[32:35]
  v_mfma_f32_4x4x4_16b_bf16 v[40:43], v[138:139], v[138:139], v[40:43]
  s_lshl_b32 s59, s66, 2
  s_add_u32 m0, s59, 133120
  s_add_u32 s58, s65, 8704
  v_xor_b32 v3, 128, v2
  buffer_load_dwordx4 v3, s[32:35], s58 offen lds
  ds_read_b128 v[152:155], v50 offset:0
  ds_read_b64_tr_b16 v[88:89], v12 offset:8192
  ds_read_b64_tr_b16 v[90:91], v12 offset:8704
  s_waitcnt lgkmcnt(9)
  v_mfma_f32_32x32x16_bf16 v[112:127], v[92:95], v[140:143], v[112:127]
  v_mfma_f32_4x4x4_16b_bf16 v[32:35], v[140:141], v[140:141], v[32:35]
  v_mfma_f32_4x4x4_16b_bf16 v[40:43], v[142:143], v[142:143], v[40:43]
  s_lshl_b32 s59, s66, 2
  s_add_u32 m0, s59, 134144
  s_add_u32 s58, s65, 12800
  v_xor_b32 v3, 192, v2
  buffer_load_dwordx4 v3, s[32:35], s58 offen lds
  ds_read_b128 v[156:159], v51 offset:0
  ds_read_b64_tr_b16 v[92:93], v13 offset:8192
  ds_read_b64_tr_b16 v[94:95], v13 offset:8704
  s_waitcnt lgkmcnt(9)
  v_mfma_f32_32x32x16_bf16 v[112:127], v[80:83], v[144:147], v[112:127]
  v_mfma_f32_16x16x32_bf16 v[28:31], v[80:83], v[24:27], v[28:31]
  v_mfma_f32_4x4x4_16b_bf16 v[32:35], v[144:145], v[144:145], v[32:35]
  v_mfma_f32_4x4x4_16b_bf16 v[40:43], v[146:147], v[146:147], v[40:43]
  s_add_u32 m0, s66, 32768
  s_add_u32 s58, s60, 786432
  buffer_load_dwordx4 v4, s[36:39], s58 offen lds
  s_waitcnt lgkmcnt(6)
  v_mfma_f32_32x32x16_bf16 v[112:127], v[84:87], v[148:151], v[112:127]
  v_mfma_f32_4x4x4_16b_bf16 v[32:35], v[148:149], v[148:149], v[32:35]
  v_mfma_f32_4x4x4_16b_bf16 v[40:43], v[150:151], v[150:151], v[40:43]
  s_add_u32 m0, s66, 40960
  s_add_u32 s58, s60, 983040
  buffer_load_dwordx4 v4, s[36:39], s58 offen lds
  s_add_u32 m0, s66, 49152
  s_add_u32 s58, s60, 1179648
  buffer_load_dwordx4 v4, s[36:39], s58 offen lds
  s_waitcnt lgkmcnt(3)
  v_mfma_f32_32x32x16_bf16 v[112:127], v[88:91], v[152:155], v[112:127]
  v_mfma_f32_4x4x4_16b_bf16 v[32:35], v[152:153], v[152:153], v[32:35]
  v_mfma_f32_4x4x4_16b_bf16 v[40:43], v[154:155], v[154:155], v[40:43]
  s_add_u32 m0, s66, 57344
  s_add_u32 s58, s60, 1376256
  buffer_load_dwordx4 v4, s[36:39], s58 offen lds
  s_waitcnt lgkmcnt(0)
  v_mfma_f32_32x32x16_bf16 v[112:127], v[92:95], v[156:159], v[112:127]
  v_mfma_f32_4x4x4_16b_bf16 v[32:35], v[156:157], v[156:157], v[32:35]
  v_mfma_f32_4x4x4_16b_bf16 v[40:43], v[158:159], v[158:159], v[40:43]
  s_waitcnt vmcnt(8)
  s_barrier
  s_cmp_lg_u32 s3, 6
  s_cbranch_scc1 pfw_5
  s_and_b32 s56, s6, 7
  s_mul_i32 s56, s56, 196608
  s_add_u32 s56, s56, s62
  s_sub_u32 s56, s56, 147456
  v_mul_u32_u24 v45, 3072, v1
  buffer_load_dword v15, v45, s[36:39], s56 offen
  buffer_load_dword v15, v45, s[36:39], s56 offen offset:124
pfw_5:
  ds_read_b128 v[160:163], v6 offset:32768
  ds_read_b64_tr_b16 v[80:81], v10 offset:16384
  ds_read_b64_tr_b16 v[82:83], v10 offset:16896
  ds_read_b128 v[164:167], v7 offset:32768
  ds_read_b64_tr_b16 v[84:85], v11 offset:16384
  ds_read_b64_tr_b16 v[86:87], v11 offset:16896
  ds_read_b128 v[168:171], v8 offset:32768
  ds_read_b64_tr_b16 v[88:89], v12 offset:16384
  ds_read_b64_tr_b16 v[90:91], v12 offset:16896
  ds_read_b128 v[172:175], v9 offset:32768
  ds_read_b64_tr_b16 v[92:93], v13 offset:16384
  ds_read_b64_tr_b16 v[94:95], v13 offset:16896
  s_waitcnt lgkmcnt(9)
  v_mfma_f32_32x32x16_bf16 v[112:127], v[80:83], v[160:163], v[112:127]
  v_mfma_f32_16x16x32_bf16 v[28:31], v[80:83], v[24:27], v[28:31]
  v_mfma_f32_4x4x4_16b_bf16 v[32:35], v[160:161], v[160:161], v[32:35]
  v_mfma_f32_4x4x4_16b_bf16 v[40:43], v[162:163], v[162:163], v[40:43]
  s_lshl_b32 s59, s66, 2
  s_add_u32 m0, s59, 65536
  s_add_u32 s58, s65, 768
  buffer_load_dwordx4 v2, s[32:35], s58 offen lds
  ds_read_b128 v[176:179], v48 offset:32768
  ds_read_b64_tr_b16 v[80:81], v10 offset:24576
  ds_read_b64_tr_b16 v[82:83], v10 offset:25088
  s_waitcnt lgkmcnt(9)
  v_mfma_f32_32x32x16_bf16 v[112:127], v[84:87], v[164:167], v[112:127]
  v_mfma_f32_4x4x4_16b_bf16 v[32:35], v[164:165], v[164:165], v[32:35]
  v_mfma_f32_4x4x4_16b_bf16 v[40:43], v[166:167], v[166:167], v[40:43]
  s_lshl_b32 s59, s66, 2
  s_add_u32 m0, s59, 66560
  s_add_u32 s58, s65, 4864
  v_xor_b32 v3, 64, v2
  buffer_load_dwordx4 v3, s[32:35], s58 offen lds
  ds_read_b128 v[180:183], v49 offset:32768
  ds_read_b64_tr_b16 v[84:85], v11 offset:24576
  ds_read_b64_tr_b16 v[86:87], v11 offset:25088
  s_waitcnt lgkmcnt(9)
  v_mfma_f32_32x32x16_bf16 v[112:127], v[88:91], v[168:171], v[112:127]
  v_mfma_f32_4x4x4_16b_bf16 v[32:35], v[168:169], v[168:169], v[32:35]
  v_mfma_f32_4x4x4_16b_bf16 v[40:43], v[170:171], v[170:171], v[40:43]
  s_lshl_b32 s59, s66, 2
  s_add_u32 m0, s59, 67584
  s_add_u32 s58, s65, 8960
  v_xor_b32 v3, 128, v2
  buffer_load_dwordx4 v3, s[32:35], s58 offen lds
  ds_read_b128 v[184:187], v50 offset:32768
  ds_read_b64_tr_b16 v[88:89], v12 offset:24576
  ds_read_b64_tr_b16 v[90:91], v12 offset:25088
  s_waitcnt lgkmcnt(9)
  v_mfma_f32_32x32x16_bf16 v[112:127], v[92:95], v[172:175], v[112:127]
  v_mfma_f32_4x4x4_16b_bf16 v[32:35], v[172:173], v[172:173], v[32:35]
  v_mfma_f32_4x4x4_16b_bf16 v[40:43], v[174:175], v[174:175], v[40:43]
  s_lshl_b32 s59, s66, 2
  s_add_u32 m0, s59, 68608
  s_add_u32 s58, s65, 13056
  v_xor_b32 v3, 192, v2
  buffer_load_dwordx4 v3, s[32:35], s58 offen lds
  ds_read_b128 v[188:191], v51 offset:32768
  ds_read_b64_tr_b16 v[92:93], v13 offset:24576
  ds_read_b64_tr_b16 v[94:95], v13 offset:25088
  s_waitcnt lgkmcnt(9)
  v_mfma_f32_32x32x16_bf16 v[112:127], v[80:83], v[176:179], v[112:127]
  v_mfma_f32_16x16x32_bf16 v[28:31], v[80:83], v[24:27], v[28:31]
  v_mfma_f32_4x4x4_16b_bf16 v[32:35], v[176:177], v[176:177], v[32:35]
  v_mfma_f32_4x4x4_16b_bf16 v[40:43], v[178:179], v[178:179], v[40:43]
  s_add_u32 m0, s66, 0
  s_add_u32 s58, s61, 0
  buffer_load_dwordx4 v4, s[36:39], s58 offen lds
  s_waitcnt lgkmcnt(6)
  v_mfma_f32_32x32x16_bf16 v[112:127], v[84:87], v[180:183], v[112:127]
  v_mfma_f32_4x4x4_16b_bf16 v[32:35], v[180:181], v[180:181], v[32:35]
  v_mfma_f32_4x4x4_16b_bf16 v[40:43], v[182:183], v[182:183], v[40:43]
  s_add_u32 m0, s66, 8192
  s_add_u32 s58, s61, 196608
  buffer_load_dwordx4 v4, s[36:39], s58 offen lds
  s_waitcnt lgkmcnt(3)
  v_mfma_f32_32x32x16_bf16 v[112:127], v[88:91], v[184:187], v[112:127]
  v_mfma_f32_4x4x4_16b_bf16 v[32:35], v[184:185], v[184:185], v[32:35]
  v_mfma_f32_4x4x4_16b_bf16 v[40:43], v[186:187], v[186:187], v[40:43]
  s_waitcnt lgkmcnt(0)
  v_mfma_f32_32x32x16_bf16 v[112:127], v[92:95], v[188:191], v[112:127]
  v_mfma_f32_4x4x4_16b_bf16 v[32:35], v[188:189], v[188:189], v[32:35]
  v_mfma_f32_4x4x4_16b_bf16 v[40:43], v[190:191], v[190:191], v[40:43]
  s_waitcnt vmcnt(8)
  s_barrier
  v_add_u32 v6, 0x10000, v6
  v_add_u32 v7, 0x10000, v7
  v_add_u32 v8, 0x10000, v8
  v_add_u32 v9, 0x10000, v9
  v_add_u32 v48, 0x10000, v48
  v_add_u32 v49, 0x10000, v49
  v_add_u32 v50, 0x10000, v50
  v_add_u32 v51, 0x10000, v51
  ds_read_b128 v[192:195], v6 offset:0
  ds_read_b64_tr_b16 v[80:81], v10 offset:32768
  ds_read_b64_tr_b16 v[82:83], v10 offset:33280
  ds_read_b128 v[196:199], v7 offset:0
  ds_read_b64_tr_b16 v[84:85], v11 offset:32768
  ds_read_b64_tr_b16 v[86:87], v11 offset:33280
  ds_read_b128 v[200:203], v8 offset:0
  ds_read_b64_tr_b16 v[88:89], v12 offset:32768
  ds_read_b64_tr_b16 v[90:91], v12 offset:33280
  ds_read_b128 v[204:207], v9 offset:0
  ds_read_b64_tr_b16 v[92:93], v13 offset:32768
  ds_read_b64_tr_b16 v[94:95], v13 offset:33280
  s_waitcnt lgkmcnt(9)
  v_mfma_f32_32x32x16_bf16 v[112:127], v[80:83], v[192:195], v[112:127]
  v_mfma_f32_16x16x32_bf16 v[28:31], v[80:83], v[24:27], v[28:31]
  v_mfma_f32_4x4x4_16b_bf16 v[32:35], v[192:193], v[192:193], v[32:35]
  v_mfma_f32_4x4x4_16b_bf16 v[40:43], v[194:195], v[194:195], v[40:43]
  s_add_u32 m0, s66, 16384
  s_add_u32 s58, s61, 393216
  buffer_load_dwordx4 v4, s[36:39], s58 offen lds
  ds_read_b128 v[208:211], v48 offset:0
  ds_read_b64_tr_b16 v[80:81], v10 offset:40960
  ds_read_b64_tr_b16 v[82:83], v10 offset:41472
  s_waitcnt lgkmcnt(9)
  v_mfma_f32_32x32x16_bf16 v[112:127], v[84:87], v[196:199], v[112:127]
  v_mfma_f32_4x4x4_16b_bf16 v[32:35], v[196:197], v[196:197], v[32:35]
  v_mfma_f32_4x4x4_16b_bf16 v[40:43], v[198:199], v[198:199], v[40:43]
  s_add_u32 m0, s66, 24576
  s_add_u32 s58, s61, 589824
  buffer_load_dwordx4 v4, s[36:39], s58 offen lds
  ds_read_b128 v[212:215], v49 offset:0
  ds_read_b64_tr_b16 v[84:85], v11 offset:40960
  ds_read_b64_tr_b16 v[86:87], v11 offset:41472
  s_waitcnt lgkmcnt(9)
  v_mfma_f32_32x32x16_bf16 v[112:127], v[88:91], v[200:203], v[112:127]
  v_mfma_f32_4x4x4_16b_bf16 v[32:35], v[200:201], v[200:201], v[32:35]
  v_mfma_f32_4x4x4_16b_bf16 v[40:43], v[202:203], v[202:203], v[40:43]
  s_add_u32 m0, s66, 98304
  s_add_u32 s58, s61, 786432
  buffer_load_dwordx4 v4, s[36:39], s58 offen lds
  ds_read_b128 v[216:219], v50 offset:0
  ds_read_b64_tr_b16 v[88:89], v12 offset:40960
  ds_read_b64_tr_b16 v[90:91], v12 offset:41472
  s_waitcnt lgkmcnt(9)
  v_mfma_f32_32x32x16_bf16 v[112:127], v[92:95], v[204:207], v[112:127]
  v_mfma_f32_4x4x4_16b_bf16 v[32:35], v[204:205], v[204:205], v[32:35]
  v_mfma_f32_4x4x4_16b_bf16 v[40:43], v[206:207], v[206:207], v[40:43]
  s_add_u32 m0, s66, 106496
  s_add_u32 s58, s61, 983040
  buffer_load_dwordx4 v4, s[36:39], s58 offen lds
  ds_read_b128 v[220:223], v51 offset:0
  ds_read_b64_tr_b16 v[92:93], v13 offset:40960
  ds_read_b64_tr_b16 v[94:95], v13 offset:41472
  s_waitcnt lgkmcnt(9)
  v_mfma_f32_32x32x16_bf16 v[112:127], v[80:83], v[208:211], v[112:127]
  v_mfma_f32_16x16x32_bf16 v[28:31], v[80:83], v[24:27], v[28:31]
  v_mfma_f32_4x4x4_16b_bf16 v[32:35], v[208:209], v[208:209], v[32:35]
  v_mfma_f32_4x4x4_16b_bf16 v[40:43], v[210:211], v[210:211], v[40:43]
  s_add_u32 m0, s66, 114688
  s_add_u32 s58, s61, 1179648
  buffer_load_dwordx4 v4, s[36:39], s58 offen lds
  s_waitcnt lgkmcnt(6)
  v_mfma_f32_32x32x16_bf16 v[112:127], v[84:87], v[212:215], v[112:127]
  v_mfma_f32_4x4x4_16b_bf16 v[32:35], v[212:213], v[212:213], v[32:35]
  v_mfma_f32_4x4x4_16b_bf16 v[40:43], v[214:215], v[214:215], v[40:43]
  s_add_u32 m0, s66, 122880
  s_add_u32 s58, s61, 1376256
  buffer_load_dwordx4 v4, s[36:39], s58 offen lds
  s_waitcnt lgkmcnt(3)
  v_mfma_f32_32x32x16_bf16 v[112:127], v[88:91], v[216:219], v[112:127]
  v_mfma_f32_4x4x4_16b_bf16 v[32:35], v[216:217], v[216:217], v[32:35]
  v_mfma_f32_4x4x4_16b_bf16 v[40:43], v[218:219], v[218:219], v[40:43]
  s_waitcnt lgkmcnt(0)
  v_mfma_f32_32x32x16_bf16 v[112:127], v[92:95], v[220:223], v[112:127]
  v_mfma_f32_4x4x4_16b_bf16 v[32:35], v[220:221], v[220:221], v[32:35]
  v_mfma_f32_4x4x4_16b_bf16 v[40:43], v[222:223], v[222:223], v[40:43]
  s_waitcnt vmcnt(8)
  s_barrier
  v_add_u32 v6, 0xffff0000, v6
  v_add_u32 v7, 0xffff0000, v7
  v_add_u32 v8, 0xffff0000, v8
  v_add_u32 v9, 0xffff0000, v9
  v_add_u32 v48, 0xffff0000, v48
  v_add_u32 v49, 0xffff0000, v49
  v_add_u32 v50, 0xffff0000, v50
  v_add_u32 v51, 0xffff0000, v51
  ds_read_b128 v[224:227], v6 offset:0
  ds_read_b64_tr_b16 v[80:81], v10 offset:49152
  ds_read_b64_tr_b16 v[82:83], v10 offset:49664
  ds_read_b128 v[228:231], v7 offset:0
  ds_read_b64_tr_b16 v[84:85], v11 offset:49152
  ds_read_b64_tr_b16 v[86:87], v11 offset:49664
  ds_read_b128 v[232:235], v8 offset:0
  ds_read_b64_tr_b16 v[88:89], v12 offset:49152
  ds_read_b64_tr_b16 v[90:91], v12 offset:49664
  ds_read_b128 v[236:239], v9 offset:0
  ds_read_b64_tr_b16 v[92:93], v13 offset:49152
  ds_read_b64_tr_b16 v[94:95], v13 offset:49664
  s_waitcnt lgkmcnt(9)
  v_mfma_f32_32x32x16_bf16 v[112:127], v[80:83], v[224:227], v[112:127]
  v_mfma_f32_16x16x32_bf16 v[28:31], v[80:83], v[24:27], v[28:31]
  v_mfma_f32_4x4x4_16b_bf16 v[32:35], v[224:225], v[224:225], v[32:35]
  v_mfma_f32_4x4x4_16b_bf16 v[40:43], v[226:227], v[226:227], v[40:43]
  ds_read_b128 v[240:243], v48 offset:0
  ds_read_b64_tr_b16 v[80:81], v10 offset:57344
  ds_read_b64_tr_b16 v[82:83], v10 offset:57856
  s_waitcnt lgkmcnt(9)
  v_mfma_f32_32x32x16_bf16 v[112:127], v[84:87], v[228:231], v[112:127]
  v_mfma_f32_4x4x4_16b_bf16 v[32:35], v[228:229], v[228:229], v[32:35]
  v_mfma_f32_4x4x4_16b_bf16 v[40:43], v[230:231], v[230:231], v[40:43]
  ds_read_b128 v[244:247], v49 offset:0
  ds_read_b64_tr_b16 v[84:85], v11 offset:57344
  ds_read_b64_tr_b16 v[86:87], v11 offset:57856
  s_waitcnt lgkmcnt(9)
  v_mfma_f32_32x32x16_bf16 v[112:127], v[88:91], v[232:235], v[112:127]
  v_mfma_f32_4x4x4_16b_bf16 v[32:35], v[232:233], v[232:233], v[32:35]
  v_mfma_f32_4x4x4_16b_bf16 v[40:43], v[234:235], v[234:235], v[40:43]
  ds_read_b128 v[248:251], v50 offset:0
  ds_read_b64_tr_b16 v[88:89], v12 offset:57344
  ds_read_b64_tr_b16 v[90:91], v12 offset:57856
  s_waitcnt lgkmcnt(9)
  v_mfma_f32_32x32x16_bf16 v[112:127], v[92:95], v[236:239], v[112:127]
  v_mfma_f32_4x4x4_16b_bf16 v[32:35], v[236:237], v[236:237], v[32:35]
  v_mfma_f32_4x4x4_16b_bf16 v[40:43], v[238:239], v[238:239], v[40:43]
  ds_read_b128 v[252:255], v51 offset:0
  ds_read_b64_tr_b16 v[92:93], v13 offset:57344
  ds_read_b64_tr_b16 v[94:95], v13 offset:57856
  s_waitcnt lgkmcnt(9)
  v_mfma_f32_32x32x16_bf16 v[112:127], v[80:83], v[240:243], v[112:127]
  v_mfma_f32_16x16x32_bf16 v[28:31], v[80:83], v[24:27], v[28:31]
  v_mfma_f32_4x4x4_16b_bf16 v[32:35], v[240:241], v[240:241], v[32:35]
  v_mfma_f32_4x4x4_16b_bf16 v[40:43], v[242:243], v[242:243], v[40:43]
  s_waitcnt lgkmcnt(6)
  v_mfma_f32_32x32x16_bf16 v[112:127], v[84:87], v[244:247], v[112:127]
  v_mfma_f32_4x4x4_16b_bf16 v[32:35], v[244:245], v[244:245], v[32:35]
  v_mfma_f32_4x4x4_16b_bf16 v[40:43], v[246:247], v[246:247], v[40:43]
  s_waitcnt lgkmcnt(3)
  v_mfma_f32_32x32x16_bf16 v[112:127], v[88:91], v[248:251], v[112:127]
  v_mfma_f32_4x4x4_16b_bf16 v[32:35], v[248:249], v[248:249], v[32:35]
  v_mfma_f32_4x4x4_16b_bf16 v[40:43], v[250:251], v[250:251], v[40:43]
  s_waitcnt lgkmcnt(0)
  v_mfma_f32_32x32x16_bf16 v[112:127], v[92:95], v[252:255], v[112:127]
  v_mfma_f32_4x4x4_16b_bf16 v[32:35], v[252:253], v[252:253], v[32:35]
  v_mfma_f32_4x4x4_16b_bf16 v[40:43], v[254:255], v[254:255], v[40:43]
  s_branch su_3_J
su_3_A:
  s_barrier
  s_cmp_lg_u32 s3, 5
  s_cbranch_scc1 pfw_6
  s_and_b32 s56, s6, 7
  s_mul_i32 s56, s56, 196608
  s_add_u32 s56, s56, s61
  s_sub_u32 s56, s56, 122880
  v_mul_u32_u24 v45, 3072, v1
  buffer_load_dword v15, v45, s[36:39], s56 offen
  buffer_load_dword v15, v45, s[36:39], s56 offen offset:124
pfw_6:
  ds_read_b128 v[128:131], v6 offset:0
  ds_read_b64_tr_b16 v[80:81], v10 offset:0
  ds_read_b64_tr_b16 v[82:83], v10 offset:512
  ds_read_b128 v[132:135], v7 offset:0
  ds_read_b64_tr_b16 v[84:85], v11 offset:0
  ds_read_b64_tr_b16 v[86:87], v11 offset:512
  ds_read_b128 v[136:139], v8 offset:0
  ds_read_b64_tr_b16 v[88:89], v12 offset:0
  ds_read_b64_tr_b16 v[90:91], v12 offset:512
  ds_read_b128 v[140:143], v9 offset:0
  ds_read_b64_tr_b16 v[92:93], v13 offset:0
  ds_read_b64_tr_b16 v[94:95], v13 offset:512
  s_waitcnt lgkmcnt(9)
  v_mfma_f32_32x32x16_bf16 v[112:127], v[80:83], v[128:131], 0
  v_mfma_f32_16x16x32_bf16 v[28:31], v[80:83], v[24:27], 0
  v_mfma_f32_4x4x4_16b_bf16 v[32:35], v[128:129], v[46:47], 0
  v_mfma_f32_4x4x4_16b_bf16 v[40:43], v[130:131], v[46:47], 0
  s_lshl_b32 s59, s66, 2
  s_add_u32 m0, s59, 131072
  s_add_u32 s58, s65, 512
  buffer_load_dwordx4 v2, s[32:35], s58 offen lds
  ds_read_b128 v[144:147], v48 offset:0
  ds_read_b64_tr_b16 v[80:81], v10 offset:8192
  ds_read_b64_tr_b16 v[82:83], v10 offset:8704
  s_waitcnt lgkmcnt(9)
  v_mfma_f32_32x32x16_bf16 v[112:127], v[84:87], v[132:135], v[112:127]
  v_mfma_f32_4x4x4_16b_bf16 v[32:35], v[132:133], v[46:47], v[32:35]
  v_mfma_f32_4x4x4_16b_bf16 v[40:43], v[134:135], v[46:47], v[40:43]
  s_lshl_b32 s59, s66, 2
  s_add_u32 m0, s59, 132096
  s_add_u32 s58, s65, 4608
  v_xor_b32 v3, 64, v2
  buffer_load_dwordx4 v3, s[32:35], s58 offen lds
  ds_read_b128 v[148:151], v49 offset:0
  ds_read_b64_tr_b16 v[84:85], v11 offset:8192
  ds_read_b64_tr_b16 v[86:87], v11 offset:8704
  s_waitcnt lgkmcnt(9)
  v_mfma_f32_32x32x16_bf16 v[112:127], v[88:91], v[136:139], v[112:127]
  v_mfma_f32_4x4x4_16b_bf16 v[32:35], v[136:137], v[46:47], v[32:35]
  v_mfma_f32_4x4x4_16b_bf16 v[40:43], v[138:139], v[46:47], v[40:43]
  s_lshl_b32 s59, s66, 2
  s_add_u32 m0, s59, 133120
  s_add_u32 s58, s65, 8704
  v_xor_b32 v3, 128, v2
  buffer_load_dwordx4 v3, s[32:35], s58 offen lds
  ds_read_b128 v[152:155], v50 offset:0
  ds_read_b64_tr_b16 v[88:89], v12 offset:8192
  ds_read_b64_tr_b16 v[90:91], v12 offset:8704
  s_waitcnt lgkmcnt(9)
  v_mfma_f32_32x32x16_bf16 v[112:127], v[92:95], v[140:143], v[112:127]
  v_mfma_f32_4x4x4_16b_bf16 v[32:35], v[140:141], v[46:47], v[32:35]
  v_mfma_f32_4x4x4_16b_bf16 v[40:43], v[142:143], v[46:47], v[40:43]
  s_lshl_b32 s59, s66, 2
  s_add_u32 m0, s59, 134144
  s_add_u32 s58, s65, 12800
  v_xor_b32 v3, 192, v2
  buffer_load_dwordx4 v3, s[32:35], s58 offen lds
  ds_read_b128 v[156:159], v51 offset:0
  ds_read_b64_tr_b16 v[92:93], v13 offset:8192
  ds_read_b64_tr_b16 v[94:95], v13 offset:8704
  s_waitcnt lgkmcnt(9)
  v_mfma_f32_32x32x16_bf16 v[112:127], v[80:83], v[144:147], v[112:127]
  v_mfma_f32_16x16x32_bf16 v[28:31], v[80:83], v[24:27], v[28:31]
  v_mfma_f32_4x4x4_16b_bf16 v[32:35], v[144:145], v[46:47], v[32:35]
  v_mfma_f32_4x4x4_16b_bf16 v[40:43], v[146:147], v[46:47], v[40:43]
  s_add_u32 m0, s66, 32768
  s_add_u32 s58, s60, 786432
  buffer_load_dwordx4 v4, s[36:39], s58 offen lds
  s_waitcnt lgkmcnt(6)
  v_mfma_f32_32x32x16_bf16 v[112:127], v[84:87], v[148:151], v[112:127]
  v_mfma_f32_4x4x4_16b_bf16 v[32:35], v[148:149], v[46:47], v[32:35]
  v_mfma_f32_4x4x4_16b_bf16 v[40:43], v[150:151], v[46:47], v[40:43]
  s_add_u32 m0, s66, 40960
  s_add_u32 s58, s60, 983040
  buffer_load_dwordx4 v4, s[36:39], s58 offen lds
  s_add_u32 m0, s66, 49152
  s_add_u32 s58, s60, 1179648
  buffer_load_dwordx4 v4, s[36:39], s58 offen lds
  s_waitcnt lgkmcnt(3)
  v_mfma_f32_32x32x16_bf16 v[112:127], v[88:91], v[152:155], v[112:127]
  v_mfma_f32_4x4x4_16b_bf16 v[32:35], v[152:153], v[46:47], v[32:35]
  v_mfma_f32_4x4x4_16b_bf16 v[40:43], v[154:155], v[46:47], v[40:43]
  s_add_u32 m0, s66, 57344
  s_add_u32 s58, s60, 1376256
  buffer_load_dwordx4 v4, s[36:39], s58 offen lds
  s_waitcnt lgkmcnt(0)
  v_mfma_f32_32x32x16_bf16 v[112:127], v[92:95], v[156:159], v[112:127]
  v_mfma_f32_4x4x4_16b_bf16 v[32:35], v[156:157], v[46:47], v[32:35]
  v_mfma_f32_4x4x4_16b_bf16 v[40:43], v[158:159], v[46:47], v[40:43]
  s_waitcnt vmcnt(8)
  s_barrier
  s_cmp_lg_u32 s3, 6
  s_cbranch_scc1 pfw_7
  s_and_b32 s56, s6, 7
  s_mul_i32 s56, s56, 196608
  s_add_u32 s56, s56, s62
  s_sub_u32 s56, s56, 147456
  v_mul_u32_u24 v45, 3072, v1
  buffer_load_dword v15, v45, s[36:39], s56 offen
  buffer_load_dword v15, v45, s[36:39], s56 offen offset:124
pfw_7:
  ds_read_b128 v[160:163], v6 offset:32768
  ds_read_b64_tr_b16 v[80:81], v10 offset:16384
  ds_read_b64_tr_b16 v[82:83], v10 offset:16896
  ds_read_b128 v[164:167], v7 offset:32768
  ds_read_b64_tr_b16 v[84:85], v11 offset:16384
  ds_read_b64_tr_b16 v[86:87], v11 offset:16896
  ds_read_b128 v[168:171], v8 offset:32768
  ds_read_b64_tr_b16 v[88:89], v12 offset:16384
  ds_read_b64_tr_b16 v[90:91], v12 offset:16896
  ds_read_b128 v[172:175], v9 offset:32768
  ds_read_b64_tr_b16 v[92:93], v13 offset:16384
  ds_read_b64_tr_b16 v[94:95], v13 offset:16896
  s_waitcnt lgkmcnt(9)
  v_mfma_f32_32x32x16_bf16 v[112:127], v[80:83], v[160:163], v[112:127]
  v_mfma_f32_16x16x32_bf16 v[28:31], v[80:83], v[24:27], v[28:31]
  v_mfma_f32_4x4x4_16b_bf16 v[32:35], v[160:161], v[46:47], v[32:35]
  v_mfma_f32_4x4x4_16b_bf16 v[40:43], v[162:163], v[46:47], v[40:43]
  s_lshl_b32 s59, s66, 2
  s_add_u32 m0, s59, 65536
  s_add_u32 s58, s65, 768
  buffer_load_dwordx4 v2, s[32:35], s58 offen lds
  ds_read_b128 v[176:179], v48 offset:32768
  ds_read_b64_tr_b16 v[80:81], v10 offset:24576
  ds_read_b64_tr_b16 v[82:83], v10 offset:25088
  s_waitcnt lgkmcnt(9)
  v_mfma_f32_32x32x16_bf16 v[112:127], v[84:87], v[164:167], v[112:127]
  v_mfma_f32_4x4x4_16b_bf16 v[32:35], v[164:165], v[46:47], v[32:35]
  v_mfma_f32_4x4x4_16b_bf16 v[40:43], v[166:167], v[46:47], v[40:43]
  s_lshl_b32 s59, s66, 2
  s_add_u32 m0, s59, 66560
  s_add_u32 s58, s65, 4864
  v_xor_b32 v3, 64, v2
  buffer_load_dwordx4 v3, s[32:35], s58 offen lds
  ds_read_b128 v[180:183], v49 offset:32768
  ds_read_b64_tr_b16 v[84:85], v11 offset:24576
  ds_read_b64_tr_b16 v[86:87], v11 offset:25088
  s_waitcnt lgkmcnt(9)
  v_mfma_f32_32x32x16_bf16 v[112:127], v[88:91], v[168:171], v[112:127]
  v_mfma_f32_4x4x4_16b_bf16 v[32:35], v[168:169], v[46:47], v[32:35]
  v_mfma_f32_4x4x4_16b_bf16 v[40:43], v[170:171], v[46:47], v[40:43]
  s_lshl_b32 s59, s66, 2
  s_add_u32 m0, s59, 67584
  s_add_u32 s58, s65, 8960
  v_xor_b32 v3, 128, v2
  buffer_load_dwordx4 v3, s[32:35], s58 offen lds
  ds_read_b128 v[184:187], v50 offset:32768
  ds_read_b64_tr_b16 v[88:89], v12 offset:24576
  ds_read_b64_tr_b16 v[90:91], v12 offset:25088
  s_waitcnt lgkmcnt(9)
  v_mfma_f32_32x32x16_bf16 v[112:127], v[92:95], v[172:175], v[112:127]
  v_mfma_f32_4x4x4_16b_bf16 v[32:35], v[172:173], v[46:47], v[32:35]
  v_mfma_f32_4x4x4_16b_bf16 v[40:43], v[174:175], v[46:47], v[40:43]
  s_lshl_b32 s59, s66, 2
  s_add_u32 m0, s59, 68608
  s_add_u32 s58, s65, 13056
  v_xor_b32 v3, 192, v2
  buffer_load_dwordx4 v3, s[32:35], s58 offen lds
  ds_read_b128 v[188:191], v51 offset:32768
  ds_read_b64_tr_b16 v[92:93], v13 offset:24576
  ds_read_b64_tr_b16 v[94:95], v13 offset:25088
  s_waitcnt lgkmcnt(9)
  v_mfma_f32_32x32x16_bf16 v[112:127], v[80:83], v[176:179], v[112:127]
  v_mfma_f32_16x16x32_bf16 v[28:31], v[80:83], v[24:27], v[28:31]
  v_mfma_f32_4x4x4_16b_bf16 v[32:35], v[176:177], v[46:47], v[32:35]
  v_mfma_f32_4x4x4_16b_bf16 v[40:43], v[178:179], v[46:47], v[40:43]
  s_add_u32 m0, s66, 0
  s_add_u32 s58, s61, 0
  buffer_load_dwordx4 v4, s[36:39], s58 offen lds
  s_waitcnt lgkmcnt(6)
  v_mfma_f32_32x32x16_bf16 v[112:127], v[84:87], v[180:183], v[112:127]
  v_mfma_f32_4x4x4_16b_bf16 v[32:35], v[180:181], v[46:47], v[32:35]
  v_mfma_f32_4x4x4_16b_bf16 v[40:43], v[182:183], v[46:47], v[40:43]
  s_add_u32 m0, s66, 8192
  s_add_u32 s58, s61, 196608
  buffer_load_dwordx4 v4, s[36:39], s58 offen lds
  s_waitcnt lgkmcnt(3)
  v_mfma_f32_32x32x16_bf16 v[112:127], v[88:91], v[184:187], v[112:127]
  v_mfma_f32_4x4x4_16b_bf16 v[32:35], v[184:185], v[46:47], v[32:35]
  v_mfma_f32_4x4x4_16b_bf16 v[40:43], v[186:187], v[46:47], v[40:43]
  s_waitcnt lgkmcnt(0)
  v_mfma_f32_32x32x16_bf16 v[112:127], v[92:95], v[188:191], v[112:127]
  v_mfma_f32_4x4x4_16b_bf16 v[32:35], v[188:189], v[46:47], v[32:35]
  v_mfma_f32_4x4x4_16b_bf16 v[40:43], v[190:191], v[46:47], v[40:43]
  s_waitcnt vmcnt(8)
  s_barrier
  v_add_u32 v6, 0x10000, v6
  v_add_u32 v7, 0x10000, v7
  v_add_u32 v8, 0x10000, v8
  v_add_u32 v9, 0x10000, v9
  v_add_u32 v48, 0x10000, v48
  v_add_u32 v49, 0x10000, v49
  v_add_u32 v50, 0x10000, v50
  v_add_u32 v51, 0x10000, v51
  ds_read_b128 v[192:195], v6 offset:0
  ds_read_b64_tr_b16 v[80:81], v10 offset:32768
  ds_read_b64_tr_b16 v[82:83], v10 offset:33280
  ds_read_b128 v[196:199], v7 offset:0
  ds_read_b64_tr_b16 v[84:85], v11 offset:32768
  ds_read_b64_tr_b16 v[86:87], v11 offset:33280
  ds_read_b128 v[200:203], v8 offset:0
  ds_read_b64_tr_b16 v[88:89], v12 offset:32768
  ds_read_b64_tr_b16 v[90:91], v12 offset:33280
  ds_read_b128 v[204:207], v9 offset:0
  ds_read_b64_tr_b16 v[92:93], v13 offset:32768
  ds_read_b64_tr_b16 v[94:95], v13 offset:33280
  s_waitcnt lgkmcnt(9)
  v_mfma_f32_32x32x16_bf16 v[112:127], v[80:83], v[192:195], v[112:127]
  v_mfma_f32_16x16x32_bf16 v[28:31], v[80:83], v[24:27], v[28:31]
  v_mfma_f32_4x4x4_16b_bf16 v[32:35], v[192:193], v[46:47], v[32:35]
  v_mfma_f32_4x4x4_16b_bf16 v[40:43], v[194:195], v[46:47], v[40:43]
  s_add_u32 m0, s66, 16384
  s_add_u32 s58, s61, 393216
  buffer_load_dwordx4 v4, s[36:39], s58 offen lds
  ds_read_b128 v[208:211], v48 offset:0
  ds_read_b64_tr_b16 v[80:81], v10 offset:40960
  ds_read_b64_tr_b16 v[82:83], v10 offset:41472
  s_waitcnt lgkmcnt(9)
  v_mfma_f32_32x32x16_bf16 v[112:127], v[84:87], v[196:199], v[112:127]
  v_mfma_f32_4x4x4_16b_bf16 v[32:35], v[196:197], v[46:47], v[32:35]
  v_mfma_f32_4x4x4_16b_bf16 v[40:43], v[198:199], v[46:47], v[40:43]
  s_add_u32 m0, s66, 24576
  s_add_u32 s58, s61, 589824
  buffer_load_dwordx4 v4, s[36:39], s58 offen lds
  ds_read_b128 v[212:215], v49 offset:0
  ds_read_b64_tr_b16 v[84:85], v11 offset:40960
  ds_read_b64_tr_b16 v[86:87], v11 offset:41472
  s_waitcnt lgkmcnt(9)
  v_mfma_f32_32x32x16_bf16 v[112:127], v[88:91], v[200:203], v[112:127]
  v_mfma_f32_4x4x4_16b_bf16 v[32:35], v[200:201], v[46:47], v[32:35]
  v_mfma_f32_4x4x4_16b_bf16 v[40:43], v[202:203], v[46:47], v[40:43]
  s_add_u32 m0, s66, 98304
  s_add_u32 s58, s61, 786432
  buffer_load_dwordx4 v4, s[36:39], s58 offen lds
  ds_read_b128 v[216:219], v50 offset:0
  ds_read_b64_tr_b16 v[88:89], v12 offset:40960
  ds_read_b64_tr_b16 v[90:91], v12 offset:41472
  s_waitcnt lgkmcnt(9)
  v_mfma_f32_32x32x16_bf16 v[112:127], v[92:95], v[204:207], v[112:127]
  v_mfma_f32_4x4x4_16b_bf16 v[32:35], v[204:205], v[46:47], v[32:35]
  v_mfma_f32_4x4x4_16b_bf16 v[40:43], v[206:207], v[46:47], v[40:43]
  s_add_u32 m0, s66, 106496
  s_add_u32 s58, s61, 983040
  buffer_load_dwordx4 v4, s[36:39], s58 offen lds
  ds_read_b128 v[220:223], v51 offset:0
  ds_read_b64_tr_b16 v[92:93], v13 offset:40960
  ds_read_b64_tr_b16 v[94:95], v13 offset:41472
  s_waitcnt lgkmcnt(9)
  v_mfma_f32_32x32x16_bf16 v[112:127], v[80:83], v[208:211], v[112:127]
  v_mfma_f32_16x16x32_bf16 v[28:31], v[80:83], v[24:27], v[28:31]
  v_mfma_f32_4x4x4_16b_bf16 v[32:35], v[208:209], v[46:47], v[32:35]
  v_mfma_f32_4x4x4_16b_bf16 v[40:43], v[210:211], v[46:47], v[40:43]
  s_add_u32 m0, s66, 114688
  s_add_u32 s58, s61, 1179648
  buffer_load_dwordx4 v4, s[36:39], s58 offen lds
  s_waitcnt lgkmcnt(6)
  v_mfma_f32_32x32x16_bf16 v[112:127], v[84:87], v[212:215], v[112:127]
  v_mfma_f32_4x4x4_16b_bf16 v[32:35], v[212:213], v[46:47], v[32:35]
  v_mfma_f32_4x4x4_16b_bf16 v[40:43], v[214:215], v[46:47], v[40:43]
  s_add_u32 m0, s66, 122880
  s_add_u32 s58, s61, 1376256
  buffer_load_dwordx4 v4, s[36:39], s58 offen lds
  s_waitcnt lgkmcnt(3)
  v_mfma_f32_32x32x16_bf16 v[112:127], v[88:91], v[216:219], v[112:127]
  v_mfma_f32_4x4x4_16b_bf16 v[32:35], v[216:217], v[46:47], v[32:35]
  v_mfma_f32_4x4x4_16b_bf16 v[40:43], v[218:219], v[46:47], v[40:43]
  s_waitcnt lgkmcnt(0)
  v_mfma_f32_32x32x16_bf16 v[112:127], v[92:95], v[220:223], v[112:127]
  v_mfma_f32_4x4x4_16b_bf16 v[32:35], v[220:221], v[46:47], v[32:35]
  v_mfma_f32_4x4x4_16b_bf16 v[40:43], v[222:223], v[46:47], v[40:43]
  s_waitcnt vmcnt(8)
  s_barrier
  v_add_u32 v6, 0xffff0000, v6
  v_add_u32 v7, 0xffff0000, v7
  v_add_u32 v8, 0xffff0000, v8
  v_add_u32 v9, 0xffff0000, v9
  v_add_u32 v48, 0xffff0000, v48
  v_add_u32 v49, 0xffff0000, v49
  v_add_u32 v50, 0xffff0000, v50
  v_add_u32 v51, 0xffff0000, v51
  ds_read_b128 v[224:227], v6 offset:0
  ds_read_b64_tr_b16 v[80:81], v10 offset:49152
  ds_read_b64_tr_b16 v[82:83], v10 offset:49664
  ds_read_b128 v[228:231], v7 offset:0
  ds_read_b64_tr_b16 v[84:85], v11 offset:49152
  ds_read_b64_tr_b16 v[86:87], v11 offset:49664
  ds_read_b128 v[232:235], v8 offset:0
  ds_read_b64_tr_b16 v[88:89], v12 offset:49152
  ds_read_b64_tr_b16 v[90:91], v12 offset:49664
  ds_read_b128 v[236:239], v9 offset:0
  ds_read_b64_tr_b16 v[92:93], v13 offset:49152
  ds_read_b64_tr_b16 v[94:95], v13 offset:49664
  s_waitcnt lgkmcnt(9)
  v_mfma_f32_32x32x16_bf16 v[112:127], v[80:83], v[224:227], v[112:127]
  v_mfma_f32_16x16x32_bf16 v[28:31], v[80:83], v[24:27], v[28:31]
  v_mfma_f32_4x4x4_16b_bf16 v[32:35], v[224:225], v[46:47], v[32:35]
  v_mfma_f32_4x4x4_16b_bf16 v[40:43], v[226:227], v[46:47], v[40:43]
  ds_read_b128 v[240:243], v48 offset:0
  ds_read_b64_tr_b16 v[80:81], v10 offset:57344
  ds_read_b64_tr_b16 v[82:83], v10 offset:57856
  s_waitcnt lgkmcnt(9)
  v_mfma_f32_32x32x16_bf16 v[112:127], v[84:87], v[228:231], v[112:127]
  v_mfma_f32_4x4x4_16b_bf16 v[32:35], v[228:229], v[46:47], v[32:35]
  v_mfma_f32_4x4x4_16b_bf16 v[40:43], v[230:231], v[46:47], v[40:43]
  ds_read_b128 v[244:247], v49 offset:0
  ds_read_b64_tr_b16 v[84:85], v11 offset:57344
  ds_read_b64_tr_b16 v[86:87], v11 offset:57856
  s_waitcnt lgkmcnt(9)
  v_mfma_f32_32x32x16_bf16 v[112:127], v[88:91], v[232:235], v[112:127]
  v_mfma_f32_4x4x4_16b_bf16 v[32:35], v[232:233], v[46:47], v[32:35]
  v_mfma_f32_4x4x4_16b_bf16 v[40:43], v[234:235], v[46:47], v[40:43]
  ds_read_b128 v[248:251], v50 offset:0
  ds_read_b64_tr_b16 v[88:89], v12 offset:57344
  ds_read_b64_tr_b16 v[90:91], v12 offset:57856
  s_waitcnt lgkmcnt(9)
  v_mfma_f32_32x32x16_bf16 v[112:127], v[92:95], v[236:239], v[112:127]
  v_mfma_f32_4x4x4_16b_bf16 v[32:35], v[236:237], v[46:47], v[32:35]
  v_mfma_f32_4x4x4_16b_bf16 v[40:43], v[238:239], v[46:47], v[40:43]
  ds_read_b128 v[252:255], v51 offset:0
  ds_read_b64_tr_b16 v[92:93], v13 offset:57344
  ds_read_b64_tr_b16 v[94:95], v13 offset:57856
  s_waitcnt lgkmcnt(9)
  v_mfma_f32_32x32x16_bf16 v[112:127], v[80:83], v[240:243], v[112:127]
  v_mfma_f32_16x16x32_bf16 v[28:31], v[80:83], v[24:27], v[28:31]
  v_mfma_f32_4x4x4_16b_bf16 v[32:35], v[240:241], v[46:47], v[32:35]
  v_mfma_f32_4x4x4_16b_bf16 v[40:43], v[242:243], v[46:47], v[40:43]
  s_waitcnt lgkmcnt(6)
  v_mfma_f32_32x32x16_bf16 v[112:127], v[84:87], v[244:247], v[112:127]
  v_mfma_f32_4x4x4_16b_bf16 v[32:35], v[244:245], v[46:47], v[32:35]
  v_mfma_f32_4x4x4_16b_bf16 v[40:43], v[246:247], v[46:47], v[40:43]
  s_waitcnt lgkmcnt(3)
  v_mfma_f32_32x32x16_bf16 v[112:127], v[88:91], v[248:251], v[112:127]
  v_mfma_f32_4x4x4_16b_bf16 v[32:35], v[248:249], v[46:47], v[32:35]
  v_mfma_f32_4x4x4_16b_bf16 v[40:43], v[250:251], v[46:47], v[40:43]
  s_waitcnt lgkmcnt(0)
  v_mfma_f32_32x32x16_bf16 v[112:127], v[92:95], v[252:255], v[112:127]
  v_mfma_f32_4x4x4_16b_bf16 v[32:35], v[252:253], v[46:47], v[32:35]
  v_mfma_f32_4x4x4_16b_bf16 v[40:43], v[254:255], v[46:47], v[40:43]
su_3_J:
  s_nop 7
  s_mov_b64 exec, s[74:75]
  ds_write_b32 v22, v28 offset:0
  ds_write_b32 v22, v29 offset:16
  ds_write_b32 v22, v30 offset:32
  ds_write_b32 v22, v31 offset:48
  s_mov_b64 exec, -1
  v_add_f32 v32, v32, v40
  v_add_f32 v33, v33, v41
  v_add_f32 v34, v34, v42
  v_add_f32 v35, v35, v43
  v_and_b32 v36, 3, v1
  v_cmp_eq_u32 vcc, 1, v36
  v_cmp_eq_u32 s[82:83], 2, v36
  v_cmp_eq_u32 s[70:71], 3, v36
  s_nop 1
  v_cndmask_b32 v32, v32, v33, vcc
  v_cndmask_b32 v32, v32, v34, s[82:83]
  v_cndmask_b32 v32, v32, v35, s[70:71]
  v_mov_b32 v33, v32
  s_nop 1
  v_permlane32_swap_b32 v32, v33
  v_add_f32 v32, v32, v33
  v_and_b32 v36, 31, v1
  v_lshlrev_b32 v3, 4, v36
  s_lshl_b32 s56, s4, 5
  v_add_u32 v36, s56, v36
  v_lshlrev_b32 v36, 2, v36
  v_add_u32 v36, 137216, v36
  s_lshl_b32 s56, s5, 9
  v_add_u32 v37, s56, v36
  ds_write_b32 v37, v32
  s_add_u32 s56, s56, 131072
  v_add_u32 v3, s56, v3
  s_waitcnt vmcnt(0) lgkmcnt(0)
  s_barrier
  ds_read_b32 v38, v36
  ds_read_b32 v39, v36 offset:512
  ds_read_b64_tr_b16 v[80:81], v10 offset:0
  ds_read_b64_tr_b16 v[82:83], v10 offset:512
  ds_read_b64_tr_b16 v[84:85], v11 offset:0
  ds_read_b64_tr_b16 v[86:87], v11 offset:512
  ds_read_b64_tr_b16 v[88:89], v12 offset:0
  ds_read_b64_tr_b16 v[90:91], v12 offset:512
  ds_read_b128 v[40:43], v3 offset:0
  s_waitcnt lgkmcnt(0)
  v_add_f32 v40, v40, v41
  v_add_f32 v42, v42, v43
  v_add_f32 v44, v40, v42
  ds_write_b32 v14, v44
  v_mul_f32 v38, 0x3b000000, v38
  v_mul_f32 v39, 0x3b000000, v39
  v_fma_f32 v39, -v38, v38, v39
  v_max_f32 v39, 0, v39
  v_add_f32 v39, 0x3727c5ac, v39
  v_sub_f32 v18, 0, v38
  v_rsq_f32 v19, v39
  v_mov_b32 v20, v39
  s_nop 0
  v_mul_f32 v17, 0xc0135761, v19
  v_mul_f32 v2, v19, v19
  v_mul_f32 v2, v2, v19
  v_mul_f32 v2, 0xbdd2d3e8, v2
  v_mul_f32 v0, 0x3fb8aa3b, v19
  v_mul_f32 v40, v18, v19
  ds_write_b32 v36, v19 offset:1024
  ds_write_b32 v36, v40 offset:1536
  v_bfe_u32 v41, v1, 2, 1
  v_cmp_eq_u32 vcc, 0, v41
  v_lshl_or_b32 v48, v101, 16, v100
  v_lshl_or_b32 v49, v103, 16, v102
  v_lshl_or_b32 v50, v105, 16, v104
  v_lshl_or_b32 v51, v107, 16, v106
  v_cndmask_b32 v6, 0, v48, vcc
  v_cndmask_b32 v7, 0, v49, vcc
  v_cndmask_b32 v8, 0, v50, vcc
  v_cndmask_b32 v9, 0, v51, vcc
  v_cndmask_b32 v32, v48, 0, vcc
  v_cndmask_b32 v33, v49, 0, vcc
  v_cndmask_b32 v34, v50, 0, vcc
  v_cndmask_b32 v35, v51, 0, vcc
  v_mov_b32 v44, 135168
  v_mov_b32 v45, 0
  ds_write_b32 v44, v45
  ds_read_b64_tr_b16 v[92:93], v13 offset:0
  ds_read_b64_tr_b16 v[94:95], v13 offset:512
  v_mfma_f32_32x32x16_bf16 v[96:111], v[128:131], v[80:83], 0
  v_mfma_f32_16x16x32_bf16 v[28:31], v[80:83], v[24:27], 0
  ds_read_b128 v[64:67], v21 offset:0
  ds_read_b128 v[68:71], v21 offset:32
  ds_read_b128 v[72:75], v21 offset:64
  ds_read_b128 v[76:79], v21 offset:96
  ds_read_b64_tr_b16 v[80:81], v10 offset:8192
  ds_read_b64_tr_b16 v[82:83], v10 offset:8704
  v_mfma_f32_32x32x16_bf16 v[96:111], v[132:135], v[84:87], v[96:111]
  s_add_u32 m0, s66, 32768
  s_add_u32 s58, s62, 0
  buffer_load_dwordx4 v4, s[36:39], s58 offen lds
  ds_read_b64_tr_b16 v[84:85], v11 offset:8192
  ds_read_b64_tr_b16 v[86:87], v11 offset:8704
  v_mfma_f32_32x32x16_bf16 v[96:111], v[136:139], v[88:91], v[96:111]
  s_waitcnt lgkmcnt(7)
  v_fma_f32 v112, v64, v18, v112
  v_fma_f32 v113, v65, v18, v113
  v_fma_f32 v114, v66, v18, v114
  v_fma_f32 v115, v67, v18, v115
  s_waitcnt lgkmcnt(6)
  v_fma_f32 v116, v68, v18, v116
  ds_read_b64_tr_b16 v[88:89], v12 offset:8192
  ds_read_b64_tr_b16 v[90:91], v12 offset:8704
  v_mfma_f32_32x32x16_bf16 v[96:111], v[140:143], v[92:95], v[96:111]
  s_add_u32 m0, s66, 40960
  s_add_u32 s58, s62, 196608
  buffer_load_dwordx4 v4, s[36:39], s58 offen lds
  v_fma_f32 v117, v69, v18, v117
  v_fma_f32 v118, v70, v18, v118
  v_fma_f32 v119, v71, v18, v119
  s_waitcnt lgkmcnt(7)
  v_fma_f32 v120, v72, v18, v120
  v_fma_f32 v121, v73, v18, v121
  ds_read_b64_tr_b16 v[92:93], v13 offset:8192
  ds_read_b64_tr_b16 v[94:95], v13 offset:8704
  s_waitcnt lgkmcnt(6)
  v_mfma_f32_32x32x16_bf16 v[96:111], v[144:147], v[80:83], v[96:111]
  v_mfma_f32_16x16x32_bf16 v[28:31], v[80:83], v[24:27], v[28:31]
  v_fma_f32 v122, v74, v18, v122
  v_fma_f32 v123, v75, v18, v123
  v_fma_f32 v124, v76, v18, v124
  v_fma_f32 v125, v77, v18, v125
  v_fma_f32 v126, v78, v18, v126
  ds_read_b64_tr_b16 v[80:81], v10 offset:16384
  ds_read_b64_tr_b16 v[82:83], v10 offset:16896
  s_waitcnt lgkmcnt(6)
  v_mfma_f32_32x32x16_bf16 v[96:111], v[148:151], v[84:87], v[96:111]
  s_add_u32 m0, s66, 49152
  s_add_u32 s58, s62, 393216
  buffer_load_dwordx4 v4, s[36:39], s58 offen lds
  v_fma_f32 v127, v79, v18, v127
  v_cvt_pk_bf16_f32 v36, v112, v113
  v_cvt_pk_bf16_f32 v37, v114, v115
  v_cvt_pk_bf16_f32 v38, v116, v117
  v_cvt_pk_bf16_f32 v39, v118, v119
  ds_read_b64_tr_b16 v[84:85], v11 offset:16384
  ds_read_b64_tr_b16 v[86:87], v11 offset:16896
  s_waitcnt lgkmcnt(6)
  v_mfma_f32_32x32x16_bf16 v[96:111], v[152:155], v[88:91], v[96:111]
  v_cvt_pk_bf16_f32 v40, v120, v121
  v_cvt_pk_bf16_f32 v41, v122, v123
  v_cvt_pk_bf16_f32 v42, v124, v125
  v_cvt_pk_bf16_f32 v43, v126, v127
  ds_read_b64_tr_b16 v[88:89], v12 offset:16384
  ds_read_b64_tr_b16 v[90:91], v12 offset:16896
  s_waitcnt lgkmcnt(6)
  v_mfma_f32_32x32x16_bf16 v[96:111], v[156:159], v[92:95], v[96:111]
  s_add_u32 m0, s66, 57344
  s_add_u32 s58, s62, 589824
  buffer_load_dwordx4 v4, s[36:39], s58 offen lds
  s_nop 1
  v_mfma_f32_32x32x16_bf16 v[112:127], v[6:9], v[36:39], 0
  v_mfma_f32_32x32x16_bf16 v[112:127], v[32:35], v[40:43], v[112:127]
  ds_read_b64_tr_b16 v[92:93], v13 offset:16384
  ds_read_b64_tr_b16 v[94:95], v13 offset:16896
  s_waitcnt lgkmcnt(6)
  v_mfma_f32_32x32x16_bf16 v[96:111], v[160:163], v[80:83], v[96:111]
  v_mfma_f32_16x16x32_bf16 v[28:31], v[80:83], v[24:27], v[28:31]
  ds_read_b64_tr_b16 v[80:81], v10 offset:24576
  ds_read_b64_tr_b16 v[82:83], v10 offset:25088
  s_waitcnt lgkmcnt(6)
  v_mfma_f32_32x32x16_bf16 v[96:111], v[164:167], v[84:87], v[96:111]
  s_add_u32 m0, s66, 65536
  s_add_u32 s58, s62, 786432
  buffer_load_dwordx4 v4, s[36:39], s58 offen lds
  ds_read_b64_tr_b16 v[84:85], v11 offset:24576
  ds_read_b64_tr_b16 v[86:87], v11 offset:25088
  s_waitcnt lgkmcnt(6)
  v_mfma_f32_32x32x16_bf16 v[96:111], v[168:171], v[88:91], v[96:111]
  v_max3_f32 v44, v112, v113, v114
  v_min3_f32 v45, v112, v113, v114
  v_max3_f32 v44, v44, v115, v116
  v_min3_f32 v45, v45, v115, v116
  v_max3_f32 v44, v44, v117, v118
  v_min3_f32 v45, v45, v117, v118
  ds_read_b64_tr_b16 v[88:89], v12 offset:24576
  ds_read_b64_tr_b16 v[90:91], v12 offset:25088
  s_waitcnt lgkmcnt(6)
  v_mfma_f32_32x32x16_bf16 v[96:111], v[172:175], v[92:95], v[96:111]
  s_add_u32 m0, s66, 73728
  s_add_u32 s58, s62, 983040
  buffer_load_dwordx4 v4, s[36:39], s58 offen lds
  v_max3_f32 v44, v44, v119, v120
  v_min3_f32 v45, v45, v119, v120
  v_max3_f32 v44, v44, v121, v122
  v_min3_f32 v45, v45, v121, v122
  v_max3_f32 v44, v44, v123, v124
  v_min3_f32 v45, v45, v123, v124
  ds_read_b64_tr_b16 v[92:93], v13 offset:24576
  ds_read_b64_tr_b16 v[94:95], v13 offset:25088
  s_waitcnt lgkmcnt(6)
  v_mfma_f32_32x32x16_bf16 v[96:111], v[176:179], v[80:83], v[96:111]
  v_mfma_f32_16x16x32_bf16 v[28:31], v[80:83], v[24:27], v[28:31]
  v_max3_f32 v44, v44, v125, v126
  v_min3_f32 v45, v45, v125, v126
  v_max_f32 v44, v44, v127
  v_min_f32 v45, v45, v127
  v_mul_f32 v44, v44, v0
  v_mul_f32 v45, v45, v0
  v_add_u32 v10, 0x10000, v10
  v_add_u32 v11, 0x10000, v11
  v_add_u32 v12, 0x10000, v12
  v_add_u32 v13, 0x10000, v13
  ds_read_b64_tr_b16 v[80:81], v10 offset:32768
  ds_read_b64_tr_b16 v[82:83], v10 offset:33280
  s_waitcnt lgkmcnt(6)
  v_mfma_f32_32x32x16_bf16 v[96:111], v[180:183], v[84:87], v[96:111]
  s_add_u32 m0, s66, 81920
  s_add_u32 s58, s62, 1179648
  buffer_load_dwordx4 v4, s[36:39], s58 offen lds
  v_fma_f32 v48, v112, v0, -v44
  v_fma_f32 v64, -v112, v0, v45
  v_fma_f32 v49, v113, v0, -v44
  v_fma_f32 v65, -v113, v0, v45
  v_fma_f32 v50, v114, v0, -v44
  v_fma_f32 v66, -v114, v0, v45
  ds_read_b64_tr_b16 v[84:85], v11 offset:32768
  ds_read_b64_tr_b16 v[86:87], v11 offset:33280
  s_waitcnt lgkmcnt(6)
  v_mfma_f32_32x32x16_bf16 v[96:111], v[184:187], v[88:91], v[96:111]
  v_fma_f32 v51, v115, v0, -v44
  v_fma_f32 v67, -v115, v0, v45
  v_fma_f32 v52, v116, v0, -v44
  v_fma_f32 v68, -v116, v0, v45
  v_fma_f32 v53, v117, v0, -v44
  v_fma_f32 v69, -v117, v0, v45
  ds_read_b64_tr_b16 v[88:89], v12 offset:32768
  ds_read_b64_tr_b16 v[90:91], v12 offset:33280
  s_waitcnt lgkmcnt(6)
  v_mfma_f32_32x32x16_bf16 v[96:111], v[188:191], v[92:95], v[96:111]
  s_add_u32 m0, s66, 90112
  s_add_u32 s58, s62, 1376256
  buffer_load_dwordx4 v4, s[36:39], s58 offen lds
  v_fma_f32 v54, v118, v0, -v44
  v_fma_f32 v70, -v118, v0, v45
  v_fma_f32 v55, v119, v0, -v44
  v_fma_f32 v71, -v119, v0, v45
  v_fma_f32 v56, v120, v0, -v44
  v_fma_f32 v72, -v120, v0, v45
  ds_read_b64_tr_b16 v[92:93], v13 offset:32768
  ds_read_b64_tr_b16 v[94:95], v13 offset:33280
  s_waitcnt lgkmcnt(6)
  v_mfma_f32_32x32x16_bf16 v[96:111], v[192:195], v[80:83], v[96:111]
  v_mfma_f32_16x16x32_bf16 v[28:31], v[80:83], v[24:27], v[28:31]
  v_fma_f32 v57, v121, v0, -v44
  v_fma_f32 v73, -v121, v0, v45
  v_fma_f32 v58, v122, v0, -v44
  v_fma_f32 v74, -v122, v0, v45
  v_fma_f32 v59, v123, v0, -v44
  v_fma_f32 v75, -v123, v0, v45
  ds_read_b64_tr_b16 v[80:81], v10 offset:40960
  ds_read_b64_tr_b16 v[82:83], v10 offset:41472
  s_waitcnt lgkmcnt(6)
  v_mfma_f32_32x32x16_bf16 v[96:111], v[196:199], v[84:87], v[96:111]
  v_fma_f32 v60, v124, v0, -v44
  v_fma_f32 v76, -v124, v0, v45
  v_fma_f32 v61, v125, v0, -v44
  v_fma_f32 v77, -v125, v0, v45
  v_fma_f32 v62, v126, v0, -v44
  v_fma_f32 v78, -v126, v0, v45
  ds_read_b64_tr_b16 v[84:85], v11 offset:40960
  ds_read_b64_tr_b16 v[86:87], v11 offset:41472
  s_waitcnt lgkmcnt(6)
  v_mfma_f32_32x32x16_bf16 v[96:111], v[200:203], v[88:91], v[96:111]
  v_fma_f32 v63, v127, v0, -v44
  v_fma_f32 v79, -v127, v0, v45
  v_exp_f32 v48, v48
  v_exp_f32 v49, v49
  ds_read_b64_tr_b16 v[88:89], v12 offset:40960
  ds_read_b64_tr_b16 v[90:91], v12 offset:41472
  s_waitcnt lgkmcnt(6)
  v_mfma_f32_32x32x16_bf16 v[96:111], v[204:207], v[92:95], v[96:111]
  v_exp_f32 v50, v50
  v_exp_f32 v51, v51
  v_exp_f32 v52, v52
  ds_read_b64_tr_b16 v[92:93], v13 offset:40960
  ds_read_b64_tr_b16 v[94:95], v13 offset:41472
  s_waitcnt lgkmcnt(6)
  v_mfma_f32_32x32x16_bf16 v[96:111], v[208:211], v[80:83], v[96:111]
  v_mfma_f32_16x16x32_bf16 v[28:31], v[80:83], v[24:27], v[28:31]
  v_exp_f32 v53, v53
  v_exp_f32 v54, v54
  v_exp_f32 v55, v55
  ds_read_b64_tr_b16 v[80:81], v10 offset:49152
  ds_read_b64_tr_b16 v[82:83], v10 offset:49664
  s_waitcnt lgkmcnt(6)
  v_mfma_f32_32x32x16_bf16 v[96:111], v[212:215], v[84:87], v[96:111]
  v_exp_f32 v56, v56
  v_exp_f32 v57, v57
  v_exp_f32 v58, v58
  ds_read_b64_tr_b16 v[84:85], v11 offset:49152
  ds_read_b64_tr_b16 v[86:87], v11 offset:49664
  s_waitcnt lgkmcnt(6)
  v_mfma_f32_32x32x16_bf16 v[96:111], v[216:219], v[88:91], v[96:111]
  v_exp_f32 v59, v59
  v_exp_f32 v60, v60
  v_exp_f32 v61, v61
  ds_read_b64_tr_b16 v[88:89], v12 offset:49152
  ds_read_b64_tr_b16 v[90:91], v12 offset:49664
  s_waitcnt lgkmcnt(6)
  v_mfma_f32_32x32x16_bf16 v[96:111], v[220:223], v[92:95], v[96:111]
  v_exp_f32 v62, v62
  v_exp_f32 v63, v63
  v_exp_f32 v64, v64
  ds_read_b64_tr_b16 v[92:93], v13 offset:49152
  ds_read_b64_tr_b16 v[94:95], v13 offset:49664
  s_waitcnt lgkmcnt(6)
  v_mfma_f32_32x32x16_bf16 v[96:111], v[224:227], v[80:83], v[96:111]
  v_mfma_f32_16x16x32_bf16 v[28:31], v[80:83], v[24:27], v[28:31]
  v_exp_f32 v65, v65
  v_exp_f32 v66, v66
  v_exp_f32 v67, v67
  ds_read_b64_tr_b16 v[80:81], v10 offset:57344
  ds_read_b64_tr_b16 v[82:83], v10 offset:57856
  s_waitcnt lgkmcnt(6)
  v_mfma_f32_32x32x16_bf16 v[96:111], v[228:231], v[84:87], v[96:111]
  v_exp_f32 v68, v68
  v_exp_f32 v69, v69
  v_exp_f32 v70, v70
  ds_read_b64_tr_b16 v[84:85], v11 offset:57344
  ds_read_b64_tr_b16 v[86:87], v11 offset:57856
  s_waitcnt lgkmcnt(6)
  v_mfma_f32_32x32x16_bf16 v[96:111], v[232:235], v[88:91], v[96:111]
  v_exp_f32 v71, v71
  v_exp_f32 v72, v72
  v_exp_f32 v73, v73
  ds_read_b64_tr_b16 v[88:89], v12 offset:57344
  ds_read_b64_tr_b16 v[90:91], v12 offset:57856
  s_waitcnt lgkmcnt(6)
  v_mfma_f32_32x32x16_bf16 v[96:111], v[236:239], v[92:95], v[96:111]
  v_exp_f32 v74, v74
  v_exp_f32 v75, v75
  v_exp_f32 v76, v76
  ds_read_b64_tr_b16 v[92:93], v13 offset:57344
  ds_read_b64_tr_b16 v[94:95], v13 offset:57856
  s_waitcnt lgkmcnt(6)
  v_mfma_f32_32x32x16_bf16 v[96:111], v[240:243], v[80:83], v[96:111]
  v_mfma_f32_16x16x32_bf16 v[28:31], v[80:83], v[24:27], v[28:31]
  v_exp_f32 v77, v77
  v_exp_f32 v78, v78
  v_exp_f32 v79, v79
  s_waitcnt lgkmcnt(4)
  v_mfma_f32_32x32x16_bf16 v[96:111], v[244:247], v[84:87], v[96:111]
  s_nop 3
  s_mov_b64 exec, s[74:75]
  ds_write_b32 v22, v28 offset:1024
  ds_write_b32 v22, v29 offset:1040
  ds_write_b32 v22, v30 offset:1056
  ds_write_b32 v22, v31 offset:1072
  s_mov_b64 exec, -1
  v_add_u32 v10, 0xffff8000, v10
  v_add_u32 v11, 0xffff8000, v11
  v_add_u32 v12, 0xffff8000, v12
  v_add_u32 v13, 0xffff8000, v13
  s_waitcnt vmcnt(0) lgkmcnt(0)
  s_barrier
  ds_read_b64_tr_b16 v[80:81], v10 offset:0
  ds_read_b64_tr_b16 v[82:83], v10 offset:512
  ds_read_b64_tr_b16 v[84:85], v11 offset:0
  ds_read_b64_tr_b16 v[86:87], v11 offset:512
  ds_read_b128 v[40:43], v3 offset:1024
  v_mfma_f32_32x32x16_bf16 v[96:111], v[248:251], v[88:91], v[96:111]
  ds_read_b64_tr_b16 v[88:89], v12 offset:0
  ds_read_b64_tr_b16 v[90:91], v12 offset:512
  v_mfma_f32_32x32x16_bf16 v[96:111], v[252:255], v[92:95], v[96:111]
  s_waitcnt lgkmcnt(2)
  v_add_f32 v40, v40, v41
  v_add_f32 v42, v42, v43
  v_add_f32 v44, v40, v42
  ds_write_b32 v14, v44
  v_mov_b32 v15, 0
  buffer_load_dword v16, v15, s[92:95], 0 offen sc1
  ds_read_b64_tr_b16 v[92:93], v13 offset:0
  ds_read_b64_tr_b16 v[94:95], v13 offset:512
  v_mfma_f32_32x32x16_bf16 v[112:127], v[80:83], v[128:131], 0
  v_mfma_f32_16x16x32_bf16 v[28:31], v[80:83], v[24:27], 0
  v_add_f32 v36, v48, v49
  v_add_f32 v37, v50, v51
  v_add_f32 v38, v64, v65
  v_add_f32 v39, v66, v67
  v_add_f32 v36, v36, v52
  ds_read_b64_tr_b16 v[80:81], v10 offset:8192
  ds_read_b64_tr_b16 v[82:83], v10 offset:8704
  v_mfma_f32_32x32x16_bf16 v[112:127], v[84:87], v[132:135], v[112:127]
  v_add_f32 v37, v37, v53
  v_add_f32 v38, v38, v68
  v_add_f32 v39, v39, v69
  v_add_f32 v36, v36, v54
  v_add_f32 v37, v37, v55
  ds_read_b64_tr_b16 v[84:85], v11 offset:8192
  ds_read_b64_tr_b16 v[86:87], v11 offset:8704
  s_waitcnt lgkmcnt(7)
  v_mfma_f32_32x32x16_bf16 v[112:127], v[88:91], v[136:139], v[112:127]
  v_add_f32 v38, v38, v70
  v_add_f32 v39, v39, v71
  v_add_f32 v36, v36, v56
  v_add_f32 v37, v37, v57
  v_add_f32 v38, v38, v72
  ds_read_b64_tr_b16 v[88:89], v12 offset:8192
  ds_read_b64_tr_b16 v[90:91], v12 offset:8704
  s_waitcnt lgkmcnt(6)
  v_mfma_f32_32x32x16_bf16 v[112:127], v[92:95], v[140:143], v[112:127]
  v_add_f32 v39, v39, v73
  v_add_f32 v36, v36, v58
  v_add_f32 v37, v37, v59
  v_add_f32 v38, v38, v74
  v_add_f32 v39, v39, v75
  ds_read_b64_tr_b16 v[92:93], v13 offset:8192
  ds_read_b64_tr_b16 v[94:95], v13 offset:8704
  s_waitcnt lgkmcnt(6)
  v_mfma_f32_32x32x16_bf16 v[112:127], v[80:83], v[144:147], v[112:127]
  v_mfma_f32_16x16x32_bf16 v[28:31], v[80:83], v[24:27], v[28:31]
  v_add_f32 v36, v36, v60
  v_add_f32 v37, v37, v61
  v_add_f32 v38, v38, v76
  v_add_f32 v39, v39, v77
  v_add_f32 v36, v36, v62
  ds_read_b64_tr_b16 v[80:81], v10 offset:16384
  ds_read_b64_tr_b16 v[82:83], v10 offset:16896
  s_waitcnt lgkmcnt(6)
  v_mfma_f32_32x32x16_bf16 v[112:127], v[84:87], v[148:151], v[112:127]
  v_add_f32 v37, v37, v63
  v_add_f32 v38, v38, v78
  v_add_f32 v39, v39, v79
  v_add_f32 v36, v36, v37
  v_add_f32 v38, v38, v39
  ds_read_b64_tr_b16 v[84:85], v11 offset:16384
  ds_read_b64_tr_b16 v[86:87], v11 offset:16896
  s_waitcnt lgkmcnt(6)
  v_mfma_f32_32x32x16_bf16 v[112:127], v[88:91], v[152:155], v[112:127]
  v_rcp_f32 v36, v36
  v_rcp_f32 v38, v38
  s_nop 0
  v_mul_f32 v48, v48, v36
  ds_read_b64_tr_b16 v[88:89], v12 offset:16384
  ds_read_b64_tr_b16 v[90:91], v12 offset:16896
  s_waitcnt lgkmcnt(6)
  v_mfma_f32_32x32x16_bf16 v[112:127], v[92:95], v[156:159], v[112:127]
  v_mul_f32 v49, v49, v36
  v_mul_f32 v50, v50, v36
  v_mul_f32 v51, v51, v36
  v_mul_f32 v52, v52, v36
  v_mul_f32 v53, v53, v36
  v_mul_f32 v54, v54, v36
  ds_read_b64_tr_b16 v[92:93], v13 offset:16384
  ds_read_b64_tr_b16 v[94:95], v13 offset:16896
  s_waitcnt lgkmcnt(6)
  v_mfma_f32_32x32x16_bf16 v[112:127], v[80:83], v[160:163], v[112:127]
  v_mfma_f32_16x16x32_bf16 v[28:31], v[80:83], v[24:27], v[28:31]
  v_mul_f32 v55, v55, v36
  v_mul_f32 v56, v56, v36
  v_mul_f32 v57, v57, v36
  v_mul_f32 v58, v58, v36
  v_mul_f32 v59, v59, v36
  ds_read_b64_tr_b16 v[80:81], v10 offset:24576
  ds_read_b64_tr_b16 v[82:83], v10 offset:25088
  s_waitcnt lgkmcnt(6)
  v_mfma_f32_32x32x16_bf16 v[112:127], v[84:87], v[164:167], v[112:127]
  v_mul_f32 v60, v60, v36
  v_mul_f32 v61, v61, v36
  v_mul_f32 v62, v62, v36
  v_mul_f32 v63, v63, v36
  v_mul_f32 v64, v64, v38
  v_mul_f32 v65, v65, v38
  ds_read_b64_tr_b16 v[84:85], v11 offset:24576
  ds_read_b64_tr_b16 v[86:87], v11 offset:25088
  s_waitcnt lgkmcnt(6)
  v_mfma_f32_32x32x16_bf16 v[112:127], v[88:91], v[168:171], v[112:127]
  v_mul_f32 v66, v66, v38
  v_mul_f32 v67, v67, v38
  v_mul_f32 v68, v68, v38
  v_mul_f32 v69, v69, v38
  v_mul_f32 v70, v70, v38
  ds_read_b64_tr_b16 v[88:89], v12 offset:24576
  ds_read_b64_tr_b16 v[90:91], v12 offset:25088
  s_waitcnt lgkmcnt(6)
  v_mfma_f32_32x32x16_bf16 v[112:127], v[92:95], v[172:175], v[112:127]
  v_mul_f32 v71, v71, v38
  v_mul_f32 v72, v72, v38
  v_mul_f32 v73, v73, v38
  v_mul_f32 v74, v74, v38
  v_mul_f32 v75, v75, v38
  v_mul_f32 v76, v76, v38
  ds_read_b64_tr_b16 v[92:93], v13 offset:24576
  ds_read_b64_tr_b16 v[94:95], v13 offset:25088
  s_waitcnt lgkmcnt(6)
  v_mfma_f32_32x32x16_bf16 v[112:127], v[80:83], v[176:179], v[112:127]
  v_mfma_f32_16x16x32_bf16 v[28:31], v[80:83], v[24:27], v[28:31]
  v_mul_f32 v77, v77, v38
  v_mul_f32 v78, v78, v38
  v_mul_f32 v79, v79, v38
  v_cvt_pk_bf16_f32 v48, v48, v49
  v_cvt_pk_bf16_f32 v49, v50, v51
  ds_read_b64_tr_b16 v[80:81], v10 offset:32768
  ds_read_b64_tr_b16 v[82:83], v10 offset:33280
  s_waitcnt lgkmcnt(6)
  v_mfma_f32_32x32x16_bf16 v[112:127], v[84:87], v[180:183], v[112:127]
  v_cvt_pk_bf16_f32 v50, v52, v53
  v_cvt_pk_bf16_f32 v51, v54, v55
  v_cvt_pk_bf16_f32 v52, v56, v57
  v_cvt_pk_bf16_f32 v53, v58, v59
  v_cvt_pk_bf16_f32 v54, v60, v61
  v_cvt_pk_bf16_f32 v55, v62, v63
  ds_read_b64_tr_b16 v[84:85], v11 offset:32768
  ds_read_b64_tr_b16 v[86:87], v11 offset:33280
  s_waitcnt lgkmcnt(6)
  v_mfma_f32_32x32x16_bf16 v[112:127], v[88:91], v[184:187], v[112:127]
  v_cvt_pk_bf16_f32 v56, v64, v65
  v_cvt_pk_bf16_f32 v57, v66, v67
  v_cvt_pk_bf16_f32 v58, v68, v69
  v_cvt_pk_bf16_f32 v59, v70, v71
  v_cvt_pk_bf16_f32 v60, v72, v73
  ds_read_b64_tr_b16 v[88:89], v12 offset:32768
  ds_read_b64_tr_b16 v[90:91], v12 offset:33280
  s_waitcnt lgkmcnt(6)
  v_mfma_f32_32x32x16_bf16 v[112:127], v[92:95], v[188:191], v[112:127]
  v_cvt_pk_bf16_f32 v61, v74, v75
  v_cvt_pk_bf16_f32 v62, v76, v77
  v_cvt_pk_bf16_f32 v63, v78, v79
  ds_read_b32 v44, v14
  v_lshrrev_b32 v45, 5, v1
  v_lshlrev_b32 v45, 4, v45
  ds_read_b64_tr_b16 v[92:93], v13 offset:32768
  ds_read_b64_tr_b16 v[94:95], v13 offset:33280
  s_waitcnt lgkmcnt(7)
  v_mfma_f32_32x32x16_bf16 v[112:127], v[80:83], v[192:195], v[112:127]
  v_mfma_f32_16x16x32_bf16 v[28:31], v[80:83], v[24:27], v[28:31]
  s_lshl_b32 s56, s4, 7
  s_add_u32 s56, s56, 138240
  v_add_u32 v46, s56, v45
  ds_read_b128 v[64:67], v46 offset:0
  ds_read_b128 v[68:71], v46 offset:512
  ds_read_b64_tr_b16 v[80:81], v10 offset:40960
  ds_read_b64_tr_b16 v[82:83], v10 offset:41472
  s_waitcnt lgkmcnt(9)
  v_mfma_f32_32x32x16_bf16 v[112:127], v[84:87], v[196:199], v[112:127]
  ds_read_b128 v[72:75], v46 offset:32
  ds_read_b128 v[76:79], v46 offset:544
  ds_read_b64_tr_b16 v[84:85], v11 offset:40960
  ds_read_b64_tr_b16 v[86:87], v11 offset:41472
  s_waitcnt lgkmcnt(11)
  v_mfma_f32_32x32x16_bf16 v[112:127], v[88:91], v[200:203], v[112:127]
  ds_read_b64_tr_b16 v[88:89], v12 offset:40960
  ds_read_b64_tr_b16 v[90:91], v12 offset:41472
  s_waitcnt lgkmcnt(10)
  v_mfma_f32_32x32x16_bf16 v[112:127], v[92:95], v[204:207], v[112:127]
  s_waitcnt lgkmcnt(8)
  v_mul_f32 v68, v68, v44
  v_mul_f32 v69, v69, v44
  v_mul_f32 v70, v70, v44
  v_mul_f32 v71, v71, v44
  v_fma_f32 v68, v96, v64, v68
  v_fma_f32 v69, v97, v65, v69
  ds_read_b64_tr_b16 v[92:93], v13 offset:40960
  ds_read_b64_tr_b16 v[94:95], v13 offset:41472
  s_waitcnt lgkmcnt(8)
  v_mfma_f32_32x32x16_bf16 v[112:127], v[80:83], v[208:211], v[112:127]
  v_mfma_f32_16x16x32_bf16 v[28:31], v[80:83], v[24:27], v[28:31]
  v_fma_f32 v70, v98, v66, v70
  v_fma_f32 v71, v99, v67, v71
  v_cvt_pk_bf16_f32 v36, v68, v69
  v_cvt_pk_bf16_f32 v37, v70, v71
  ds_read_b128 v[64:67], v46 offset:64
  ds_read_b128 v[68:71], v46 offset:576
  ds_read_b64_tr_b16 v[80:81], v10 offset:49152
  ds_read_b64_tr_b16 v[82:83], v10 offset:49664
  s_waitcnt lgkmcnt(8)
  v_mfma_f32_32x32x16_bf16 v[112:127], v[84:87], v[212:215], v[112:127]
  v_mul_f32 v76, v76, v44
  v_mul_f32 v77, v77, v44
  v_mul_f32 v78, v78, v44
  v_mul_f32 v79, v79, v44
  v_fma_f32 v76, v100, v72, v76
  v_fma_f32 v77, v101, v73, v77
  v_fma_f32 v78, v102, v74, v78
  ds_read_b64_tr_b16 v[84:85], v11 offset:49152
  ds_read_b64_tr_b16 v[86:87], v11 offset:49664
  s_waitcnt lgkmcnt(8)
  v_mfma_f32_32x32x16_bf16 v[112:127], v[88:91], v[216:219], v[112:127]
  v_fma_f32 v79, v103, v75, v79
  v_cvt_pk_bf16_f32 v38, v76, v77
  v_cvt_pk_bf16_f32 v39, v78, v79
  ds_read_b128 v[72:75], v46 offset:96
  ds_read_b128 v[76:79], v46 offset:608
  s_waitcnt lgkmcnt(6)
  v_mul_f32 v68, v68, v44
  ds_read_b64_tr_b16 v[88:89], v12 offset:49152
  ds_read_b64_tr_b16 v[90:91], v12 offset:49664
  v_mfma_f32_32x32x16_bf16 v[112:127], v[92:95], v[220:223], v[112:127]
  v_mul_f32 v69, v69, v44
  v_mul_f32 v70, v70, v44
  v_mul_f32 v71, v71, v44
  v_fma_f32 v68, v104, v64, v68
  v_fma_f32 v69, v105, v65, v69
  v_fma_f32 v70, v106, v66, v70
  v_fma_f32 v71, v107, v67, v71
  ds_read_b64_tr_b16 v[92:93], v13 offset:49152
  ds_read_b64_tr_b16 v[94:95], v13 offset:49664
  s_waitcnt lgkmcnt(8)
  v_mfma_f32_32x32x16_bf16 v[112:127], v[80:83], v[224:227], v[112:127]
  v_mfma_f32_16x16x32_bf16 v[28:31], v[80:83], v[24:27], v[28:31]
  v_cvt_pk_bf16_f32 v40, v68, v69
  v_cvt_pk_bf16_f32 v41, v70, v71
  s_waitcnt lgkmcnt(4)
  v_mul_f32 v76, v76, v44
  v_mul_f32 v77, v77, v44
  v_mul_f32 v78, v78, v44
  v_mul_f32 v79, v79, v44
  ds_read_b64_tr_b16 v[80:81], v10 offset:57344
  ds_read_b64_tr_b16 v[82:83], v10 offset:57856
  v_mfma_f32_32x32x16_bf16 v[112:127], v[84:87], v[228:231], v[112:127]
  v_fma_f32 v76, v108, v72, v76
  v_fma_f32 v77, v109, v73, v77
  v_fma_f32 v78, v110, v74, v78
  v_fma_f32 v79, v111, v75, v79
  v_cvt_pk_bf16_f32 v42, v76, v77
  v_cvt_pk_bf16_f32 v43, v78, v79
  ds_read_b64_tr_b16 v[84:85], v11 offset:57344
  ds_read_b64_tr_b16 v[86:87], v11 offset:57856
  s_waitcnt lgkmcnt(6)
  v_mfma_f32_32x32x16_bf16 v[112:127], v[88:91], v[232:235], v[112:127]
  s_lshl_b32 s56, s3, 11
  s_add_u32 s56, s56, 139264
  v_add_u32 v45, s56, v23
  ds_write_b128 v45, v[36:39]
  ds_write_b128 v45, v[40:43] offset:1024
  v_and_b32 v45, 31, v1
  v_lshlrev_b32 v44, 6, v45
  ds_read_b64_tr_b16 v[88:89], v12 offset:57344
  ds_read_b64_tr_b16 v[90:91], v12 offset:57856
  s_waitcnt lgkmcnt(8)
  v_mfma_f32_32x32x16_bf16 v[112:127], v[92:95], v[236:239], v[112:127]
  v_lshrrev_b32 v45, 5, v1
  v_lshl_add_u32 v44, v45, 11, v44
  s_lshl_b32 s56, s3, 12
  s_add_u32 s56, s56, 0
  v_add_u32 v44, s56, v44
  ds_write_b128 v44, v[48:51] offset:0
  ds_read_b64_tr_b16 v[92:93], v13 offset:57344
  ds_read_b64_tr_b16 v[94:95], v13 offset:57856
  s_waitcnt lgkmcnt(9)
  v_mfma_f32_32x32x16_bf16 v[112:127], v[80:83], v[240:243], v[112:127]
  v_mfma_f32_16x16x32_bf16 v[28:31], v[80:83], v[24:27], v[28:31]
  ds_write_b128 v44, v[52:55] offset:16
  ds_write_b128 v44, v[56:59] offset:32
  ds_write_b128 v44, v[60:63] offset:48
  s_waitcnt lgkmcnt(10)
  v_mfma_f32_32x32x16_bf16 v[112:127], v[84:87], v[244:247], v[112:127]
  s_nop 3
  s_mov_b64 exec, s[74:75]
  ds_write_b32 v22, v28 offset:2048
  ds_write_b32 v22, v29 offset:2064
  ds_write_b32 v22, v30 offset:2080
  ds_write_b32 v22, v31 offset:2096
  s_mov_b64 exec, -1
  s_waitcnt lgkmcnt(0)
  s_barrier
  ds_read_b128 v[40:43], v3 offset:2048
  v_mfma_f32_32x32x16_bf16 v[112:127], v[88:91], v[248:251], v[112:127]
  v_mfma_f32_32x32x16_bf16 v[112:127], v[92:95], v[252:255], v[112:127]
  s_waitcnt lgkmcnt(0)
  v_add_f32 v40, v40, v41
  v_add_f32 v42, v42, v43
  v_add_f32 v44, v40, v42
  ds_write_b32 v14, v44
  s_waitcnt vmcnt(0)
  v_readfirstlane_b32 s72, v16
  s_cmp_lg_u32 s72, 0
  s_cbranch_scc1 nr_8
  v_mov_b32 v36, 0
nn_9:
  buffer_load_dword v37, v36, s[92:95], 0 offen sc1
  s_waitcnt vmcnt(0)
  v_readfirstlane_b32 s72, v37
  s_cmp_lg_u32 s72, 0
  s_cbranch_scc1 nn_9_ok
  s_sleep 4
  s_branch nn_9
nn_9_ok:
nr_8:
  v_mov_b32 v36, 0
  v_mov_b32 v37, s72
  s_cmp_ge_u32 s4, 2
  s_cbranch_scc1 kvx_10
  v_lshrrev_b32 v45, 5, v1
  v_bfe_u32 v46, v1, 2, 2
  v_lshl_add_u32 v46, v45, 2, v46
  v_lshlrev_b32 v46, 6, v46
  v_bfe_u32 v47, v1, 4, 1
  v_lshl_add_u32 v46, v47, 5, v46
  v_and_b32 v44, 3, v1
  v_lshl_add_u32 v46, v44, 3, v46
  s_lshl_b32 s56, s4, 11
  s_lshl_b32 s57, s5, 14
  s_add_u32 s56, s56, s57
  s_add_u32 s56, s56, 0
  v_add_u32 v44, s56, v46
  v_cmp_eq_u32 vcc, s4, v47
  v_and_b32 v42, 15, v1
  v_lshlrev_b32 v41, 4, v45
  v_lshl_add_u32 v43, v45, 4, v42
  v_lshlrev_b32 v43, 4, v43
  s_lshl_b32 s56, s5, 13
  s_add_u32 s56, s56, 139264
  v_cndmask_b32 v46, 0, -1, vcc
  v_add_u32 v45, s56, v23
  v_mov_b32 v47, 0x3f803f80
  s_cmp_eq_u32 s4, 0
  s_mov_b32 s70, 0x0000ffff
  s_mov_b32 s71, 0x00010000
  s_cselect_b32 s82, s70, 0xffff0000
  s_cselect_b32 s70, s71, 1
  s_mov_b32 s83, s82
  s_mov_b32 s71, s70
  s_lshl_b32 s57, s68, 2
  s_add_u32 s57, s57, s4
  s_lshl_b32 s58, s5, 1
  s_add_u32 s57, s57, s58
  s_lshl_b32 s57, s57, 4
  s_add_u32 s57, s57, s6
  s_lshl_b32 s58, s57, 7
  s_add_u32 s58, s58, 23068672
  s_lshl_b32 s57, s57, 11
  s_add_u32 s57, s57, 20971520
  s_waitcnt lgkmcnt(0)
  ds_read_b64_tr_b16 v[48:49], v44 offset:0
  ds_read_b64_tr_b16 v[50:51], v44 offset:512
  ds_read_b128 v[52:55], v45 offset:0
  ds_read_b64_tr_b16 v[56:57], v44 offset:1024
  ds_read_b64_tr_b16 v[58:59], v44 offset:1536
  ds_read_b128 v[60:63], v45 offset:1024
  s_waitcnt lgkmcnt(3)
  v_bfi_b32 v52, v46, v52, v47
  v_bfi_b32 v53, v46, v53, v47
  v_bfi_b32 v54, v46, v54, v47
  v_bfi_b32 v55, v46, v55, v47
  s_nop 1
  v_mfma_f32_32x32x16_bf16 v[64:79], v[48:51], v[52:55], 0
  ds_read_b64_tr_b16 v[48:49], v44 offset:4096
  ds_read_b64_tr_b16 v[50:51], v44 offset:4608
  ds_read_b128 v[52:55], v45 offset:2048
  s_waitcnt lgkmcnt(3)
  v_bfi_b32 v60, v46, v60, v47
  v_bfi_b32 v61, v46, v61, v47
  v_bfi_b32 v62, v46, v62, v47
  v_bfi_b32 v63, v46, v63, v47
  s_nop 1
  v_mfma_f32_32x32x16_bf16 v[64:79], v[56:59], v[60:63], v[64:79]
  ds_read_b64_tr_b16 v[56:57], v44 offset:5120
  ds_read_b64_tr_b16 v[58:59], v44 offset:5632
  ds_read_b128 v[60:63], v45 offset:3072
  s_waitcnt lgkmcnt(3)
  v_bfi_b32 v52, v46, v52, v47
  v_bfi_b32 v53, v46, v53, v47
  v_bfi_b32 v54, v46, v54, v47
  v_bfi_b32 v55, v46, v55, v47
  s_nop 1
  v_mfma_f32_32x32x16_bf16 v[64:79], v[48:51], v[52:55], v[64:79]
  ds_read_b64_tr_b16 v[48:49], v44 offset:8192
  ds_read_b64_tr_b16 v[50:51], v44 offset:8704
  ds_read_b128 v[52:55], v45 offset:4096
  s_waitcnt lgkmcnt(3)
  v_bfi_b32 v60, v46, v60, v47
  v_bfi_b32 v61, v46, v61, v47
  v_bfi_b32 v62, v46, v62, v47
  v_bfi_b32 v63, v46, v63, v47
  s_nop 1
  v_mfma_f32_32x32x16_bf16 v[64:79], v[56:59], v[60:63], v[64:79]
  ds_read_b64_tr_b16 v[56:57], v44 offset:9216
  ds_read_b64_tr_b16 v[58:59], v44 offset:9728
  ds_read_b128 v[60:63], v45 offset:5120
  s_waitcnt lgkmcnt(3)
  v_bfi_b32 v52, v46, v52, v47
  v_bfi_b32 v53, v46, v53, v47
  v_bfi_b32 v54, v46, v54, v47
  v_bfi_b32 v55, v46, v55, v47
  s_nop 1
  v_mfma_f32_32x32x16_bf16 v[64:79], v[48:51], v[52:55], v[64:79]
  ds_read_b64_tr_b16 v[48:49], v44 offset:12288
  ds_read_b64_tr_b16 v[50:51], v44 offset:12800
  ds_read_b128 v[52:55], v45 offset:6144
  s_waitcnt lgkmcnt(3)
  v_bfi_b32 v60, v46, v60, v47
  v_bfi_b32 v61, v46, v61, v47
  v_bfi_b32 v62, v46, v62, v47
  v_bfi_b32 v63, v46, v63, v47
  s_nop 1
  v_mfma_f32_32x32x16_bf16 v[64:79], v[56:59], v[60:63], v[64:79]
  ds_read_b64_tr_b16 v[56:57], v44 offset:13312
  ds_read_b64_tr_b16 v[58:59], v44 offset:13824
  ds_read_b128 v[60:63], v45 offset:7168
  s_waitcnt lgkmcnt(3)
  v_bfi_b32 v52, v46, v52, v47
  v_bfi_b32 v53, v46, v53, v47
  v_bfi_b32 v54, v46, v54, v47
  v_bfi_b32 v55, v46, v55, v47
  s_nop 1
  v_mfma_f32_32x32x16_bf16 v[64:79], v[48:51], v[52:55], v[64:79]
  s_waitcnt lgkmcnt(0)
  v_bfi_b32 v60, v46, v60, v47
  v_bfi_b32 v61, v46, v61, v47
  v_bfi_b32 v62, v46, v62, v47
  v_bfi_b32 v63, v46, v63, v47
  s_nop 1
  v_mfma_f32_32x32x16_bf16 v[64:79], v[56:59], v[60:63], v[64:79]
  s_nop 7
  s_nop 7
  s_mov_b64 exec, s[82:83]
  buffer_store_dwordx4 v[64:67], v43, s[48:51], s57 offen offset:0 sc1
  buffer_store_dwordx4 v[68:71], v43, s[48:51], s57 offen offset:512 sc1
  buffer_store_dwordx4 v[72:75], v43, s[48:51], s57 offen offset:1024 sc1
  buffer_store_dwordx4 v[76:79], v43, s[48:51], s57 offen offset:1536 sc1
  s_mov_b64 exec, s[70:71]
  buffer_store_dwordx4 v[64:67], v41, s[48:51], s58 offen offset:0 sc1
  buffer_store_dwordx4 v[68:71], v41, s[48:51], s58 offen offset:32 sc1
  buffer_store_dwordx4 v[72:75], v41, s[48:51], s58 offen offset:64 sc1
  buffer_store_dwordx4 v[76:79], v41, s[48:51], s58 offen offset:96 sc1
  s_mov_b64 exec, -1
  s_waitcnt vmcnt(0)
  s_lshl_b32 s56, s68, 4
  s_add_u32 s56, s56, s6
  s_lshl_b32 s56, s56, 2
  s_lshl_b32 s57, s5, 1
  s_add_u32 s56, s56, s57
  s_add_u32 s56, s56, s4
  s_lshl_b32 s56, s56, 7
  s_add_u32 s56, s56, 24117248
  v_mov_b32 v36, 0
  v_mov_b32 v37, s72
  s_mov_b64 exec, 1
  buffer_store_dword v37, v36, s[48:51], s56 offen sc1
  s_mov_b64 exec, -1
kvx_10:
  s_waitcnt lgkmcnt(0)
  ds_read_b128 v[64:67], v21 offset:0
  ds_read_b128 v[68:71], v21 offset:32
  ds_read_b128 v[72:75], v21 offset:64
  ds_read_b128 v[76:79], v21 offset:96
  s_waitcnt lgkmcnt(3)
  s_nop 3
  v_fma_f32 v112, v64, v18, v112
  v_fma_f32 v113, v65, v18, v113
  v_fma_f32 v114, v66, v18, v114
  v_fma_f32 v115, v67, v18, v115
  s_waitcnt lgkmcnt(2)
  v_fma_f32 v116, v68, v18, v116
  v_fma_f32 v117, v69, v18, v117
  v_fma_f32 v118, v70, v18, v118
  v_fma_f32 v119, v71, v18, v119
  s_waitcnt lgkmcnt(1)
  v_fma_f32 v120, v72, v18, v120
  v_fma_f32 v121, v73, v18, v121
  v_fma_f32 v122, v74, v18, v122
  v_fma_f32 v123, v75, v18, v123
  s_waitcnt lgkmcnt(0)
  v_fma_f32 v124, v76, v18, v124
  v_fma_f32 v125, v77, v18, v125
  v_fma_f32 v126, v78, v18, v126
  v_fma_f32 v127, v79, v18, v127
  v_cvt_pk_bf16_f32 v36, v112, v113
  v_cvt_pk_bf16_f32 v37, v114, v115
  v_cvt_pk_bf16_f32 v38, v116, v117
  v_cvt_pk_bf16_f32 v39, v118, v119
  v_cvt_pk_bf16_f32 v40, v120, v121
  v_cvt_pk_bf16_f32 v41, v122, v123
  v_cvt_pk_bf16_f32 v42, v124, v125
  v_cvt_pk_bf16_f32 v43, v126, v127
  s_nop 1
  v_mfma_f32_32x32x16_bf16 v[112:127], v[6:9], v[36:39], 0
  v_mfma_f32_32x32x16_bf16 v[112:127], v[32:35], v[40:43], v[112:127]
  s_nop 7
  s_nop 5
  v_max3_f32 v44, v112, v113, v114
  v_min3_f32 v45, v112, v113, v114
  v_max3_f32 v44, v44, v115, v116
  v_min3_f32 v45, v45, v115, v116
  v_max3_f32 v44, v44, v117, v118
  v_min3_f32 v45, v45, v117, v118
  v_max3_f32 v44, v44, v119, v120
  v_min3_f32 v45, v45, v119, v120
  v_max3_f32 v44, v44, v121, v122
  v_min3_f32 v45, v45, v121, v122
  v_max3_f32 v44, v44, v123, v124
  v_min3_f32 v45, v45, v123, v124
  v_max3_f32 v44, v44, v125, v126
  v_min3_f32 v45, v45, v125, v126
  v_max_f32 v44, v44, v127
  v_min_f32 v45, v45, v127
  v_mul_f32 v44, v44, v0
  v_mul_f32 v45, v45, v0
  v_fma_f32 v48, v112, v0, -v44
  v_fma_f32 v64, -v112, v0, v45
  v_fma_f32 v49, v113, v0, -v44
  v_fma_f32 v65, -v113, v0, v45
  v_fma_f32 v50, v114, v0, -v44
  v_fma_f32 v66, -v114, v0, v45
  v_fma_f32 v51, v115, v0, -v44
  v_fma_f32 v67, -v115, v0, v45
  v_fma_f32 v52, v116, v0, -v44
  v_fma_f32 v68, -v116, v0, v45
  v_fma_f32 v53, v117, v0, -v44
  v_fma_f32 v69, -v117, v0, v45
  v_fma_f32 v54, v118, v0, -v44
  v_fma_f32 v70, -v118, v0, v45
  v_fma_f32 v55, v119, v0, -v44
  v_fma_f32 v71, -v119, v0, v45
  v_fma_f32 v56, v120, v0, -v44
  v_fma_f32 v72, -v120, v0, v45
  v_fma_f32 v57, v121, v0, -v44
  v_fma_f32 v73, -v121, v0, v45
  v_fma_f32 v58, v122, v0, -v44
  v_fma_f32 v74, -v122, v0, v45
  v_fma_f32 v59, v123, v0, -v44
  v_fma_f32 v75, -v123, v0, v45
  v_fma_f32 v60, v124, v0, -v44
  v_fma_f32 v76, -v124, v0, v45
  v_fma_f32 v61, v125, v0, -v44
  v_fma_f32 v77, -v125, v0, v45
  v_fma_f32 v62, v126, v0, -v44
  v_fma_f32 v78, -v126, v0, v45
  v_fma_f32 v63, v127, v0, -v44
  v_fma_f32 v79, -v127, v0, v45
  v_exp_f32 v48, v48
  v_exp_f32 v49, v49
  v_exp_f32 v50, v50
  v_exp_f32 v51, v51
  v_exp_f32 v52, v52
  v_exp_f32 v53, v53
  v_exp_f32 v54, v54
  v_exp_f32 v55, v55
  v_exp_f32 v56, v56
  v_exp_f32 v57, v57
  v_exp_f32 v58, v58
  v_exp_f32 v59, v59
  v_exp_f32 v60, v60
  v_exp_f32 v61, v61
  v_exp_f32 v62, v62
  v_exp_f32 v63, v63
  v_exp_f32 v64, v64
  v_exp_f32 v65, v65
  v_exp_f32 v66, v66
  v_exp_f32 v67, v67
  v_exp_f32 v68, v68
  v_exp_f32 v69, v69
  v_exp_f32 v70, v70
  v_exp_f32 v71, v71
  v_exp_f32 v72, v72
  v_exp_f32 v73, v73
  v_exp_f32 v74, v74
  v_exp_f32 v75, v75
  v_exp_f32 v76, v76
  v_exp_f32 v77, v77
  v_exp_f32 v78, v78
  v_exp_f32 v79, v79
  v_add_f32 v36, v48, v49
  v_add_f32 v37, v50, v51
  v_add_f32 v38, v64, v65
  v_add_f32 v39, v66, v67
  v_add_f32 v36, v36, v52
  v_add_f32 v37, v37, v53
  v_add_f32 v38, v38, v68
  v_add_f32 v39, v39, v69
  v_add_f32 v36, v36, v54
  v_add_f32 v37, v37, v55
  v_add_f32 v38, v38, v70
  v_add_f32 v39, v39, v71
  v_add_f32 v36, v36, v56
  v_add_f32 v37, v37, v57
  v_add_f32 v38, v38, v72
  v_add_f32 v39, v39, v73
  v_add_f32 v36, v36, v58
  v_add_f32 v37, v37, v59
  v_add_f32 v38, v38, v74
  v_add_f32 v39, v39, v75
  v_add_f32 v36, v36, v60
  v_add_f32 v37, v37, v61
  v_add_f32 v38, v38, v76
  v_add_f32 v39, v39, v77
  v_add_f32 v36, v36, v62
  v_add_f32 v37, v37, v63
  v_add_f32 v38, v38, v78
  v_add_f32 v39, v39, v79
  v_add_f32 v36, v36, v37
  v_add_f32 v38, v38, v39
  v_rcp_f32 v36, v36
  v_rcp_f32 v38, v38
  s_nop 0
  v_mul_f32 v48, v48, v36
  v_mul_f32 v49, v49, v36
  v_mul_f32 v50, v50, v36
  v_mul_f32 v51, v51, v36
  v_mul_f32 v52, v52, v36
  v_mul_f32 v53, v53, v36
  v_mul_f32 v54, v54, v36
  v_mul_f32 v55, v55, v36
  v_mul_f32 v56, v56, v36
  v_mul_f32 v57, v57, v36
  v_mul_f32 v58, v58, v36
  v_mul_f32 v59, v59, v36
  v_mul_f32 v60, v60, v36
  v_mul_f32 v61, v61, v36
  v_mul_f32 v62, v62, v36
  v_mul_f32 v63, v63, v36
  v_mul_f32 v64, v64, v38
  v_mul_f32 v65, v65, v38
  v_mul_f32 v66, v66, v38
  v_mul_f32 v67, v67, v38
  v_mul_f32 v68, v68, v38
  v_mul_f32 v69, v69, v38
  v_mul_f32 v70, v70, v38
  v_mul_f32 v71, v71, v38
  v_mul_f32 v72, v72, v38
  v_mul_f32 v73, v73, v38
  v_mul_f32 v74, v74, v38
  v_mul_f32 v75, v75, v38
  v_mul_f32 v76, v76, v38
  v_mul_f32 v77, v77, v38
  v_mul_f32 v78, v78, v38
  v_mul_f32 v79, v79, v38
  v_cvt_pk_bf16_f32 v48, v48, v49
  v_cvt_pk_bf16_f32 v49, v50, v51
  v_cvt_pk_bf16_f32 v50, v52, v53
  v_cvt_pk_bf16_f32 v51, v54, v55
  v_cvt_pk_bf16_f32 v52, v56, v57
  v_cvt_pk_bf16_f32 v53, v58, v59
  v_cvt_pk_bf16_f32 v54, v60, v61
  v_cvt_pk_bf16_f32 v55, v62, v63
  v_cvt_pk_bf16_f32 v56, v64, v65
  v_cvt_pk_bf16_f32 v57, v66, v67
  v_cvt_pk_bf16_f32 v58, v68, v69
  v_cvt_pk_bf16_f32 v59, v70, v71
  v_cvt_pk_bf16_f32 v60, v72, v73
  v_cvt_pk_bf16_f32 v61, v74, v75
  v_cvt_pk_bf16_f32 v62, v76, v77
  v_cvt_pk_bf16_f32 v63, v78, v79
  s_cmp_lg_u32 s3, 7
  s_cbranch_scc1 p2_11_np
  s_lshl_b32 s56, s68, 13
  s_add_u32 s56, s56, 24117248
  v_lshlrev_b32 v36, 7, v1
p2_11_poll:
  buffer_load_dword v37, v36, s[48:51], s56 offen sc1
  s_waitcnt vmcnt(0)
  v_cmp_ne_u32 vcc, s72, v37
  s_nop 1
  s_cbranch_vccz p2_11_np
  s_sleep 4
  s_branch p2_11_poll
p2_11_np:
  s_barrier
  s_lshl_b32 s56, s68, 2
  s_lshr_b32 s57, s3, 1
  s_add_u32 s56, s56, s57
  s_and_b32 s57, s3, 1
  s_lshl_b32 s57, s57, 10
  s_lshl_b32 s58, s56, 11
  s_add_u32 s58, s58, s57
  s_add_u32 s58, s58, 23068672
  s_lshl_b32 s56, s56, 15
  s_add_u32 s56, s56, s57
  s_add_u32 s56, s56, 20971520
  buffer_load_dwordx4 v[192:195], v23, s[48:51], s58 offen sc1
  buffer_load_dwordx4 v[128:131], v23, s[48:51], s56 offen sc1
  s_add_u32 s56, s56, 2048
  buffer_load_dwordx4 v[132:135], v23, s[48:51], s56 offen sc1
  s_add_u32 s56, s56, 2048
  buffer_load_dwordx4 v[136:139], v23, s[48:51], s56 offen sc1
  s_add_u32 s56, s56, 2048
  buffer_load_dwordx4 v[140:143], v23, s[48:51], s56 offen sc1
  s_add_u32 s56, s56, 2048
  buffer_load_dwordx4 v[144:147], v23, s[48:51], s56 offen sc1
  s_add_u32 s56, s56, 2048
  buffer_load_dwordx4 v[148:151], v23, s[48:51], s56 offen sc1
  s_add_u32 s56, s56, 2048
  buffer_load_dwordx4 v[152:155], v23, s[48:51], s56 offen sc1
  s_add_u32 s56, s56, 2048
  buffer_load_dwordx4 v[156:159], v23, s[48:51], s56 offen sc1
  s_add_u32 s56, s56, 2048
  buffer_load_dwordx4 v[160:163], v23, s[48:51], s56 offen sc1
  s_add_u32 s56, s56, 2048
  buffer_load_dwordx4 v[164:167], v23, s[48:51], s56 offen sc1
  s_add_u32 s56, s56, 2048
  buffer_load_dwordx4 v[168:171], v23, s[48:51], s56 offen sc1
  s_add_u32 s56, s56, 2048
  buffer_load_dwordx4 v[172:175], v23, s[48:51], s56 offen sc1
  s_add_u32 s56, s56, 2048
  buffer_load_dwordx4 v[176:179], v23, s[48:51], s56 offen sc1
  s_add_u32 s56, s56, 2048
  buffer_load_dwordx4 v[180:183], v23, s[48:51], s56 offen sc1
  s_add_u32 s56, s56, 2048
  buffer_load_dwordx4 v[184:187], v23, s[48:51], s56 offen sc1
  s_add_u32 s56, s56, 2048
  buffer_load_dwordx4 v[188:191], v23, s[48:51], s56 offen sc1
  s_waitcnt vmcnt(16)
  v_add_f32_dpp v192, v192, v192 row_ror:8 row_mask:0xf bank_mask:0xf
  v_add_f32_dpp v193, v193, v193 row_ror:8 row_mask:0xf bank_mask:0xf
  v_add_f32_dpp v194, v194, v194 row_ror:8 row_mask:0xf bank_mask:0xf
  v_add_f32_dpp v195, v195, v195 row_ror:8 row_mask:0xf bank_mask:0xf
  v_mov_b32 v196, v192
  v_mov_b32 v197, v193
  v_mov_b32 v198, v194
  v_mov_b32 v199, v195
  s_nop 1
  v_permlane16_swap_b32 v192, v196
  v_permlane16_swap_b32 v193, v197
  v_permlane16_swap_b32 v194, v198
  v_permlane16_swap_b32 v195, v199
  v_add_f32 v192, v192, v196
  v_add_f32 v193, v193, v197
  v_add_f32 v194, v194, v198
  v_add_f32 v195, v195, v199
  v_mov_b32 v196, v192
  v_mov_b32 v197, v193
  v_mov_b32 v198, v194
  v_mov_b32 v199, v195
  s_nop 1
  v_permlane32_swap_b32 v192, v196
  v_permlane32_swap_b32 v193, v197
  v_permlane32_swap_b32 v194, v198
  v_permlane32_swap_b32 v195, v199
  v_add_f32 v192, v192, v196
  v_add_f32 v193, v193, v197
  v_add_f32 v194, v194, v198
  v_add_f32 v195, v195, v199
  s_lshl_b32 s57, s3, 7
  s_add_u32 s57, s57, 155648
  v_add_u32 v36, s57, v23
  s_mov_b64 exec, 0xff
  ds_write_b128 v36, v[192:195]
  s_mov_b64 exec, -1
  s_waitcnt vmcnt(14)
  v_add_f32 v128, v128, v132
  v_add_f32 v129, v129, v133
  v_add_f32 v130, v130, v134
  v_add_f32 v131, v131, v135
  s_waitcnt vmcnt(13)
  v_add_f32 v128, v128, v136
  v_add_f32 v129, v129, v137
  v_add_f32 v130, v130, v138
  v_add_f32 v131, v131, v139
  s_waitcnt vmcnt(12)
  v_add_f32 v128, v128, v140
  v_add_f32 v129, v129, v141
  v_add_f32 v130, v130, v142
  v_add_f32 v131, v131, v143
  s_waitcnt vmcnt(11)
  v_add_f32 v128, v128, v144
  v_add_f32 v129, v129, v145
  v_add_f32 v130, v130, v146
  v_add_f32 v131, v131, v147
  s_waitcnt vmcnt(10)
  v_add_f32 v128, v128, v148
  v_add_f32 v129, v129, v149
  v_add_f32 v130, v130, v150
  v_add_f32 v131, v131, v151
  s_waitcnt vmcnt(9)
  v_add_f32 v128, v128, v152
  v_add_f32 v129, v129, v153
  v_add_f32 v130, v130, v154
  v_add_f32 v131, v131, v155
  s_waitcnt vmcnt(8)
  v_add_f32 v128, v128, v156
  v_add_f32 v129, v129, v157
  v_add_f32 v130, v130, v158
  v_add_f32 v131, v131, v159
  s_waitcnt vmcnt(7)
  v_add_f32 v128, v128, v160
  v_add_f32 v129, v129, v161
  v_add_f32 v130, v130, v162
  v_add_f32 v131, v131, v163
  s_waitcnt vmcnt(6)
  v_add_f32 v128, v128, v164
  v_add_f32 v129, v129, v165
  v_add_f32 v130, v130, v166
  v_add_f32 v131, v131, v167
  s_waitcnt vmcnt(5)
  v_add_f32 v128, v128, v168
  v_add_f32 v129, v129, v169
  v_add_f32 v130, v130, v170
  v_add_f32 v131, v131, v171
  s_waitcnt vmcnt(4)
  v_add_f32 v128, v128, v172
  v_add_f32 v129, v129, v173
  v_add_f32 v130, v130, v174
  v_add_f32 v131, v131, v175
  s_waitcnt vmcnt(3)
  v_add_f32 v128, v128, v176
  v_add_f32 v129, v129, v177
  v_add_f32 v130, v130, v178
  v_add_f32 v131, v131, v179
  s_waitcnt vmcnt(2)
  v_add_f32 v128, v128, v180
  v_add_f32 v129, v129, v181
  v_add_f32 v130, v130, v182
  v_add_f32 v131, v131, v183
  s_waitcnt vmcnt(1)
  v_add_f32 v128, v128, v184
  v_add_f32 v129, v129, v185
  v_add_f32 v130, v130, v186
  v_add_f32 v131, v131, v187
  s_waitcnt vmcnt(0)
  v_add_f32 v128, v128, v188
  v_add_f32 v129, v129, v189
  v_add_f32 v130, v130, v190
  v_add_f32 v131, v131, v191
  s_lshl_b32 s57, s3, 10
  s_add_u32 s57, s57, 139264
  v_add_u32 v36, s57, v23
  ds_write_b128 v36, v[128:131]
  s_waitcnt lgkmcnt(0)
  s_barrier
  v_lshrrev_b32 v36, 5, v1
  v_bfe_u32 v37, v1, 4, 1
  v_cmp_eq_u32 vcc, v36, v37
  v_and_b32 v38, 15, v1
  s_lshl_b32 s56, s5, 1
  v_add_u32 v36, s56, v36
  v_lshlrev_b32 v39, 11, v36
  v_lshl_add_u32 v39, v38, 4, v39
  v_add_u32 v39, 139264, v39
  v_lshlrev_b32 v40, 8, v36
  v_add_u32 v40, 155648, v40
  v_cndmask_b32 v41, 0, -1, vcc
  ds_read_b128 v[128:131], v39 offset:0
  ds_read_b128 v[132:135], v39 offset:256
  ds_read_b128 v[136:139], v40 offset:0
  ds_read_b128 v[140:143], v40 offset:16
  ds_read_b128 v[144:147], v40 offset:128
  ds_read_b128 v[148:151], v40 offset:144
  s_waitcnt lgkmcnt(0)
  v_add_f32 v136, v136, v144
  v_add_f32 v137, v137, v145
  v_add_f32 v138, v138, v146
  v_add_f32 v139, v139, v147
  v_add_f32 v140, v140, v148
  v_add_f32 v141, v141, v149
  v_add_f32 v142, v142, v150
  v_add_f32 v143, v143, v151
  v_cvt_pk_bf16_f32 v200, v128, v129
  v_cvt_pk_bf16_f32 v216, v136, v137
  v_cvt_pk_bf16_f32 v201, v130, v131
  v_cvt_pk_bf16_f32 v217, v138, v139
  v_cvt_pk_bf16_f32 v202, v132, v133
  v_cvt_pk_bf16_f32 v218, v140, v141
  v_cvt_pk_bf16_f32 v203, v134, v135
  v_cvt_pk_bf16_f32 v219, v142, v143
  v_and_b32 v200, v200, v41
  v_and_b32 v216, v216, v41
  v_and_b32 v201, v201, v41
  v_and_b32 v217, v217, v41
  v_and_b32 v202, v202, v41
  v_and_b32 v218, v218, v41
  v_and_b32 v203, v203, v41
  v_and_b32 v219, v219, v41
  ds_read_b128 v[152:155], v39 offset:512
  ds_read_b128 v[156:159], v39 offset:768
  ds_read_b128 v[160:163], v40 offset:32
  ds_read_b128 v[164:167], v40 offset:48
  ds_read_b128 v[168:171], v40 offset:160
  ds_read_b128 v[172:175], v40 offset:176
  s_waitcnt lgkmcnt(0)
  v_add_f32 v160, v160, v168
  v_add_f32 v161, v161, v169
  v_add_f32 v162, v162, v170
  v_add_f32 v163, v163, v171
  v_add_f32 v164, v164, v172
  v_add_f32 v165, v165, v173
  v_add_f32 v166, v166, v174
  v_add_f32 v167, v167, v175
  v_cvt_pk_bf16_f32 v204, v152, v153
  v_cvt_pk_bf16_f32 v220, v160, v161
  v_cvt_pk_bf16_f32 v205, v154, v155
  v_cvt_pk_bf16_f32 v221, v162, v163
  v_cvt_pk_bf16_f32 v206, v156, v157
  v_cvt_pk_bf16_f32 v222, v164, v165
  v_cvt_pk_bf16_f32 v207, v158, v159
  v_cvt_pk_bf16_f32 v223, v166, v167
  v_and_b32 v204, v204, v41
  v_and_b32 v220, v220, v41
  v_and_b32 v205, v205, v41
  v_and_b32 v221, v221, v41
  v_and_b32 v206, v206, v41
  v_and_b32 v222, v222, v41
  v_and_b32 v207, v207, v41
  v_and_b32 v223, v223, v41
  ds_read_b128 v[128:131], v39 offset:1024
  ds_read_b128 v[132:135], v39 offset:1280
  ds_read_b128 v[136:139], v40 offset:64
  ds_read_b128 v[140:143], v40 offset:80
  ds_read_b128 v[144:147], v40 offset:192
  ds_read_b128 v[148:151], v40 offset:208
  s_waitcnt lgkmcnt(0)
  v_add_f32 v136, v136, v144
  v_add_f32 v137, v137, v145
  v_add_f32 v138, v138, v146
  v_add_f32 v139, v139, v147
  v_add_f32 v140, v140, v148
  v_add_f32 v141, v141, v149
  v_add_f32 v142, v142, v150
  v_add_f32 v143, v143, v151
  v_cvt_pk_bf16_f32 v208, v128, v129
  v_cvt_pk_bf16_f32 v224, v136, v137
  v_cvt_pk_bf16_f32 v209, v130, v131
  v_cvt_pk_bf16_f32 v225, v138, v139
  v_cvt_pk_bf16_f32 v210, v132, v133
  v_cvt_pk_bf16_f32 v226, v140, v141
  v_cvt_pk_bf16_f32 v211, v134, v135
  v_cvt_pk_bf16_f32 v227, v142, v143
  v_and_b32 v208, v208, v41
  v_and_b32 v224, v224, v41
  v_and_b32 v209, v209, v41
  v_and_b32 v225, v225, v41
  v_and_b32 v210, v210, v41
  v_and_b32 v226, v226, v41
  v_and_b32 v211, v211, v41
  v_and_b32 v227, v227, v41
  ds_read_b128 v[152:155], v39 offset:1536
  ds_read_b128 v[156:159], v39 offset:1792
  ds_read_b128 v[160:163], v40 offset:96
  ds_read_b128 v[164:167], v40 offset:112
  ds_read_b128 v[168:171], v40 offset:224
  ds_read_b128 v[172:175], v40 offset:240
  s_waitcnt lgkmcnt(0)
  v_add_f32 v160, v160, v168
  v_add_f32 v161, v161, v169
  v_add_f32 v162, v162, v170
  v_add_f32 v163, v163, v171
  v_add_f32 v164, v164, v172
  v_add_f32 v165, v165, v173
  v_add_f32 v166, v166, v174
  v_add_f32 v167, v167, v175
  v_cvt_pk_bf16_f32 v212, v152, v153
  v_cvt_pk_bf16_f32 v228, v160, v161
  v_cvt_pk_bf16_f32 v213, v154, v155
  v_cvt_pk_bf16_f32 v229, v162, v163
  v_cvt_pk_bf16_f32 v214, v156, v157
  v_cvt_pk_bf16_f32 v230, v164, v165
  v_cvt_pk_bf16_f32 v215, v158, v159
  v_cvt_pk_bf16_f32 v231, v166, v167
  v_and_b32 v212, v212, v41
  v_and_b32 v228, v228, v41
  v_and_b32 v213, v213, v41
  v_and_b32 v229, v229, v41
  v_and_b32 v214, v214, v41
  v_and_b32 v230, v230, v41
  v_and_b32 v215, v215, v41
  v_and_b32 v231, v231, v41
  s_nop 1
  v_mfma_f32_32x32x16_bf16 v[112:127], v[200:203], v[48:51], 0
  v_mfma_f32_32x32x16_bf16 v[112:127], v[204:207], v[52:55], v[112:127]
  v_mfma_f32_32x32x16_bf16 v[112:127], v[208:211], v[56:59], v[112:127]
  v_mfma_f32_32x32x16_bf16 v[112:127], v[212:215], v[60:63], v[112:127]
  v_mfma_f32_32x32x16_bf16 v[96:111], v[216:219], v[48:51], 0
  v_mfma_f32_32x32x16_bf16 v[96:111], v[220:223], v[52:55], v[96:111]
  v_mfma_f32_32x32x16_bf16 v[96:111], v[224:227], v[56:59], v[96:111]
  v_mfma_f32_32x32x16_bf16 v[96:111], v[228:231], v[60:63], v[96:111]
  s_nop 7
  s_nop 7
  v_add_f32 v96, 0x358637bd, v96
  v_add_f32 v104, 0x358637bd, v104
  v_rcp_f32 v96, v96
  v_rcp_f32 v104, v104
  s_nop 0
  v_mul_f32 v112, v112, v96
  v_mul_f32 v113, v113, v96
  v_mul_f32 v114, v114, v96
  v_mul_f32 v115, v115, v96
  v_mul_f32 v116, v116, v96
  v_mul_f32 v117, v117, v96
  v_mul_f32 v118, v118, v96
  v_mul_f32 v119, v119, v96
  v_mul_f32 v120, v120, v104
  v_mul_f32 v121, v121, v104
  v_mul_f32 v122, v122, v104
  v_mul_f32 v123, v123, v104
  v_mul_f32 v124, v124, v104
  v_mul_f32 v125, v125, v104
  v_mul_f32 v126, v126, v104
  v_mul_f32 v127, v127, v104
  v_cvt_pk_bf16_f32 v128, v112, v113
  v_cvt_pk_bf16_f32 v129, v114, v115
  v_cvt_pk_bf16_f32 v130, v116, v117
  v_cvt_pk_bf16_f32 v131, v118, v119
  v_cvt_pk_bf16_f32 v132, v120, v121
  v_cvt_pk_bf16_f32 v133, v122, v123
  v_cvt_pk_bf16_f32 v134, v124, v125
  v_cvt_pk_bf16_f32 v135, v126, v127
  s_lshl_b32 s57, s76, 5
  s_lshl_b32 s58, s68, 2
  s_add_u32 s57, s57, s58
  s_lshl_b32 s58, s5, 1
  s_add_u32 s57, s57, s58
  s_lshl_b32 s57, s57, 10
  s_add_u32 s57, s57, 8388608
  buffer_store_dwordx4 v[128:131], v23, s[48:51], s57 offen sc1
  buffer_store_dwordx4 v[132:135], v23, s[48:51], s57 offen offset:1024 sc1
  s_waitcnt vmcnt(0)
  s_lshl_b32 s56, s6, 3
  s_lshr_b32 s57, s7, 1
  s_add_u32 s56, s56, s57
  s_lshl_b32 s56, s56, 3
  s_add_u32 s56, s56, s3
  s_lshl_b32 s56, s56, 7
  s_add_u32 s56, s56, 24903680
  v_mov_b32 v36, 0
  v_mov_b32 v37, s72
  s_mov_b64 exec, 1
  buffer_store_dword v37, v36, s[48:51], s56 offen sc1
  s_mov_b64 exec, -1
  s_waitcnt lgkmcnt(0)
  s_barrier
  v_mov_b32 v38, 155648
  v_mov_b32 v39, 0
  ds_write_b32 v38, v39
  s_waitcnt lgkmcnt(0)
  s_barrier
  s_branch p3_entry
k1_ffn6:
  s_cmp_ge_u32 s3, 4
  s_cbranch_scc1 pf_12_w
  s_lshr_b32 s56, s2, 3
  s_lshl_b32 s56, s56, 15
  s_lshl_b32 s57, s3, 13
  s_add_u32 s56, s56, s57
  s_bfe_u32 s57, s2, 0x10002
  s_lshl_b32 s57, s57, 20
  s_add_u32 s56, s56, s57
  v_lshlrev_b32 v36, 7, v1
  buffer_load_dword v15, v36, s[32:35], s56 offen
  s_branch pf_12_e
pf_12_w:
  s_cmp_lg_u32 s3, 4
  s_cbranch_scc1 pfw_13
  s_and_b32 s56, s6, 7
  s_mul_i32 s56, s56, 176128
  s_add_u32 s56, s56, s60
  s_sub_u32 s56, s56, 88064
  v_mul_u32_u24 v45, 2752, v1
  buffer_load_dword v15, v45, s[40:43], s56 offen
  buffer_load_dword v15, v45, s[40:43], s56 offen offset:124
pfw_13:
pf_12_e:
  s_lshl_b32 s59, s66, 2
  s_add_u32 m0, s59, 65536
  s_add_u32 s58, s65, 0
  buffer_load_dwordx4 v2, s[32:35], s58 offen lds
  s_lshl_b32 s59, s66, 2
  s_add_u32 m0, s59, 66560
  s_add_u32 s58, s65, 4096
  v_xor_b32 v3, 64, v2
  buffer_load_dwordx4 v3, s[32:35], s58 offen lds
  s_lshl_b32 s59, s66, 2
  s_add_u32 m0, s59, 67584
  s_add_u32 s58, s65, 8192
  v_xor_b32 v3, 128, v2
  buffer_load_dwordx4 v3, s[32:35], s58 offen lds
  s_lshl_b32 s59, s66, 2
  s_add_u32 m0, s59, 68608
  s_add_u32 s58, s65, 12288
  v_xor_b32 v3, 192, v2
  buffer_load_dwordx4 v3, s[32:35], s58 offen lds
  s_add_u32 m0, s66, 0
  s_add_u32 s58, s60, 0
  buffer_load_dwordx4 v5, s[40:43], s58 offen lds
  s_add_u32 m0, s66, 8192
  s_add_u32 s58, s60, 176128
  buffer_load_dwordx4 v5, s[40:43], s58 offen lds
  v_lshlrev_b32 v23, 4, v1
  v_and_b32 v36, 31, v1
  v_lshrrev_b32 v37, 5, v1
  v_and_b32 v38, 15, v1
  v_xor_b32 v38, v38, v37
  s_lshl_b32 s56, s4, 13
  s_add_u32 s56, s56, 65536
  v_lshlrev_b32 v39, 8, v36
  v_add_u32 v39, s56, v39
  s_add_u32 s57, s4, 0
  s_and_b32 s57, s57, 3
  s_add_u32 s57, s57, 0
  s_lshl_b32 s57, s57, 1
  v_xor_b32 v40, s57, v38
  v_lshl_add_u32 v6, v40, 4, v39
  s_add_u32 s57, s4, 1
  s_and_b32 s57, s57, 3
  s_add_u32 s57, s57, 0
  s_lshl_b32 s57, s57, 1
  v_xor_b32 v40, s57, v38
  v_lshl_add_u32 v7, v40, 4, v39
  s_add_u32 s57, s4, 2
  s_and_b32 s57, s57, 3
  s_add_u32 s57, s57, 0
  s_lshl_b32 s57, s57, 1
  v_xor_b32 v40, s57, v38
  v_lshl_add_u32 v8, v40, 4, v39
  s_add_u32 s57, s4, 3
  s_and_b32 s57, s57, 3
  s_add_u32 s57, s57, 0
  s_lshl_b32 s57, s57, 1
  v_xor_b32 v40, s57, v38
  v_lshl_add_u32 v9, v40, 4, v39
  s_add_u32 s57, s4, 4
  s_and_b32 s57, s57, 3
  s_add_u32 s57, s57, 4
  s_lshl_b32 s57, s57, 1
  v_xor_b32 v40, s57, v38
  v_lshl_add_u32 v48, v40, 4, v39
  s_add_u32 s57, s4, 5
  s_and_b32 s57, s57, 3
  s_add_u32 s57, s57, 4
  s_lshl_b32 s57, s57, 1
  v_xor_b32 v40, s57, v38
  v_lshl_add_u32 v49, v40, 4, v39
  s_add_u32 s57, s4, 6
  s_and_b32 s57, s57, 3
  s_add_u32 s57, s57, 4
  s_lshl_b32 s57, s57, 1
  v_xor_b32 v40, s57, v38
  v_lshl_add_u32 v50, v40, 4, v39
  s_add_u32 s57, s4, 7
  s_and_b32 s57, s57, 3
  s_add_u32 s57, s57, 4
  s_lshl_b32 s57, s57, 1
  v_xor_b32 v40, s57, v38
  v_lshl_add_u32 v51, v40, 4, v39
  v_bfe_u32 v40, v1, 2, 2
  v_lshl_add_u32 v41, v37, 3, v40
  v_lshlrev_b32 v41, 7, v41
  v_bfe_u32 v42, v1, 4, 1
  v_lshlrev_b32 v42, 1, v42
  v_bfe_u32 v43, v1, 1, 1
  v_add_u32 v42, v42, v43
  s_lshl_b32 s56, s5, 2
  v_add_u32 v42, s56, v42
  v_lshrrev_b32 v43, 1, v40
  v_lshlrev_b32 v43, 2, v43
  v_xor_b32 v42, v42, v43
  v_lshl_add_u32 v41, v42, 4, v41
  v_and_b32 v43, 1, v1
  v_lshl_add_u32 v41, v43, 3, v41
  s_add_u32 s57, s4, 0
  s_and_b32 s57, s57, 3
  s_lshl_b32 s57, s57, 11
  v_add_u32 v10, s57, v41
  s_add_u32 s57, s4, 1
  s_and_b32 s57, s57, 3
  s_lshl_b32 s57, s57, 11
  v_add_u32 v11, s57, v41
  s_add_u32 s57, s4, 2
  s_and_b32 s57, s57, 3
  s_lshl_b32 s57, s57, 11
  v_add_u32 v12, s57, v41
  s_add_u32 s57, s4, 3
  s_and_b32 s57, s57, 3
  s_lshl_b32 s57, s57, 11
  v_add_u32 v13, s57, v41
  v_and_b32 v40, 15, v1
  v_bfe_u32 v42, v1, 4, 1
  v_cmp_eq_u32 vcc, v40, v42
  v_mov_b32 v43, 0x3f803f80
  v_lshrrev_b32 v42, 4, v1
  v_cndmask_b32 v24, 0, v43, vcc
  v_mov_b32 v25, v24
  v_mov_b32 v26, v24
  v_mov_b32 v27, v24
  v_mov_b32 v46, 0x3f803f80
  v_mov_b32 v47, 0x3f803f80
  v_lshlrev_b32 v42, 6, v42
  v_lshl_add_u32 v42, v40, 8, v42
  s_lshl_b32 s56, s5, 9
  s_lshl_b32 s57, s4, 2
  s_add_u32 s57, s56, s57
  s_add_u32 s57, s57, 131072
  v_add_u32 v22, s57, v42
  v_lshlrev_b32 v42, 4, v37
  s_lshl_b32 s57, s3, 7
  s_add_u32 s57, s57, 136192
  v_add_u32 v21, s57, v42
  v_lshlrev_b32 v42, 2, v36
  v_add_u32 v14, s57, v42
  s_mov_b32 s74, 0x00030003
  s_mov_b32 s75, 0x00030003
  s_mov_b32 s78, 0x0001ffff
  s_mov_b32 s80, 0xffff0001
  s_lshl_b32 s76, s6, 2
  s_add_u32 s76, s76, s4
  s_mul_i32 s67, s76, 88064
  s_waitcnt vmcnt(0)
  s_lshl_b32 s59, s66, 2
  s_add_u32 m0, s59, 98304
  s_add_u32 s58, s65, 256
  buffer_load_dwordx4 v2, s[32:35], s58 offen lds
  s_lshl_b32 s59, s66, 2
  s_add_u32 m0, s59, 99328
  s_add_u32 s58, s65, 4352
  v_xor_b32 v3, 64, v2
  buffer_load_dwordx4 v3, s[32:35], s58 offen lds
  s_lshl_b32 s59, s66, 2
  s_add_u32 m0, s59, 100352
  s_add_u32 s58, s65, 8448
  v_xor_b32 v3, 128, v2
  buffer_load_dwordx4 v3, s[32:35], s58 offen lds
  s_lshl_b32 s59, s66, 2
  s_add_u32 m0, s59, 101376
  s_add_u32 s58, s65, 12544
  v_xor_b32 v3, 192, v2
  buffer_load_dwordx4 v3, s[32:35], s58 offen lds
  s_add_u32 m0, s66, 16384
  s_add_u32 s58, s60, 352256
  buffer_load_dwordx4 v5, s[40:43], s58 offen lds
  s_add_u32 m0, s66, 24576
  s_add_u32 s58, s60, 528384
  buffer_load_dwordx4 v5, s[40:43], s58 offen lds
  s_cmp_eq_u32 s5, 0
  s_cbranch_scc1 su_14_A
  s_barrier
  s_cmp_lg_u32 s3, 5
  s_cbranch_scc1 pfw_15
  s_and_b32 s56, s6, 7
  s_mul_i32 s56, s56, 176128
  s_add_u32 s56, s56, s61
  s_sub_u32 s56, s56, 110080
  v_mul_u32_u24 v45, 2752, v1
  buffer_load_dword v15, v45, s[44:47], s56 offen
  buffer_load_dword v15, v45, s[44:47], s56 offen offset:124
pfw_15:
  ds_read_b128 v[128:131], v6 offset:0
  ds_read_b64_tr_b16 v[80:81], v10 offset:0
  ds_read_b64_tr_b16 v[82:83], v10 offset:512
  ds_read_b128 v[132:135], v7 offset:0
  ds_read_b64_tr_b16 v[84:85], v11 offset:0
  ds_read_b64_tr_b16 v[86:87], v11 offset:512
  ds_read_b128 v[136:139], v8 offset:0
  ds_read_b64_tr_b16 v[88:89], v12 offset:0
  ds_read_b64_tr_b16 v[90:91], v12 offset:512
  ds_read_b128 v[140:143], v9 offset:0
  ds_read_b64_tr_b16 v[92:93], v13 offset:0
  ds_read_b64_tr_b16 v[94:95], v13 offset:512
  s_waitcnt lgkmcnt(9)
  v_mfma_f32_32x32x16_bf16 v[112:127], v[80:83], v[128:131], 0
  v_mfma_f32_16x16x32_bf16 v[28:31], v[80:83], v[24:27], 0
  v_mfma_f32_4x4x4_16b_bf16 v[32:35], v[128:129], v[128:129], 0
  v_mfma_f32_4x4x4_16b_bf16 v[40:43], v[130:131], v[130:131], 0
  s_lshl_b32 s59, s66, 2
  s_add_u32 m0, s59, 131072
  s_add_u32 s58, s65, 512
  buffer_load_dwordx4 v2, s[32:35], s58 offen lds
  ds_read_b128 v[144:147], v48 offset:0
  ds_read_b64_tr_b16 v[80:81], v10 offset:8192
  ds_read_b64_tr_b16 v[82:83], v10 offset:8704
  s_waitcnt lgkmcnt(9)
  v_mfma_f32_32x32x16_bf16 v[112:127], v[84:87], v[132:135], v[112:127]
  v_mfma_f32_4x4x4_16b_bf16 v[32:35], v[132:133], v[132:133], v[32:35]
  v_mfma_f32_4x4x4_16b_bf16 v[40:43], v[134:135], v[134:135], v[40:43]
  s_lshl_b32 s59, s66, 2
  s_add_u32 m0, s59, 132096
  s_add_u32 s58, s65, 4608
  v_xor_b32 v3, 64, v2
  buffer_load_dwordx4 v3, s[32:35], s58 offen lds
  ds_read_b128 v[148:151], v49 offset:0
  ds_read_b64_tr_b16 v[84:85], v11 offset:8192
  ds_read_b64_tr_b16 v[86:87], v11 offset:8704
  s_waitcnt lgkmcnt(9)
  v_mfma_f32_32x32x16_bf16 v[112:127], v[88:91], v[136:139], v[112:127]
  v_mfma_f32_4x4x4_16b_bf16 v[32:35], v[136:137], v[136:137], v[32:35]
  v_mfma_f32_4x4x4_16b_bf16 v[40:43], v[138:139], v[138:139], v[40:43]
  s_lshl_b32 s59, s66, 2
  s_add_u32 m0, s59, 133120
  s_add_u32 s58, s65, 8704
  v_xor_b32 v3, 128, v2
  buffer_load_dwordx4 v3, s[32:35], s58 offen lds
  ds_read_b128 v[152:155], v50 offset:0
  ds_read_b64_tr_b16 v[88:89], v12 offset:8192
  ds_read_b64_tr_b16 v[90:91], v12 offset:8704
  s_waitcnt lgkmcnt(9)
  v_mfma_f32_32x32x16_bf16 v[112:127], v[92:95], v[140:143], v[112:127]
  v_mfma_f32_4x4x4_16b_bf16 v[32:35], v[140:141], v[140:141], v[32:35]
  v_mfma_f32_4x4x4_16b_bf16 v[40:43], v[142:143], v[142:143], v[40:43]
  s_lshl_b32 s59, s66, 2
  s_add_u32 m0, s59, 134144
  s_add_u32 s58, s65, 12800
  v_xor_b32 v3, 192, v2
  buffer_load_dwordx4 v3, s[32:35], s58 offen lds
  ds_read_b128 v[156:159], v51 offset:0
  ds_read_b64_tr_b16 v[92:93], v13 offset:8192
  ds_read_b64_tr_b16 v[94:95], v13 offset:8704
  s_waitcnt lgkmcnt(9)
  v_mfma_f32_32x32x16_bf16 v[112:127], v[80:83], v[144:147], v[112:127]
  v_mfma_f32_16x16x32_bf16 v[28:31], v[80:83], v[24:27], v[28:31]
  v_mfma_f32_4x4x4_16b_bf16 v[32:35], v[144:145], v[144:145], v[32:35]
  v_mfma_f32_4x4x4_16b_bf16 v[40:43], v[146:147], v[146:147], v[40:43]
  s_add_u32 m0, s66, 32768
  s_add_u32 s58, s60, 704512
  buffer_load_dwordx4 v5, s[40:43], s58 offen lds
  s_waitcnt lgkmcnt(6)
  v_mfma_f32_32x32x16_bf16 v[112:127], v[84:87], v[148:151], v[112:127]
  v_mfma_f32_4x4x4_16b_bf16 v[32:35], v[148:149], v[148:149], v[32:35]
  v_mfma_f32_4x4x4_16b_bf16 v[40:43], v[150:151], v[150:151], v[40:43]
  s_add_u32 m0, s66, 40960
  s_add_u32 s58, s60, 880640
  buffer_load_dwordx4 v5, s[40:43], s58 offen lds
  s_add_u32 m0, s66, 49152
  s_add_u32 s58, s60, 1056768
  buffer_load_dwordx4 v5, s[40:43], s58 offen lds
  s_waitcnt lgkmcnt(3)
  v_mfma_f32_32x32x16_bf16 v[112:127], v[88:91], v[152:155], v[112:127]
  v_mfma_f32_4x4x4_16b_bf16 v[32:35], v[152:153], v[152:153], v[32:35]
  v_mfma_f32_4x4x4_16b_bf16 v[40:43], v[154:155], v[154:155], v[40:43]
  s_add_u32 m0, s66, 57344
  s_add_u32 s58, s60, 1232896
  buffer_load_dwordx4 v5, s[40:43], s58 offen lds
  s_waitcnt lgkmcnt(0)
  v_mfma_f32_32x32x16_bf16 v[112:127], v[92:95], v[156:159], v[112:127]
  v_mfma_f32_4x4x4_16b_bf16 v[32:35], v[156:157], v[156:157], v[32:35]
  v_mfma_f32_4x4x4_16b_bf16 v[40:43], v[158:159], v[158:159], v[40:43]
  s_waitcnt vmcnt(8)
  s_barrier
  s_cmp_lg_u32 s3, 6
  s_cbranch_scc1 pfw_16
  s_and_b32 s56, s6, 7
  s_mul_i32 s56, s56, 176128
  s_add_u32 s56, s56, s62
  s_sub_u32 s56, s56, 132096
  v_mul_u32_u24 v45, 2752, v1
  buffer_load_dword v15, v45, s[40:43], s56 offen
  buffer_load_dword v15, v45, s[40:43], s56 offen offset:124
pfw_16:
  ds_read_b128 v[160:163], v6 offset:32768
  ds_read_b64_tr_b16 v[80:81], v10 offset:16384
  ds_read_b64_tr_b16 v[82:83], v10 offset:16896
  ds_read_b128 v[164:167], v7 offset:32768
  ds_read_b64_tr_b16 v[84:85], v11 offset:16384
  ds_read_b64_tr_b16 v[86:87], v11 offset:16896
  ds_read_b128 v[168:171], v8 offset:32768
  ds_read_b64_tr_b16 v[88:89], v12 offset:16384
  ds_read_b64_tr_b16 v[90:91], v12 offset:16896
  ds_read_b128 v[172:175], v9 offset:32768
  ds_read_b64_tr_b16 v[92:93], v13 offset:16384
  ds_read_b64_tr_b16 v[94:95], v13 offset:16896
  s_waitcnt lgkmcnt(9)
  v_mfma_f32_32x32x16_bf16 v[112:127], v[80:83], v[160:163], v[112:127]
  v_mfma_f32_16x16x32_bf16 v[28:31], v[80:83], v[24:27], v[28:31]
  v_mfma_f32_4x4x4_16b_bf16 v[32:35], v[160:161], v[160:161], v[32:35]
  v_mfma_f32_4x4x4_16b_bf16 v[40:43], v[162:163], v[162:163], v[40:43]
  s_lshl_b32 s59, s66, 2
  s_add_u32 m0, s59, 65536
  s_add_u32 s58, s65, 768
  buffer_load_dwordx4 v2, s[32:35], s58 offen lds
  ds_read_b128 v[176:179], v48 offset:32768
  ds_read_b64_tr_b16 v[80:81], v10 offset:24576
  ds_read_b64_tr_b16 v[82:83], v10 offset:25088
  s_waitcnt lgkmcnt(9)
  v_mfma_f32_32x32x16_bf16 v[112:127], v[84:87], v[164:167], v[112:127]
  v_mfma_f32_4x4x4_16b_bf16 v[32:35], v[164:165], v[164:165], v[32:35]
  v_mfma_f32_4x4x4_16b_bf16 v[40:43], v[166:167], v[166:167], v[40:43]
  s_lshl_b32 s59, s66, 2
  s_add_u32 m0, s59, 66560
  s_add_u32 s58, s65, 4864
  v_xor_b32 v3, 64, v2
  buffer_load_dwordx4 v3, s[32:35], s58 offen lds
  ds_read_b128 v[180:183], v49 offset:32768
  ds_read_b64_tr_b16 v[84:85], v11 offset:24576
  ds_read_b64_tr_b16 v[86:87], v11 offset:25088
  s_waitcnt lgkmcnt(9)
  v_mfma_f32_32x32x16_bf16 v[112:127], v[88:91], v[168:171], v[112:127]
  v_mfma_f32_4x4x4_16b_bf16 v[32:35], v[168:169], v[168:169], v[32:35]
  v_mfma_f32_4x4x4_16b_bf16 v[40:43], v[170:171], v[170:171], v[40:43]
  s_lshl_b32 s59, s66, 2
  s_add_u32 m0, s59, 67584
  s_add_u32 s58, s65, 8960
  v_xor_b32 v3, 128, v2
  buffer_load_dwordx4 v3, s[32:35], s58 offen lds
  ds_read_b128 v[184:187], v50 offset:32768
  ds_read_b64_tr_b16 v[88:89], v12 offset:24576
  ds_read_b64_tr_b16 v[90:91], v12 offset:25088
  s_waitcnt lgkmcnt(9)
  v_mfma_f32_32x32x16_bf16 v[112:127], v[92:95], v[172:175], v[112:127]
  v_mfma_f32_4x4x4_16b_bf16 v[32:35], v[172:173], v[172:173], v[32:35]
  v_mfma_f32_4x4x4_16b_bf16 v[40:43], v[174:175], v[174:175], v[40:43]
  s_lshl_b32 s59, s66, 2
  s_add_u32 m0, s59, 68608
  s_add_u32 s58, s65, 13056
  v_xor_b32 v3, 192, v2
  buffer_load_dwordx4 v3, s[32:35], s58 offen lds
  ds_read_b128 v[188:191], v51 offset:32768
  ds_read_b64_tr_b16 v[92:93], v13 offset:24576
  ds_read_b64_tr_b16 v[94:95], v13 offset:25088
  s_waitcnt lgkmcnt(9)
  v_mfma_f32_32x32x16_bf16 v[112:127], v[80:83], v[176:179], v[112:127]
  v_mfma_f32_16x16x32_bf16 v[28:31], v[80:83], v[24:27], v[28:31]
  v_mfma_f32_4x4x4_16b_bf16 v[32:35], v[176:177], v[176:177], v[32:35]
  v_mfma_f32_4x4x4_16b_bf16 v[40:43], v[178:179], v[178:179], v[40:43]
  s_add_u32 m0, s66, 0
  s_add_u32 s58, s61, 0
  buffer_load_dwordx4 v5, s[44:47], s58 offen lds
  s_waitcnt lgkmcnt(6)
  v_mfma_f32_32x32x16_bf16 v[112:127], v[84:87], v[180:183], v[112:127]
  v_mfma_f32_4x4x4_16b_bf16 v[32:35], v[180:181], v[180:181], v[32:35]
  v_mfma_f32_4x4x4_16b_bf16 v[40:43], v[182:183], v[182:183], v[40:43]
  s_add_u32 m0, s66, 8192
  s_add_u32 s58, s61, 176128
  buffer_load_dwordx4 v5, s[44:47], s58 offen lds
  s_waitcnt lgkmcnt(3)
  v_mfma_f32_32x32x16_bf16 v[112:127], v[88:91], v[184:187], v[112:127]
  v_mfma_f32_4x4x4_16b_bf16 v[32:35], v[184:185], v[184:185], v[32:35]
  v_mfma_f32_4x4x4_16b_bf16 v[40:43], v[186:187], v[186:187], v[40:43]
  s_waitcnt lgkmcnt(0)
  v_mfma_f32_32x32x16_bf16 v[112:127], v[92:95], v[188:191], v[112:127]
  v_mfma_f32_4x4x4_16b_bf16 v[32:35], v[188:189], v[188:189], v[32:35]
  v_mfma_f32_4x4x4_16b_bf16 v[40:43], v[190:191], v[190:191], v[40:43]
  s_waitcnt vmcnt(8)
  s_barrier
  v_add_u32 v6, 0x10000, v6
  v_add_u32 v7, 0x10000, v7
  v_add_u32 v8, 0x10000, v8
  v_add_u32 v9, 0x10000, v9
  v_add_u32 v48, 0x10000, v48
  v_add_u32 v49, 0x10000, v49
  v_add_u32 v50, 0x10000, v50
  v_add_u32 v51, 0x10000, v51
  ds_read_b128 v[192:195], v6 offset:0
  ds_read_b64_tr_b16 v[80:81], v10 offset:32768
  ds_read_b64_tr_b16 v[82:83], v10 offset:33280
  ds_read_b128 v[196:199], v7 offset:0
  ds_read_b64_tr_b16 v[84:85], v11 offset:32768
  ds_read_b64_tr_b16 v[86:87], v11 offset:33280
  ds_read_b128 v[200:203], v8 offset:0
  ds_read_b64_tr_b16 v[88:89], v12 offset:32768
  ds_read_b64_tr_b16 v[90:91], v12 offset:33280
  ds_read_b128 v[204:207], v9 offset:0
  ds_read_b64_tr_b16 v[92:93], v13 offset:32768
  ds_read_b64_tr_b16 v[94:95], v13 offset:33280
  s_waitcnt lgkmcnt(9)
  v_mfma_f32_32x32x16_bf16 v[112:127], v[80:83], v[192:195], v[112:127]
  v_mfma_f32_16x16x32_bf16 v[28:31], v[80:83], v[24:27], v[28:31]
  v_mfma_f32_4x4x4_16b_bf16 v[32:35], v[192:193], v[192:193], v[32:35]
  v_mfma_f32_4x4x4_16b_bf16 v[40:43], v[194:195], v[194:195], v[40:43]
  s_add_u32 m0, s66, 16384
  s_add_u32 s58, s61, 352256
  buffer_load_dwordx4 v5, s[44:47], s58 offen lds
  ds_read_b128 v[208:211], v48 offset:0
  ds_read_b64_tr_b16 v[80:81], v10 offset:40960
  ds_read_b64_tr_b16 v[82:83], v10 offset:41472
  s_waitcnt lgkmcnt(9)
  v_mfma_f32_32x32x16_bf16 v[112:127], v[84:87], v[196:199], v[112:127]
  v_mfma_f32_4x4x4_16b_bf16 v[32:35], v[196:197], v[196:197], v[32:35]
  v_mfma_f32_4x4x4_16b_bf16 v[40:43], v[198:199], v[198:199], v[40:43]
  s_add_u32 m0, s66, 24576
  s_add_u32 s58, s61, 528384
  buffer_load_dwordx4 v5, s[44:47], s58 offen lds
  ds_read_b128 v[212:215], v49 offset:0
  ds_read_b64_tr_b16 v[84:85], v11 offset:40960
  ds_read_b64_tr_b16 v[86:87], v11 offset:41472
  s_waitcnt lgkmcnt(9)
  v_mfma_f32_32x32x16_bf16 v[112:127], v[88:91], v[200:203], v[112:127]
  v_mfma_f32_4x4x4_16b_bf16 v[32:35], v[200:201], v[200:201], v[32:35]
  v_mfma_f32_4x4x4_16b_bf16 v[40:43], v[202:203], v[202:203], v[40:43]
  s_add_u32 m0, s66, 98304
  s_add_u32 s58, s61, 704512
  buffer_load_dwordx4 v5, s[44:47], s58 offen lds
  ds_read_b128 v[216:219], v50 offset:0
  ds_read_b64_tr_b16 v[88:89], v12 offset:40960
  ds_read_b64_tr_b16 v[90:91], v12 offset:41472
  s_waitcnt lgkmcnt(9)
  v_mfma_f32_32x32x16_bf16 v[112:127], v[92:95], v[204:207], v[112:127]
  v_mfma_f32_4x4x4_16b_bf16 v[32:35], v[204:205], v[204:205], v[32:35]
  v_mfma_f32_4x4x4_16b_bf16 v[40:43], v[206:207], v[206:207], v[40:43]
  s_add_u32 m0, s66, 106496
  s_add_u32 s58, s61, 880640
  buffer_load_dwordx4 v5, s[44:47], s58 offen lds
  ds_read_b128 v[220:223], v51 offset:0
  ds_read_b64_tr_b16 v[92:93], v13 offset:40960
  ds_read_b64_tr_b16 v[94:95], v13 offset:41472
  s_waitcnt lgkmcnt(9)
  v_mfma_f32_32x32x16_bf16 v[112:127], v[80:83], v[208:211], v[112:127]
  v_mfma_f32_16x16x32_bf16 v[28:31], v[80:83], v[24:27], v[28:31]
  v_mfma_f32_4x4x4_16b_bf16 v[32:35], v[208:209], v[208:209], v[32:35]
  v_mfma_f32_4x4x4_16b_bf16 v[40:43], v[210:211], v[210:211], v[40:43]
  s_add_u32 m0, s66, 114688
  s_add_u32 s58, s61, 1056768
  buffer_load_dwordx4 v5, s[44:47], s58 offen lds
  s_waitcnt lgkmcnt(6)
  v_mfma_f32_32x32x16_bf16 v[112:127], v[84:87], v[212:215], v[112:127]
  v_mfma_f32_4x4x4_16b_bf16 v[32:35], v[212:213], v[212:213], v[32:35]
  v_mfma_f32_4x4x4_16b_bf16 v[40:43], v[214:215], v[214:215], v[40:43]
  s_add_u32 m0, s66, 122880
  s_add_u32 s58, s61, 1232896
  buffer_load_dwordx4 v5, s[44:47], s58 offen lds
  s_waitcnt lgkmcnt(3)
  v_mfma_f32_32x32x16_bf16 v[112:127], v[88:91], v[216:219], v[112:127]
  v_mfma_f32_4x4x4_16b_bf16 v[32:35], v[216:217], v[216:217], v[32:35]
  v_mfma_f32_4x4x4_16b_bf16 v[40:43], v[218:219], v[218:219], v[40:43]
  s_waitcnt lgkmcnt(0)
  v_mfma_f32_32x32x16_bf16 v[112:127], v[92:95], v[220:223], v[112:127]
  v_mfma_f32_4x4x4_16b_bf16 v[32:35], v[220:221], v[220:221], v[32:35]
  v_mfma_f32_4x4x4_16b_bf16 v[40:43], v[222:223], v[222:223], v[40:43]
  s_waitcnt vmcnt(8)
  s_barrier
  s_cmp_lg_u32 s3, 7
  s_cbranch_scc1 pfw_17
  s_and_b32 s56, s6, 7
  s_mul_i32 s56, s56, 176128
  s_add_u32 s56, s56, s63
  s_sub_u32 s56, s56, 154112
  v_mul_u32_u24 v45, 2752, v1
  buffer_load_dword v15, v45, s[44:47], s56 offen
  buffer_load_dword v15, v45, s[44:47], s56 offen offset:124
pfw_17:
  v_add_u32 v6, 0xffff0000, v6
  v_add_u32 v7, 0xffff0000, v7
  v_add_u32 v8, 0xffff0000, v8
  v_add_u32 v9, 0xffff0000, v9
  v_add_u32 v48, 0xffff0000, v48
  v_add_u32 v49, 0xffff0000, v49
  v_add_u32 v50, 0xffff0000, v50
  v_add_u32 v51, 0xffff0000, v51
  ds_read_b128 v[224:227], v6 offset:0
  ds_read_b64_tr_b16 v[80:81], v10 offset:49152
  ds_read_b64_tr_b16 v[82:83], v10 offset:49664
  ds_read_b128 v[228:231], v7 offset:0
  ds_read_b64_tr_b16 v[84:85], v11 offset:49152
  ds_read_b64_tr_b16 v[86:87], v11 offset:49664
  ds_read_b128 v[232:235], v8 offset:0
  ds_read_b64_tr_b16 v[88:89], v12 offset:49152
  ds_read_b64_tr_b16 v[90:91], v12 offset:49664
  ds_read_b128 v[236:239], v9 offset:0
  ds_read_b64_tr_b16 v[92:93], v13 offset:49152
  ds_read_b64_tr_b16 v[94:95], v13 offset:49664
  s_waitcnt lgkmcnt(9)
  v_mfma_f32_32x32x16_bf16 v[112:127], v[80:83], v[224:227], v[112:127]
  v_mfma_f32_16x16x32_bf16 v[28:31], v[80:83], v[24:27], v[28:31]
  v_mfma_f32_4x4x4_16b_bf16 v[32:35], v[224:225], v[224:225], v[32:35]
  v_mfma_f32_4x4x4_16b_bf16 v[40:43], v[226:227], v[226:227], v[40:43]
  ds_read_b128 v[240:243], v48 offset:0
  ds_read_b64_tr_b16 v[80:81], v10 offset:57344
  ds_read_b64_tr_b16 v[82:83], v10 offset:57856
  s_waitcnt lgkmcnt(9)
  v_mfma_f32_32x32x16_bf16 v[112:127], v[84:87], v[228:231], v[112:127]
  v_mfma_f32_4x4x4_16b_bf16 v[32:35], v[228:229], v[228:229], v[32:35]
  v_mfma_f32_4x4x4_16b_bf16 v[40:43], v[230:231], v[230:231], v[40:43]
  ds_read_b128 v[244:247], v49 offset:0
  ds_read_b64_tr_b16 v[84:85], v11 offset:57344
  ds_read_b64_tr_b16 v[86:87], v11 offset:57856
  s_waitcnt lgkmcnt(9)
  v_mfma_f32_32x32x16_bf16 v[112:127], v[88:91], v[232:235], v[112:127]
  v_mfma_f32_4x4x4_16b_bf16 v[32:35], v[232:233], v[232:233], v[32:35]
  v_mfma_f32_4x4x4_16b_bf16 v[40:43], v[234:235], v[234:235], v[40:43]
  ds_read_b128 v[248:251], v50 offset:0
  ds_read_b64_tr_b16 v[88:89], v12 offset:57344
  ds_read_b64_tr_b16 v[90:91], v12 offset:57856
  s_waitcnt lgkmcnt(9)
  v_mfma_f32_32x32x16_bf16 v[112:127], v[92:95], v[236:239], v[112:127]
  v_mfma_f32_4x4x4_16b_bf16 v[32:35], v[236:237], v[236:237], v[32:35]
  v_mfma_f32_4x4x4_16b_bf16 v[40:43], v[238:239], v[238:239], v[40:43]
  ds_read_b128 v[252:255], v51 offset:0
  ds_read_b64_tr_b16 v[92:93], v13 offset:57344
  ds_read_b64_tr_b16 v[94:95], v13 offset:57856
  s_waitcnt lgkmcnt(9)
  v_mfma_f32_32x32x16_bf16 v[112:127], v[80:83], v[240:243], v[112:127]
  v_mfma_f32_16x16x32_bf16 v[28:31], v[80:83], v[24:27], v[28:31]
  v_mfma_f32_4x4x4_16b_bf16 v[32:35], v[240:241], v[240:241], v[32:35]
  v_mfma_f32_4x4x4_16b_bf16 v[40:43], v[242:243], v[242:243], v[40:43]
  s_waitcnt lgkmcnt(6)
  v_mfma_f32_32x32x16_bf16 v[112:127], v[84:87], v[244:247], v[112:127]
  v_mfma_f32_4x4x4_16b_bf16 v[32:35], v[244:245], v[244:245], v[32:35]
  v_mfma_f32_4x4x4_16b_bf16 v[40:43], v[246:247], v[246:247], v[40:43]
  s_waitcnt lgkmcnt(3)
  v_mfma_f32_32x32x16_bf16 v[112:127], v[88:91], v[248:251], v[112:127]
  v_mfma_f32_4x4x4_16b_bf16 v[32:35], v[248:249], v[248:249], v[32:35]
  v_mfma_f32_4x4x4_16b_bf16 v[40:43], v[250:251], v[250:251], v[40:43]
  s_waitcnt lgkmcnt(0)
  v_mfma_f32_32x32x16_bf16 v[112:127], v[92:95], v[252:255], v[112:127]
  v_mfma_f32_4x4x4_16b_bf16 v[32:35], v[252:253], v[252:253], v[32:35]
  v_mfma_f32_4x4x4_16b_bf16 v[40:43], v[254:255], v[254:255], v[40:43]
  s_branch su_14_J
su_14_A:
  s_barrier
  s_cmp_lg_u32 s3, 5
  s_cbranch_scc1 pfw_18
  s_and_b32 s56, s6, 7
  s_mul_i32 s56, s56, 176128
  s_add_u32 s56, s56, s61
  s_sub_u32 s56, s56, 110080
  v_mul_u32_u24 v45, 2752, v1
  buffer_load_dword v15, v45, s[44:47], s56 offen
  buffer_load_dword v15, v45, s[44:47], s56 offen offset:124
pfw_18:
  ds_read_b128 v[128:131], v6 offset:0
  ds_read_b64_tr_b16 v[80:81], v10 offset:0
  ds_read_b64_tr_b16 v[82:83], v10 offset:512
  ds_read_b128 v[132:135], v7 offset:0
  ds_read_b64_tr_b16 v[84:85], v11 offset:0
  ds_read_b64_tr_b16 v[86:87], v11 offset:512
  ds_read_b128 v[136:139], v8 offset:0
  ds_read_b64_tr_b16 v[88:89], v12 offset:0
  ds_read_b64_tr_b16 v[90:91], v12 offset:512
  ds_read_b128 v[140:143], v9 offset:0
  ds_read_b64_tr_b16 v[92:93], v13 offset:0
  ds_read_b64_tr_b16 v[94:95], v13 offset:512
  s_waitcnt lgkmcnt(9)
  v_mfma_f32_32x32x16_bf16 v[112:127], v[80:83], v[128:131], 0
  v_mfma_f32_16x16x32_bf16 v[28:31], v[80:83], v[24:27], 0
  v_mfma_f32_4x4x4_16b_bf16 v[32:35], v[128:129], v[46:47], 0
  v_mfma_f32_4x4x4_16b_bf16 v[40:43], v[130:131], v[46:47], 0
  s_lshl_b32 s59, s66, 2
  s_add_u32 m0, s59, 131072
  s_add_u32 s58, s65, 512
  buffer_load_dwordx4 v2, s[32:35], s58 offen lds
  ds_read_b128 v[144:147], v48 offset:0
  ds_read_b64_tr_b16 v[80:81], v10 offset:8192
  ds_read_b64_tr_b16 v[82:83], v10 offset:8704
  s_waitcnt lgkmcnt(9)
  v_mfma_f32_32x32x16_bf16 v[112:127], v[84:87], v[132:135], v[112:127]
  v_mfma_f32_4x4x4_16b_bf16 v[32:35], v[132:133], v[46:47], v[32:35]
  v_mfma_f32_4x4x4_16b_bf16 v[40:43], v[134:135], v[46:47], v[40:43]
  s_lshl_b32 s59, s66, 2
  s_add_u32 m0, s59, 132096
  s_add_u32 s58, s65, 4608
  v_xor_b32 v3, 64, v2
  buffer_load_dwordx4 v3, s[32:35], s58 offen lds
  ds_read_b128 v[148:151], v49 offset:0
  ds_read_b64_tr_b16 v[84:85], v11 offset:8192
  ds_read_b64_tr_b16 v[86:87], v11 offset:8704
  s_waitcnt lgkmcnt(9)
  v_mfma_f32_32x32x16_bf16 v[112:127], v[88:91], v[136:139], v[112:127]
  v_mfma_f32_4x4x4_16b_bf16 v[32:35], v[136:137], v[46:47], v[32:35]
  v_mfma_f32_4x4x4_16b_bf16 v[40:43], v[138:139], v[46:47], v[40:43]
  s_lshl_b32 s59, s66, 2
  s_add_u32 m0, s59, 133120
  s_add_u32 s58, s65, 8704
  v_xor_b32 v3, 128, v2
  buffer_load_dwordx4 v3, s[32:35], s58 offen lds
  ds_read_b128 v[152:155], v50 offset:0
  ds_read_b64_tr_b16 v[88:89], v12 offset:8192
  ds_read_b64_tr_b16 v[90:91], v12 offset:8704
  s_waitcnt lgkmcnt(9)
  v_mfma_f32_32x32x16_bf16 v[112:127], v[92:95], v[140:143], v[112:127]
  v_mfma_f32_4x4x4_16b_bf16 v[32:35], v[140:141], v[46:47], v[32:35]
  v_mfma_f32_4x4x4_16b_bf16 v[40:43], v[142:143], v[46:47], v[40:43]
  s_lshl_b32 s59, s66, 2
  s_add_u32 m0, s59, 134144
  s_add_u32 s58, s65, 12800
  v_xor_b32 v3, 192, v2
  buffer_load_dwordx4 v3, s[32:35], s58 offen lds
  ds_read_b128 v[156:159], v51 offset:0
  ds_read_b64_tr_b16 v[92:93], v13 offset:8192
  ds_read_b64_tr_b16 v[94:95], v13 offset:8704
  s_waitcnt lgkmcnt(9)
  v_mfma_f32_32x32x16_bf16 v[112:127], v[80:83], v[144:147], v[112:127]
  v_mfma_f32_16x16x32_bf16 v[28:31], v[80:83], v[24:27], v[28:31]
  v_mfma_f32_4x4x4_16b_bf16 v[32:35], v[144:145], v[46:47], v[32:35]
  v_mfma_f32_4x4x4_16b_bf16 v[40:43], v[146:147], v[46:47], v[40:43]
  s_add_u32 m0, s66, 32768
  s_add_u32 s58, s60, 704512
  buffer_load_dwordx4 v5, s[40:43], s58 offen lds
  s_waitcnt lgkmcnt(6)
  v_mfma_f32_32x32x16_bf16 v[112:127], v[84:87], v[148:151], v[112:127]
  v_mfma_f32_4x4x4_16b_bf16 v[32:35], v[148:149], v[46:47], v[32:35]
  v_mfma_f32_4x4x4_16b_bf16 v[40:43], v[150:151], v[46:47], v[40:43]
  s_add_u32 m0, s66, 40960
  s_add_u32 s58, s60, 880640
  buffer_load_dwordx4 v5, s[40:43], s58 offen lds
  s_add_u32 m0, s66, 49152
  s_add_u32 s58, s60, 1056768
  buffer_load_dwordx4 v5, s[40:43], s58 offen lds
  s_waitcnt lgkmcnt(3)
  v_mfma_f32_32x32x16_bf16 v[112:127], v[88:91], v[152:155], v[112:127]
  v_mfma_f32_4x4x4_16b_bf16 v[32:35], v[152:153], v[46:47], v[32:35]
  v_mfma_f32_4x4x4_16b_bf16 v[40:43], v[154:155], v[46:47], v[40:43]
  s_add_u32 m0, s66, 57344
  s_add_u32 s58, s60, 1232896
  buffer_load_dwordx4 v5, s[40:43], s58 offen lds
  s_waitcnt lgkmcnt(0)
  v_mfma_f32_32x32x16_bf16 v[112:127], v[92:95], v[156:159], v[112:127]
  v_mfma_f32_4x4x4_16b_bf16 v[32:35], v[156:157], v[46:47], v[32:35]
  v_mfma_f32_4x4x4_16b_bf16 v[40:43], v[158:159], v[46:47], v[40:43]
  s_waitcnt vmcnt(8)
  s_barrier
  s_cmp_lg_u32 s3, 6
  s_cbranch_scc1 pfw_19
  s_and_b32 s56, s6, 7
  s_mul_i32 s56, s56, 176128
  s_add_u32 s56, s56, s62
  s_sub_u32 s56, s56, 132096
  v_mul_u32_u24 v45, 2752, v1
  buffer_load_dword v15, v45, s[40:43], s56 offen
  buffer_load_dword v15, v45, s[40:43], s56 offen offset:124
pfw_19:
  ds_read_b128 v[160:163], v6 offset:32768
  ds_read_b64_tr_b16 v[80:81], v10 offset:16384
  ds_read_b64_tr_b16 v[82:83], v10 offset:16896
  ds_read_b128 v[164:167], v7 offset:32768
  ds_read_b64_tr_b16 v[84:85], v11 offset:16384
  ds_read_b64_tr_b16 v[86:87], v11 offset:16896
  ds_read_b128 v[168:171], v8 offset:32768
  ds_read_b64_tr_b16 v[88:89], v12 offset:16384
  ds_read_b64_tr_b16 v[90:91], v12 offset:16896
  ds_read_b128 v[172:175], v9 offset:32768
  ds_read_b64_tr_b16 v[92:93], v13 offset:16384
  ds_read_b64_tr_b16 v[94:95], v13 offset:16896
  s_waitcnt lgkmcnt(9)
  v_mfma_f32_32x32x16_bf16 v[112:127], v[80:83], v[160:163], v[112:127]
  v_mfma_f32_16x16x32_bf16 v[28:31], v[80:83], v[24:27], v[28:31]
  v_mfma_f32_4x4x4_16b_bf16 v[32:35], v[160:161], v[46:47], v[32:35]
  v_mfma_f32_4x4x4_16b_bf16 v[40:43], v[162:163], v[46:47], v[40:43]
  s_lshl_b32 s59, s66, 2
  s_add_u32 m0, s59, 65536
  s_add_u32 s58, s65, 768
  buffer_load_dwordx4 v2, s[32:35], s58 offen lds
  ds_read_b128 v[176:179], v48 offset:32768
  ds_read_b64_tr_b16 v[80:81], v10 offset:24576
  ds_read_b64_tr_b16 v[82:83], v10 offset:25088
  s_waitcnt lgkmcnt(9)
  v_mfma_f32_32x32x16_bf16 v[112:127], v[84:87], v[164:167], v[112:127]
  v_mfma_f32_4x4x4_16b_bf16 v[32:35], v[164:165], v[46:47], v[32:35]
  v_mfma_f32_4x4x4_16b_bf16 v[40:43], v[166:167], v[46:47], v[40:43]
  s_lshl_b32 s59, s66, 2
  s_add_u32 m0, s59, 66560
  s_add_u32 s58, s65, 4864
  v_xor_b32 v3, 64, v2
  buffer_load_dwordx4 v3, s[32:35], s58 offen lds
  ds_read_b128 v[180:183], v49 offset:32768
  ds_read_b64_tr_b16 v[84:85], v11 offset:24576
  ds_read_b64_tr_b16 v[86:87], v11 offset:25088
  s_waitcnt lgkmcnt(9)
  v_mfma_f32_32x32x16_bf16 v[112:127], v[88:91], v[168:171], v[112:127]
  v_mfma_f32_4x4x4_16b_bf16 v[32:35], v[168:169], v[46:47], v[32:35]
  v_mfma_f32_4x4x4_16b_bf16 v[40:43], v[170:171], v[46:47], v[40:43]
  s_lshl_b32 s59, s66, 2
  s_add_u32 m0, s59, 67584
  s_add_u32 s58, s65, 8960
  v_xor_b32 v3, 128, v2
  buffer_load_dwordx4 v3, s[32:35], s58 offen lds
  ds_read_b128 v[184:187], v50 offset:32768
  ds_read_b64_tr_b16 v[88:89], v12 offset:24576
  ds_read_b64_tr_b16 v[90:91], v12 offset:25088
  s_waitcnt lgkmcnt(9)
  v_mfma_f32_32x32x16_bf16 v[112:127], v[92:95], v[172:175], v[112:127]
  v_mfma_f32_4x4x4_16b_bf16 v[32:35], v[172:173], v[46:47], v[32:35]
  v_mfma_f32_4x4x4_16b_bf16 v[40:43], v[174:175], v[46:47], v[40:43]
  s_lshl_b32 s59, s66, 2
  s_add_u32 m0, s59, 68608
  s_add_u32 s58, s65, 13056
  v_xor_b32 v3, 192, v2
  buffer_load_dwordx4 v3, s[32:35], s58 offen lds
  ds_read_b128 v[188:191], v51 offset:32768
  ds_read_b64_tr_b16 v[92:93], v13 offset:24576
  ds_read_b64_tr_b16 v[94:95], v13 offset:25088
  s_waitcnt lgkmcnt(9)
  v_mfma_f32_32x32x16_bf16 v[112:127], v[80:83], v[176:179], v[112:127]
  v_mfma_f32_16x16x32_bf16 v[28:31], v[80:83], v[24:27], v[28:31]
  v_mfma_f32_4x4x4_16b_bf16 v[32:35], v[176:177], v[46:47], v[32:35]
  v_mfma_f32_4x4x4_16b_bf16 v[40:43], v[178:179], v[46:47], v[40:43]
  s_add_u32 m0, s66, 0
  s_add_u32 s58, s61, 0
  buffer_load_dwordx4 v5, s[44:47], s58 offen lds
  s_waitcnt lgkmcnt(6)
  v_mfma_f32_32x32x16_bf16 v[112:127], v[84:87], v[180:183], v[112:127]
  v_mfma_f32_4x4x4_16b_bf16 v[32:35], v[180:181], v[46:47], v[32:35]
  v_mfma_f32_4x4x4_16b_bf16 v[40:43], v[182:183], v[46:47], v[40:43]
  s_add_u32 m0, s66, 8192
  s_add_u32 s58, s61, 176128
  buffer_load_dwordx4 v5, s[44:47], s58 offen lds
  s_waitcnt lgkmcnt(3)
  v_mfma_f32_32x32x16_bf16 v[112:127], v[88:91], v[184:187], v[112:127]
  v_mfma_f32_4x4x4_16b_bf16 v[32:35], v[184:185], v[46:47], v[32:35]
  v_mfma_f32_4x4x4_16b_bf16 v[40:43], v[186:187], v[46:47], v[40:43]
  s_waitcnt lgkmcnt(0)
  v_mfma_f32_32x32x16_bf16 v[112:127], v[92:95], v[188:191], v[112:127]
  v_mfma_f32_4x4x4_16b_bf16 v[32:35], v[188:189], v[46:47], v[32:35]
  v_mfma_f32_4x4x4_16b_bf16 v[40:43], v[190:191], v[46:47], v[40:43]
  s_waitcnt vmcnt(8)
  s_barrier
  v_add_u32 v6, 0x10000, v6
  v_add_u32 v7, 0x10000, v7
  v_add_u32 v8, 0x10000, v8
  v_add_u32 v9, 0x10000, v9
  v_add_u32 v48, 0x10000, v48
  v_add_u32 v49, 0x10000, v49
  v_add_u32 v50, 0x10000, v50
  v_add_u32 v51, 0x10000, v51
  ds_read_b128 v[192:195], v6 offset:0
  ds_read_b64_tr_b16 v[80:81], v10 offset:32768
  ds_read_b64_tr_b16 v[82:83], v10 offset:33280
  ds_read_b128 v[196:199], v7 offset:0
  ds_read_b64_tr_b16 v[84:85], v11 offset:32768
  ds_read_b64_tr_b16 v[86:87], v11 offset:33280
  ds_read_b128 v[200:203], v8 offset:0
  ds_read_b64_tr_b16 v[88:89], v12 offset:32768
  ds_read_b64_tr_b16 v[90:91], v12 offset:33280
  ds_read_b128 v[204:207], v9 offset:0
  ds_read_b64_tr_b16 v[92:93], v13 offset:32768
  ds_read_b64_tr_b16 v[94:95], v13 offset:33280
  s_waitcnt lgkmcnt(9)
  v_mfma_f32_32x32x16_bf16 v[112:127], v[80:83], v[192:195], v[112:127]
  v_mfma_f32_16x16x32_bf16 v[28:31], v[80:83], v[24:27], v[28:31]
  v_mfma_f32_4x4x4_16b_bf16 v[32:35], v[192:193], v[46:47], v[32:35]
  v_mfma_f32_4x4x4_16b_bf16 v[40:43], v[194:195], v[46:47], v[40:43]
  s_add_u32 m0, s66, 16384
  s_add_u32 s58, s61, 352256
  buffer_load_dwordx4 v5, s[44:47], s58 offen lds
  ds_read_b128 v[208:211], v48 offset:0
  ds_read_b64_tr_b16 v[80:81], v10 offset:40960
  ds_read_b64_tr_b16 v[82:83], v10 offset:41472
  s_waitcnt lgkmcnt(9)
  v_mfma_f32_32x32x16_bf16 v[112:127], v[84:87], v[196:199], v[112:127]
  v_mfma_f32_4x4x4_16b_bf16 v[32:35], v[196:197], v[46:47], v[32:35]
  v_mfma_f32_4x4x4_16b_bf16 v[40:43], v[198:199], v[46:47], v[40:43]
  s_add_u32 m0, s66, 24576
  s_add_u32 s58, s61, 528384
  buffer_load_dwordx4 v5, s[44:47], s58 offen lds
  ds_read_b128 v[212:215], v49 offset:0
  ds_read_b64_tr_b16 v[84:85], v11 offset:40960
  ds_read_b64_tr_b16 v[86:87], v11 offset:41472
  s_waitcnt lgkmcnt(9)
  v_mfma_f32_32x32x16_bf16 v[112:127], v[88:91], v[200:203], v[112:127]
  v_mfma_f32_4x4x4_16b_bf16 v[32:35], v[200:201], v[46:47], v[32:35]
  v_mfma_f32_4x4x4_16b_bf16 v[40:43], v[202:203], v[46:47], v[40:43]
  s_add_u32 m0, s66, 98304
  s_add_u32 s58, s61, 704512
  buffer_load_dwordx4 v5, s[44:47], s58 offen lds
  ds_read_b128 v[216:219], v50 offset:0
  ds_read_b64_tr_b16 v[88:89], v12 offset:40960
  ds_read_b64_tr_b16 v[90:91], v12 offset:41472
  s_waitcnt lgkmcnt(9)
  v_mfma_f32_32x32x16_bf16 v[112:127], v[92:95], v[204:207], v[112:127]
  v_mfma_f32_4x4x4_16b_bf16 v[32:35], v[204:205], v[46:47], v[32:35]
  v_mfma_f32_4x4x4_16b_bf16 v[40:43], v[206:207], v[46:47], v[40:43]
  s_add_u32 m0, s66, 106496
  s_add_u32 s58, s61, 880640
  buffer_load_dwordx4 v5, s[44:47], s58 offen lds
  ds_read_b128 v[220:223], v51 offset:0
  ds_read_b64_tr_b16 v[92:93], v13 offset:40960
  ds_read_b64_tr_b16 v[94:95], v13 offset:41472
  s_waitcnt lgkmcnt(9)
  v_mfma_f32_32x32x16_bf16 v[112:127], v[80:83], v[208:211], v[112:127]
  v_mfma_f32_16x16x32_bf16 v[28:31], v[80:83], v[24:27], v[28:31]
  v_mfma_f32_4x4x4_16b_bf16 v[32:35], v[208:209], v[46:47], v[32:35]
  v_mfma_f32_4x4x4_16b_bf16 v[40:43], v[210:211], v[46:47], v[40:43]
  s_add_u32 m0, s66, 114688
  s_add_u32 s58, s61, 1056768
  buffer_load_dwordx4 v5, s[44:47], s58 offen lds
  s_waitcnt lgkmcnt(6)
  v_mfma_f32_32x32x16_bf16 v[112:127], v[84:87], v[212:215], v[112:127]
  v_mfma_f32_4x4x4_16b_bf16 v[32:35], v[212:213], v[46:47], v[32:35]
  v_mfma_f32_4x4x4_16b_bf16 v[40:43], v[214:215], v[46:47], v[40:43]
  s_add_u32 m0, s66, 122880
  s_add_u32 s58, s61, 1232896
  buffer_load_dwordx4 v5, s[44:47], s58 offen lds
  s_waitcnt lgkmcnt(3)
  v_mfma_f32_32x32x16_bf16 v[112:127], v[88:91], v[216:219], v[112:127]
  v_mfma_f32_4x4x4_16b_bf16 v[32:35], v[216:217], v[46:47], v[32:35]
  v_mfma_f32_4x4x4_16b_bf16 v[40:43], v[218:219], v[46:47], v[40:43]
  s_waitcnt lgkmcnt(0)
  v_mfma_f32_32x32x16_bf16 v[112:127], v[92:95], v[220:223], v[112:127]
  v_mfma_f32_4x4x4_16b_bf16 v[32:35], v[220:221], v[46:47], v[32:35]
  v_mfma_f32_4x4x4_16b_bf16 v[40:43], v[222:223], v[46:47], v[40:43]
  s_waitcnt vmcnt(8)
  s_barrier
  s_cmp_lg_u32 s3, 7
  s_cbranch_scc1 pfw_20
  s_and_b32 s56, s6, 7
  s_mul_i32 s56, s56, 176128
  s_add_u32 s56, s56, s63
  s_sub_u32 s56, s56, 154112
  v_mul_u32_u24 v45, 2752, v1
  buffer_load_dword v15, v45, s[44:47], s56 offen
  buffer_load_dword v15, v45, s[44:47], s56 offen offset:124
pfw_20:
  v_add_u32 v6, 0xffff0000, v6
  v_add_u32 v7, 0xffff0000, v7
  v_add_u32 v8, 0xffff0000, v8
  v_add_u32 v9, 0xffff0000, v9
  v_add_u32 v48, 0xffff0000, v48
  v_add_u32 v49, 0xffff0000, v49
  v_add_u32 v50, 0xffff0000, v50
  v_add_u32 v51, 0xffff0000, v51
  ds_read_b128 v[224:227], v6 offset:0
  ds_read_b64_tr_b16 v[80:81], v10 offset:49152
  ds_read_b64_tr_b16 v[82:83], v10 offset:49664
  ds_read_b128 v[228:231], v7 offset:0
  ds_read_b64_tr_b16 v[84:85], v11 offset:49152
  ds_read_b64_tr_b16 v[86:87], v11 offset:49664
  ds_read_b128 v[232:235], v8 offset:0
  ds_read_b64_tr_b16 v[88:89], v12 offset:49152
  ds_read_b64_tr_b16 v[90:91], v12 offset:49664
  ds_read_b128 v[236:239], v9 offset:0
  ds_read_b64_tr_b16 v[92:93], v13 offset:49152
  ds_read_b64_tr_b16 v[94:95], v13 offset:49664
  s_waitcnt lgkmcnt(9)
  v_mfma_f32_32x32x16_bf16 v[112:127], v[80:83], v[224:227], v[112:127]
  v_mfma_f32_16x16x32_bf16 v[28:31], v[80:83], v[24:27], v[28:31]
  v_mfma_f32_4x4x4_16b_bf16 v[32:35], v[224:225], v[46:47], v[32:35]
  v_mfma_f32_4x4x4_16b_bf16 v[40:43], v[226:227], v[46:47], v[40:43]
  ds_read_b128 v[240:243], v48 offset:0
  ds_read_b64_tr_b16 v[80:81], v10 offset:57344
  ds_read_b64_tr_b16 v[82:83], v10 offset:57856
  s_waitcnt lgkmcnt(9)
  v_mfma_f32_32x32x16_bf16 v[112:127], v[84:87], v[228:231], v[112:127]
  v_mfma_f32_4x4x4_16b_bf16 v[32:35], v[228:229], v[46:47], v[32:35]
  v_mfma_f32_4x4x4_16b_bf16 v[40:43], v[230:231], v[46:47], v[40:43]
  ds_read_b128 v[244:247], v49 offset:0
  ds_read_b64_tr_b16 v[84:85], v11 offset:57344
  ds_read_b64_tr_b16 v[86:87], v11 offset:57856
  s_waitcnt lgkmcnt(9)
  v_mfma_f32_32x32x16_bf16 v[112:127], v[88:91], v[232:235], v[112:127]
  v_mfma_f32_4x4x4_16b_bf16 v[32:35], v[232:233], v[46:47], v[32:35]
  v_mfma_f32_4x4x4_16b_bf16 v[40:43], v[234:235], v[46:47], v[40:43]
  ds_read_b128 v[248:251], v50 offset:0
  ds_read_b64_tr_b16 v[88:89], v12 offset:57344
  ds_read_b64_tr_b16 v[90:91], v12 offset:57856
  s_waitcnt lgkmcnt(9)
  v_mfma_f32_32x32x16_bf16 v[112:127], v[92:95], v[236:239], v[112:127]
  v_mfma_f32_4x4x4_16b_bf16 v[32:35], v[236:237], v[46:47], v[32:35]
  v_mfma_f32_4x4x4_16b_bf16 v[40:43], v[238:239], v[46:47], v[40:43]
  ds_read_b128 v[252:255], v51 offset:0
  ds_read_b64_tr_b16 v[92:93], v13 offset:57344
  ds_read_b64_tr_b16 v[94:95], v13 offset:57856
  s_waitcnt lgkmcnt(9)
  v_mfma_f32_32x32x16_bf16 v[112:127], v[80:83], v[240:243], v[112:127]
  v_mfma_f32_16x16x32_bf16 v[28:31], v[80:83], v[24:27], v[28:31]
  v_mfma_f32_4x4x4_16b_bf16 v[32:35], v[240:241], v[46:47], v[32:35]
  v_mfma_f32_4x4x4_16b_bf16 v[40:43], v[242:243], v[46:47], v[40:43]
  s_waitcnt lgkmcnt(6)
  v_mfma_f32_32x32x16_bf16 v[112:127], v[84:87], v[244:247], v[112:127]
  v_mfma_f32_4x4x4_16b_bf16 v[32:35], v[244:245], v[46:47], v[32:35]
  v_mfma_f32_4x4x4_16b_bf16 v[40:43], v[246:247], v[46:47], v[40:43]
  s_waitcnt lgkmcnt(3)
  v_mfma_f32_32x32x16_bf16 v[112:127], v[88:91], v[248:251], v[112:127]
  v_mfma_f32_4x4x4_16b_bf16 v[32:35], v[248:249], v[46:47], v[32:35]
  v_mfma_f32_4x4x4_16b_bf16 v[40:43], v[250:251], v[46:47], v[40:43]
  s_waitcnt lgkmcnt(0)
  v_mfma_f32_32x32x16_bf16 v[112:127], v[92:95], v[252:255], v[112:127]
  v_mfma_f32_4x4x4_16b_bf16 v[32:35], v[252:253], v[46:47], v[32:35]
  v_mfma_f32_4x4x4_16b_bf16 v[40:43], v[254:255], v[46:47], v[40:43]
su_14_J:
  s_nop 7
  s_mov_b64 exec, s[74:75]
  ds_write_b32 v22, v28 offset:0
  ds_write_b32 v22, v29 offset:16
  ds_write_b32 v22, v30 offset:32
  ds_write_b32 v22, v31 offset:48
  s_mov_b64 exec, -1
  v_add_f32 v32, v32, v40
  v_add_f32 v33, v33, v41
  v_add_f32 v34, v34, v42
  v_add_f32 v35, v35, v43
  v_and_b32 v36, 3, v1
  v_cmp_eq_u32 vcc, 1, v36
  v_cmp_eq_u32 s[82:83], 2, v36
  v_cmp_eq_u32 s[70:71], 3, v36
  s_nop 1
  v_cndmask_b32 v32, v32, v33, vcc
  v_cndmask_b32 v32, v32, v34, s[82:83]
  v_cndmask_b32 v32, v32, v35, s[70:71]
  v_mov_b32 v33, v32
  s_nop 1
  v_permlane32_swap_b32 v32, v33
  v_add_f32 v32, v32, v33
  v_and_b32 v36, 31, v1
  v_lshlrev_b32 v3, 4, v36
  s_lshl_b32 s56, s4, 5
  v_add_u32 v36, s56, v36
  v_lshlrev_b32 v36, 2, v36
  v_add_u32 v36, 137216, v36
  s_lshl_b32 s56, s5, 9
  v_add_u32 v37, s56, v36
  ds_write_b32 v37, v32
  s_add_u32 s56, s56, 131072
  v_add_u32 v3, s56, v3
  s_waitcnt vmcnt(0) lgkmcnt(0)
  s_barrier
  ds_read_b32 v38, v36
  ds_read_b32 v39, v36 offset:512
  ds_read_b64_tr_b16 v[80:81], v10 offset:0
  ds_read_b64_tr_b16 v[82:83], v10 offset:512
  ds_read_b64_tr_b16 v[84:85], v11 offset:0
  ds_read_b64_tr_b16 v[86:87], v11 offset:512
  ds_read_b64_tr_b16 v[88:89], v12 offset:0
  ds_read_b64_tr_b16 v[90:91], v12 offset:512
  ds_read_b128 v[40:43], v3 offset:0
  s_waitcnt lgkmcnt(0)
  v_add_f32 v40, v40, v41
  v_add_f32 v42, v42, v43
  v_add_f32 v44, v40, v42
  ds_write_b32 v14, v44
  s_cmp_lg_u32 s3, 4
  s_cbranch_scc1 pfw_21
  s_and_b32 s56, s6, 7
  s_mul_i32 s56, s56, 176128
  s_add_u32 s56, s56, s64
  s_sub_u32 s56, s56, 88064
  v_mul_u32_u24 v16, 2752, v1
  buffer_load_dword v15, v16, s[40:43], s56 offen
  buffer_load_dword v15, v16, s[40:43], s56 offen offset:124
pfw_21:
  s_cmp_lg_u32 s3, 5
  s_cbranch_scc1 pfw_22
  s_and_b32 s56, s6, 7
  s_mul_i32 s56, s56, 176128
  s_add_u32 s56, s56, s73
  s_sub_u32 s56, s56, 110080
  v_mul_u32_u24 v16, 2752, v1
  buffer_load_dword v15, v16, s[44:47], s56 offen
  buffer_load_dword v15, v16, s[44:47], s56 offen offset:124
pfw_22:
  v_mul_f32 v38, 0x3b000000, v38
  v_mul_f32 v39, 0x3b000000, v39
  v_fma_f32 v39, -v38, v38, v39
  v_max_f32 v39, 0, v39
  v_add_f32 v39, 0x3727c5ac, v39
  v_sub_f32 v18, 0, v38
  v_rsq_f32 v19, v39
  v_mov_b32 v20, v39
  s_nop 0
  v_mul_f32 v17, 0xc0135761, v19
  v_mul_f32 v2, v19, v19
  v_mul_f32 v2, v2, v19
  v_mul_f32 v2, 0xbdd2d3e8, v2
  ds_read_b64_tr_b16 v[92:93], v13 offset:0
  ds_read_b64_tr_b16 v[94:95], v13 offset:512
  v_mfma_f32_32x32x16_bf16 v[96:111], v[80:83], v[128:131], 0
  v_mfma_f32_16x16x32_bf16 v[28:31], v[80:83], v[24:27], 0
  ds_read_b128 v[36:39], v21 offset:0
  ds_read_b128 v[40:43], v21 offset:32
  ds_read_b64_tr_b16 v[80:81], v10 offset:8192
  ds_read_b64_tr_b16 v[82:83], v10 offset:8704
  v_mfma_f32_32x32x16_bf16 v[96:111], v[84:87], v[132:135], v[96:111]
  s_add_u32 m0, s66, 32768
  s_add_u32 s58, s62, 0
  buffer_load_dwordx4 v5, s[40:43], s58 offen lds
  ds_read_b64_tr_b16 v[84:85], v11 offset:8192
  ds_read_b64_tr_b16 v[86:87], v11 offset:8704
  v_mfma_f32_32x32x16_bf16 v[96:111], v[88:91], v[136:139], v[96:111]
  ds_read_b64_tr_b16 v[88:89], v12 offset:8192
  ds_read_b64_tr_b16 v[90:91], v12 offset:8704
  s_waitcnt lgkmcnt(8)
  v_mfma_f32_32x32x16_bf16 v[96:111], v[92:95], v[140:143], v[96:111]
  s_add_u32 m0, s66, 40960
  s_add_u32 s58, s62, 176128
  buffer_load_dwordx4 v5, s[40:43], s58 offen lds
  s_waitcnt lgkmcnt(7)
  v_fma_f32 v44, v36, v18, v112
  v_fma_f32 v45, v37, v18, v113
  v_fma_f32 v46, v38, v18, v114
  ds_read_b64_tr_b16 v[92:93], v13 offset:8192
  ds_read_b64_tr_b16 v[94:95], v13 offset:8704
  s_waitcnt lgkmcnt(6)
  v_mfma_f32_32x32x16_bf16 v[96:111], v[80:83], v[144:147], v[96:111]
  v_mfma_f32_16x16x32_bf16 v[28:31], v[80:83], v[24:27], v[28:31]
  v_fma_f32 v47, v39, v18, v115
  ds_read_b128 v[36:39], v21 offset:64
  v_mul_f32 v48, v44, v44
  ds_read_b64_tr_b16 v[80:81], v10 offset:16384
  ds_read_b64_tr_b16 v[82:83], v10 offset:16896
  s_waitcnt lgkmcnt(7)
  v_mfma_f32_32x32x16_bf16 v[96:111], v[84:87], v[148:151], v[96:111]
  s_add_u32 m0, s66, 49152
  s_add_u32 s58, s62, 352256
  buffer_load_dwordx4 v5, s[40:43], s58 offen lds
  v_mul_f32 v49, v45, v45
  v_mul_f32 v50, v46, v46
  v_mul_f32 v51, v47, v47
  v_fma_f32 v48, v48, v2, v17
  ds_read_b64_tr_b16 v[84:85], v11 offset:16384
  ds_read_b64_tr_b16 v[86:87], v11 offset:16896
  s_waitcnt lgkmcnt(7)
  v_mfma_f32_32x32x16_bf16 v[96:111], v[88:91], v[152:155], v[96:111]
  v_fma_f32 v49, v49, v2, v17
  v_fma_f32 v50, v50, v2, v17
  v_fma_f32 v51, v51, v2, v17
  ds_read_b64_tr_b16 v[88:89], v12 offset:16384
  ds_read_b64_tr_b16 v[90:91], v12 offset:16896
  s_waitcnt lgkmcnt(7)
  v_mfma_f32_32x32x16_bf16 v[96:111], v[92:95], v[156:159], v[96:111]
  s_add_u32 m0, s66, 57344
  s_add_u32 s58, s62, 528384
  buffer_load_dwordx4 v5, s[40:43], s58 offen lds
  v_mul_f32 v48, v48, v44
  v_mul_f32 v49, v49, v45
  v_mul_f32 v50, v50, v46
  v_mul_f32 v51, v51, v47
  ds_read_b64_tr_b16 v[92:93], v13 offset:16384
  ds_read_b64_tr_b16 v[94:95], v13 offset:16896
  s_waitcnt lgkmcnt(6)
  v_mfma_f32_32x32x16_bf16 v[96:111], v[80:83], v[160:163], v[96:111]
  v_mfma_f32_16x16x32_bf16 v[28:31], v[80:83], v[24:27], v[28:31]
  v_exp_f32 v48, v48
  v_exp_f32 v49, v49
  ds_read_b64_tr_b16 v[80:81], v10 offset:24576
  ds_read_b64_tr_b16 v[82:83], v10 offset:25088
  s_waitcnt lgkmcnt(6)
  v_mfma_f32_32x32x16_bf16 v[96:111], v[84:87], v[164:167], v[96:111]
  s_add_u32 m0, s66, 65536
  s_add_u32 s58, s62, 704512
  buffer_load_dwordx4 v5, s[40:43], s58 offen lds
  v_exp_f32 v50, v50
  v_exp_f32 v51, v51
  ds_read_b64_tr_b16 v[84:85], v11 offset:24576
  ds_read_b64_tr_b16 v[86:87], v11 offset:25088
  s_waitcnt lgkmcnt(6)
  v_mfma_f32_32x32x16_bf16 v[96:111], v[88:91], v[168:171], v[96:111]
  v_fma_f32 v48, v48, v20, v20
  v_fma_f32 v49, v49, v20, v20
  v_fma_f32 v50, v50, v20, v20
  ds_read_b64_tr_b16 v[88:89], v12 offset:24576
  ds_read_b64_tr_b16 v[90:91], v12 offset:25088
  s_waitcnt lgkmcnt(6)
  v_mfma_f32_32x32x16_bf16 v[96:111], v[92:95], v[172:175], v[96:111]
  s_add_u32 m0, s66, 73728
  s_add_u32 s58, s62, 880640
  buffer_load_dwordx4 v5, s[40:43], s58 offen lds
  v_fma_f32 v51, v51, v20, v20
  v_rcp_f32 v48, v48
  ds_read_b64_tr_b16 v[92:93], v13 offset:24576
  ds_read_b64_tr_b16 v[94:95], v13 offset:25088
  s_waitcnt lgkmcnt(6)
  v_mfma_f32_32x32x16_bf16 v[96:111], v[80:83], v[176:179], v[96:111]
  v_mfma_f32_16x16x32_bf16 v[28:31], v[80:83], v[24:27], v[28:31]
  v_rcp_f32 v49, v49
  v_rcp_f32 v50, v50
  v_add_u32 v10, 0x10000, v10
  v_add_u32 v11, 0x10000, v11
  v_add_u32 v12, 0x10000, v12
  v_add_u32 v13, 0x10000, v13
  ds_read_b64_tr_b16 v[80:81], v10 offset:32768
  ds_read_b64_tr_b16 v[82:83], v10 offset:33280
  s_waitcnt lgkmcnt(6)
  v_mfma_f32_32x32x16_bf16 v[96:111], v[84:87], v[180:183], v[96:111]
  s_add_u32 m0, s66, 81920
  s_add_u32 s58, s62, 1056768
  buffer_load_dwordx4 v5, s[40:43], s58 offen lds
  v_rcp_f32 v51, v51
  v_mul_f32 v48, v48, v44
  ds_read_b64_tr_b16 v[84:85], v11 offset:32768
  ds_read_b64_tr_b16 v[86:87], v11 offset:33280
  s_waitcnt lgkmcnt(6)
  v_mfma_f32_32x32x16_bf16 v[96:111], v[88:91], v[184:187], v[96:111]
  v_mul_f32 v49, v49, v45
  v_mul_f32 v50, v50, v46
  v_mul_f32 v51, v51, v47
  ds_read_b64_tr_b16 v[88:89], v12 offset:32768
  ds_read_b64_tr_b16 v[90:91], v12 offset:33280
  s_waitcnt lgkmcnt(6)
  v_mfma_f32_32x32x16_bf16 v[96:111], v[92:95], v[188:191], v[96:111]
  s_add_u32 m0, s66, 90112
  s_add_u32 s58, s62, 1232896
  buffer_load_dwordx4 v5, s[40:43], s58 offen lds
  v_fma_f32 v44, v40, v18, v116
  v_fma_f32 v45, v41, v18, v117
  v_fma_f32 v46, v42, v18, v118
  v_fma_f32 v47, v43, v18, v119
  ds_read_b64_tr_b16 v[92:93], v13 offset:32768
  ds_read_b64_tr_b16 v[94:95], v13 offset:33280
  s_waitcnt lgkmcnt(6)
  v_mfma_f32_32x32x16_bf16 v[96:111], v[80:83], v[192:195], v[96:111]
  v_mfma_f32_16x16x32_bf16 v[28:31], v[80:83], v[24:27], v[28:31]
  ds_read_b128 v[40:43], v21 offset:96
  v_mul_f32 v52, v44, v44
  v_mul_f32 v53, v45, v45
  ds_read_b64_tr_b16 v[80:81], v10 offset:40960
  ds_read_b64_tr_b16 v[82:83], v10 offset:41472
  s_waitcnt lgkmcnt(7)
  v_mfma_f32_32x32x16_bf16 v[96:111], v[84:87], v[196:199], v[96:111]
  v_mul_f32 v54, v46, v46
  v_mul_f32 v55, v47, v47
  v_fma_f32 v52, v52, v2, v17
  v_fma_f32 v53, v53, v2, v17
  ds_read_b64_tr_b16 v[84:85], v11 offset:40960
  ds_read_b64_tr_b16 v[86:87], v11 offset:41472
  s_waitcnt lgkmcnt(7)
  v_mfma_f32_32x32x16_bf16 v[96:111], v[88:91], v[200:203], v[96:111]
  v_fma_f32 v54, v54, v2, v17
  v_fma_f32 v55, v55, v2, v17
  v_mul_f32 v52, v52, v44
  ds_read_b64_tr_b16 v[88:89], v12 offset:40960
  ds_read_b64_tr_b16 v[90:91], v12 offset:41472
  s_waitcnt lgkmcnt(7)
  v_mfma_f32_32x32x16_bf16 v[96:111], v[92:95], v[204:207], v[96:111]
  v_mul_f32 v53, v53, v45
  v_mul_f32 v54, v54, v46
  v_mul_f32 v55, v55, v47
  ds_read_b64_tr_b16 v[92:93], v13 offset:40960
  ds_read_b64_tr_b16 v[94:95], v13 offset:41472
  s_waitcnt lgkmcnt(6)
  v_mfma_f32_32x32x16_bf16 v[96:111], v[80:83], v[208:211], v[96:111]
  v_mfma_f32_16x16x32_bf16 v[28:31], v[80:83], v[24:27], v[28:31]
  v_exp_f32 v52, v52
  v_exp_f32 v53, v53
  ds_read_b64_tr_b16 v[80:81], v10 offset:49152
  ds_read_b64_tr_b16 v[82:83], v10 offset:49664
  s_waitcnt lgkmcnt(6)
  v_mfma_f32_32x32x16_bf16 v[96:111], v[84:87], v[212:215], v[96:111]
  v_exp_f32 v54, v54
  v_exp_f32 v55, v55
  ds_read_b64_tr_b16 v[84:85], v11 offset:49152
  ds_read_b64_tr_b16 v[86:87], v11 offset:49664
  s_waitcnt lgkmcnt(6)
  v_mfma_f32_32x32x16_bf16 v[96:111], v[88:91], v[216:219], v[96:111]
  v_fma_f32 v52, v52, v20, v20
  v_fma_f32 v53, v53, v20, v20
  v_fma_f32 v54, v54, v20, v20
  ds_read_b64_tr_b16 v[88:89], v12 offset:49152
  ds_read_b64_tr_b16 v[90:91], v12 offset:49664
  s_waitcnt lgkmcnt(6)
  v_mfma_f32_32x32x16_bf16 v[96:111], v[92:95], v[220:223], v[96:111]
  v_fma_f32 v55, v55, v20, v20
  v_rcp_f32 v52, v52
  ds_read_b64_tr_b16 v[92:93], v13 offset:49152
  ds_read_b64_tr_b16 v[94:95], v13 offset:49664
  s_waitcnt lgkmcnt(6)
  v_mfma_f32_32x32x16_bf16 v[96:111], v[80:83], v[224:227], v[96:111]
  v_mfma_f32_16x16x32_bf16 v[28:31], v[80:83], v[24:27], v[28:31]
  v_rcp_f32 v53, v53
  v_rcp_f32 v54, v54
  ds_read_b64_tr_b16 v[80:81], v10 offset:57344
  ds_read_b64_tr_b16 v[82:83], v10 offset:57856
  s_waitcnt lgkmcnt(6)
  v_mfma_f32_32x32x16_bf16 v[96:111], v[84:87], v[228:231], v[96:111]
  v_rcp_f32 v55, v55
  v_mul_f32 v52, v52, v44
  v_mul_f32 v53, v53, v45
  ds_read_b64_tr_b16 v[84:85], v11 offset:57344
  ds_read_b64_tr_b16 v[86:87], v11 offset:57856
  s_waitcnt lgkmcnt(6)
  v_mfma_f32_32x32x16_bf16 v[96:111], v[88:91], v[232:235], v[96:111]
  v_mul_f32 v54, v54, v46
  v_mul_f32 v55, v55, v47
  v_fma_f32 v56, v36, v18, v120
  ds_read_b64_tr_b16 v[88:89], v12 offset:57344
  ds_read_b64_tr_b16 v[90:91], v12 offset:57856
  s_waitcnt lgkmcnt(6)
  v_mfma_f32_32x32x16_bf16 v[96:111], v[92:95], v[236:239], v[96:111]
  v_fma_f32 v57, v37, v18, v121
  v_fma_f32 v58, v38, v18, v122
  v_fma_f32 v59, v39, v18, v123
  v_fma_f32 v60, v40, v18, v124
  ds_read_b64_tr_b16 v[92:93], v13 offset:57344
  ds_read_b64_tr_b16 v[94:95], v13 offset:57856
  s_waitcnt lgkmcnt(6)
  v_mfma_f32_32x32x16_bf16 v[96:111], v[80:83], v[240:243], v[96:111]
  v_mfma_f32_16x16x32_bf16 v[28:31], v[80:83], v[24:27], v[28:31]
  v_fma_f32 v61, v41, v18, v125
  v_fma_f32 v62, v42, v18, v126
  v_fma_f32 v63, v43, v18, v127
  s_waitcnt lgkmcnt(4)
  v_mfma_f32_32x32x16_bf16 v[96:111], v[84:87], v[244:247], v[96:111]
  s_nop 3
  s_mov_b64 exec, s[74:75]
  ds_write_b32 v22, v28 offset:1024
  ds_write_b32 v22, v29 offset:1040
  ds_write_b32 v22, v30 offset:1056
  ds_write_b32 v22, v31 offset:1072
  s_mov_b64 exec, -1
  v_add_u32 v10, 0xffff8000, v10
  v_add_u32 v11, 0xffff8000, v11
  v_add_u32 v12, 0xffff8000, v12
  v_add_u32 v13, 0xffff8000, v13
  s_waitcnt vmcnt(0) lgkmcnt(0)
  s_barrier
  ds_read_b64_tr_b16 v[80:81], v10 offset:0
  ds_read_b64_tr_b16 v[82:83], v10 offset:512
  ds_read_b64_tr_b16 v[84:85], v11 offset:0
  ds_read_b64_tr_b16 v[86:87], v11 offset:512
  ds_read_b128 v[40:43], v3 offset:1024
  v_mfma_f32_32x32x16_bf16 v[96:111], v[88:91], v[248:251], v[96:111]
  ds_read_b64_tr_b16 v[88:89], v12 offset:0
  ds_read_b64_tr_b16 v[90:91], v12 offset:512
  v_mfma_f32_32x32x16_bf16 v[96:111], v[92:95], v[252:255], v[96:111]
  s_waitcnt lgkmcnt(2)
  v_add_f32 v40, v40, v41
  v_add_f32 v42, v42, v43
  v_add_f32 v44, v40, v42
  ds_write_b32 v14, v44
  ds_read_b64_tr_b16 v[92:93], v13 offset:0
  ds_read_b64_tr_b16 v[94:95], v13 offset:512
  v_mfma_f32_32x32x16_bf16 v[112:127], v[80:83], v[128:131], 0
  v_mfma_f32_16x16x32_bf16 v[28:31], v[80:83], v[24:27], 0
  v_mul_f32 v44, v56, v56
  v_mul_f32 v45, v57, v57
  v_mul_f32 v46, v58, v58
  v_mul_f32 v47, v59, v59
  ds_read_b64_tr_b16 v[80:81], v10 offset:8192
  ds_read_b64_tr_b16 v[82:83], v10 offset:8704
  v_mfma_f32_32x32x16_bf16 v[112:127], v[84:87], v[132:135], v[112:127]
  s_add_u32 m0, s66, 0
  s_add_u32 s58, s63, 0
  buffer_load_dwordx4 v5, s[44:47], s58 offen lds
  v_fma_f32 v44, v44, v2, v17
  v_fma_f32 v45, v45, v2, v17
  v_fma_f32 v46, v46, v2, v17
  v_fma_f32 v47, v47, v2, v17
  ds_read_b64_tr_b16 v[84:85], v11 offset:8192
  ds_read_b64_tr_b16 v[86:87], v11 offset:8704
  s_waitcnt lgkmcnt(7)
  v_mfma_f32_32x32x16_bf16 v[112:127], v[88:91], v[136:139], v[112:127]
  v_mul_f32 v44, v44, v56
  v_mul_f32 v45, v45, v57
  v_mul_f32 v46, v46, v58
  v_mul_f32 v47, v47, v59
  ds_read_b64_tr_b16 v[88:89], v12 offset:8192
  ds_read_b64_tr_b16 v[90:91], v12 offset:8704
  s_waitcnt lgkmcnt(6)
  v_mfma_f32_32x32x16_bf16 v[112:127], v[92:95], v[140:143], v[112:127]
  s_add_u32 m0, s66, 8192
  s_add_u32 s58, s63, 176128
  buffer_load_dwordx4 v5, s[44:47], s58 offen lds
  v_exp_f32 v44, v44
  v_exp_f32 v45, v45
  ds_read_b64_tr_b16 v[92:93], v13 offset:8192
  ds_read_b64_tr_b16 v[94:95], v13 offset:8704
  s_waitcnt lgkmcnt(6)
  v_mfma_f32_32x32x16_bf16 v[112:127], v[80:83], v[144:147], v[112:127]
  v_mfma_f32_16x16x32_bf16 v[28:31], v[80:83], v[24:27], v[28:31]
  v_exp_f32 v46, v46
  v_exp_f32 v47, v47
  ds_read_b64_tr_b16 v[80:81], v10 offset:16384
  ds_read_b64_tr_b16 v[82:83], v10 offset:16896
  s_waitcnt lgkmcnt(6)
  v_mfma_f32_32x32x16_bf16 v[112:127], v[84:87], v[148:151], v[112:127]
  s_add_u32 m0, s66, 16384
  s_add_u32 s58, s63, 352256
  buffer_load_dwordx4 v5, s[44:47], s58 offen lds
  v_fma_f32 v44, v44, v20, v20
  v_fma_f32 v45, v45, v20, v20
  v_fma_f32 v46, v46, v20, v20
  v_fma_f32 v47, v47, v20, v20
  ds_read_b64_tr_b16 v[84:85], v11 offset:16384
  ds_read_b64_tr_b16 v[86:87], v11 offset:16896
  s_waitcnt lgkmcnt(6)
  v_mfma_f32_32x32x16_bf16 v[112:127], v[88:91], v[152:155], v[112:127]
  v_rcp_f32 v44, v44
  v_rcp_f32 v45, v45
  ds_read_b64_tr_b16 v[88:89], v12 offset:16384
  ds_read_b64_tr_b16 v[90:91], v12 offset:16896
  s_waitcnt lgkmcnt(6)
  v_mfma_f32_32x32x16_bf16 v[112:127], v[92:95], v[156:159], v[112:127]
  s_add_u32 m0, s66, 24576
  s_add_u32 s58, s63, 528384
  buffer_load_dwordx4 v5, s[44:47], s58 offen lds
  v_rcp_f32 v46, v46
  v_rcp_f32 v47, v47
  ds_read_b64_tr_b16 v[92:93], v13 offset:16384
  ds_read_b64_tr_b16 v[94:95], v13 offset:16896
  s_waitcnt lgkmcnt(6)
  v_mfma_f32_32x32x16_bf16 v[112:127], v[80:83], v[160:163], v[112:127]
  v_mfma_f32_16x16x32_bf16 v[28:31], v[80:83], v[24:27], v[28:31]
  v_mul_f32 v56, v56, v44
  v_mul_f32 v57, v57, v45
  v_mul_f32 v58, v58, v46
  v_mul_f32 v59, v59, v47
  ds_read_b64_tr_b16 v[80:81], v10 offset:24576
  ds_read_b64_tr_b16 v[82:83], v10 offset:25088
  s_waitcnt lgkmcnt(6)
  v_mfma_f32_32x32x16_bf16 v[112:127], v[84:87], v[164:167], v[112:127]
  s_add_u32 m0, s66, 98304
  s_add_u32 s58, s63, 704512
  buffer_load_dwordx4 v5, s[44:47], s58 offen lds
  v_mul_f32 v44, v60, v60
  v_mul_f32 v45, v61, v61
  v_mul_f32 v46, v62, v62
  v_mul_f32 v47, v63, v63
  ds_read_b64_tr_b16 v[84:85], v11 offset:24576
  ds_read_b64_tr_b16 v[86:87], v11 offset:25088
  s_waitcnt lgkmcnt(6)
  v_mfma_f32_32x32x16_bf16 v[112:127], v[88:91], v[168:171], v[112:127]
  v_fma_f32 v44, v44, v2, v17
  v_fma_f32 v45, v45, v2, v17
  v_fma_f32 v46, v46, v2, v17
  v_fma_f32 v47, v47, v2, v17
  ds_read_b64_tr_b16 v[88:89], v12 offset:24576
  ds_read_b64_tr_b16 v[90:91], v12 offset:25088
  s_waitcnt lgkmcnt(6)
  v_mfma_f32_32x32x16_bf16 v[112:127], v[92:95], v[172:175], v[112:127]
  s_add_u32 m0, s66, 106496
  s_add_u32 s58, s63, 880640
  buffer_load_dwordx4 v5, s[44:47], s58 offen lds
  v_mul_f32 v44, v44, v60
  v_mul_f32 v45, v45, v61
  v_mul_f32 v46, v46, v62
  v_mul_f32 v47, v47, v63
  ds_read_b64_tr_b16 v[92:93], v13 offset:24576
  ds_read_b64_tr_b16 v[94:95], v13 offset:25088
  s_waitcnt lgkmcnt(6)
  v_mfma_f32_32x32x16_bf16 v[112:127], v[80:83], v[176:179], v[112:127]
  v_mfma_f32_16x16x32_bf16 v[28:31], v[80:83], v[24:27], v[28:31]
  v_exp_f32 v44, v44
  v_exp_f32 v45, v45
  ds_read_b64_tr_b16 v[80:81], v10 offset:32768
  ds_read_b64_tr_b16 v[82:83], v10 offset:33280
  s_waitcnt lgkmcnt(6)
  v_mfma_f32_32x32x16_bf16 v[112:127], v[84:87], v[180:183], v[112:127]
  s_add_u32 m0, s66, 114688
  s_add_u32 s58, s63, 1056768
  buffer_load_dwordx4 v5, s[44:47], s58 offen lds
  v_exp_f32 v46, v46
  v_exp_f32 v47, v47
  ds_read_b64_tr_b16 v[84:85], v11 offset:32768
  ds_read_b64_tr_b16 v[86:87], v11 offset:33280
  s_waitcnt lgkmcnt(6)
  v_mfma_f32_32x32x16_bf16 v[112:127], v[88:91], v[184:187], v[112:127]
  v_fma_f32 v44, v44, v20, v20
  v_fma_f32 v45, v45, v20, v20
  v_fma_f32 v46, v46, v20, v20
  v_fma_f32 v47, v47, v20, v20
  ds_read_b64_tr_b16 v[88:89], v12 offset:32768
  ds_read_b64_tr_b16 v[90:91], v12 offset:33280
  s_waitcnt lgkmcnt(6)
  v_mfma_f32_32x32x16_bf16 v[112:127], v[92:95], v[188:191], v[112:127]
  s_add_u32 m0, s66, 122880
  s_add_u32 s58, s63, 1232896
  buffer_load_dwordx4 v5, s[44:47], s58 offen lds
  v_rcp_f32 v44, v44
  v_rcp_f32 v45, v45
  ds_read_b64_tr_b16 v[92:93], v13 offset:32768
  ds_read_b64_tr_b16 v[94:95], v13 offset:33280
  s_waitcnt lgkmcnt(6)
  v_mfma_f32_32x32x16_bf16 v[112:127], v[80:83], v[192:195], v[112:127]
  v_mfma_f32_16x16x32_bf16 v[28:31], v[80:83], v[24:27], v[28:31]
  v_rcp_f32 v46, v46
  v_rcp_f32 v47, v47
  ds_read_b64_tr_b16 v[80:81], v10 offset:40960
  ds_read_b64_tr_b16 v[82:83], v10 offset:41472
  s_waitcnt lgkmcnt(6)
  v_mfma_f32_32x32x16_bf16 v[112:127], v[84:87], v[196:199], v[112:127]
  v_mul_f32 v60, v60, v44
  v_mul_f32 v61, v61, v45
  v_mul_f32 v62, v62, v46
  v_mul_f32 v63, v63, v47
  ds_read_b64_tr_b16 v[84:85], v11 offset:40960
  ds_read_b64_tr_b16 v[86:87], v11 offset:41472
  s_waitcnt lgkmcnt(6)
  v_mfma_f32_32x32x16_bf16 v[112:127], v[88:91], v[200:203], v[112:127]
  s_lshl_b32 s57, s68, 12
  s_lshl_b32 s58, s5, 11
  s_add_u32 s57, s57, s58
  s_add_u32 s57, s57, s67
  ds_read_b128 v[36:39], v21 offset:0
  ds_read_b128 v[40:43], v21 offset:32
  ds_read_b64_tr_b16 v[88:89], v12 offset:40960
  ds_read_b64_tr_b16 v[90:91], v12 offset:41472
  s_waitcnt lgkmcnt(8)
  v_mfma_f32_32x32x16_bf16 v[112:127], v[92:95], v[204:207], v[112:127]
  ds_read_b64_tr_b16 v[92:93], v13 offset:40960
  ds_read_b64_tr_b16 v[94:95], v13 offset:41472
  s_waitcnt lgkmcnt(8)
  v_mfma_f32_32x32x16_bf16 v[112:127], v[80:83], v[208:211], v[112:127]
  v_mfma_f32_16x16x32_bf16 v[28:31], v[80:83], v[24:27], v[28:31]
  ds_read_b64_tr_b16 v[80:81], v10 offset:49152
  ds_read_b64_tr_b16 v[82:83], v10 offset:49664
  s_waitcnt lgkmcnt(8)
  v_mfma_f32_32x32x16_bf16 v[112:127], v[84:87], v[212:215], v[112:127]
  s_waitcnt lgkmcnt(7)
  v_fma_f32 v44, v36, v18, v96
  v_fma_f32 v45, v37, v18, v97
  v_fma_f32 v46, v38, v18, v98
  v_fma_f32 v47, v39, v18, v99
  ds_read_b128 v[36:39], v21 offset:64
  v_mul_f32 v44, v44, v48
  ds_read_b64_tr_b16 v[84:85], v11 offset:49152
  ds_read_b64_tr_b16 v[86:87], v11 offset:49664
  s_waitcnt lgkmcnt(7)
  v_mfma_f32_32x32x16_bf16 v[112:127], v[88:91], v[216:219], v[112:127]
  v_mul_f32 v45, v45, v49
  v_mul_f32 v46, v46, v50
  v_mul_f32 v47, v47, v51
  v_cvt_pk_bf16_f32 v48, v44, v45
  v_cvt_pk_bf16_f32 v49, v46, v47
  ds_read_b64_tr_b16 v[88:89], v12 offset:49152
  ds_read_b64_tr_b16 v[90:91], v12 offset:49664
  s_waitcnt lgkmcnt(7)
  v_mfma_f32_32x32x16_bf16 v[112:127], v[92:95], v[220:223], v[112:127]
  v_fma_f32 v44, v40, v18, v100
  v_fma_f32 v45, v41, v18, v101
  v_fma_f32 v46, v42, v18, v102
  v_fma_f32 v47, v43, v18, v103
  ds_read_b128 v[40:43], v21 offset:96
  v_mul_f32 v44, v44, v52
  ds_read_b64_tr_b16 v[92:93], v13 offset:49152
  ds_read_b64_tr_b16 v[94:95], v13 offset:49664
  s_waitcnt lgkmcnt(8)
  v_mfma_f32_32x32x16_bf16 v[112:127], v[80:83], v[224:227], v[112:127]
  v_mfma_f32_16x16x32_bf16 v[28:31], v[80:83], v[24:27], v[28:31]
  v_mul_f32 v45, v45, v53
  v_mul_f32 v46, v46, v54
  v_mul_f32 v47, v47, v55
  v_cvt_pk_bf16_f32 v50, v44, v45
  v_cvt_pk_bf16_f32 v51, v46, v47
  ds_read_b64_tr_b16 v[80:81], v10 offset:57344
  ds_read_b64_tr_b16 v[82:83], v10 offset:57856
  s_waitcnt lgkmcnt(7)
  v_mfma_f32_32x32x16_bf16 v[112:127], v[84:87], v[228:231], v[112:127]
  buffer_store_dwordx4 v[48:51], v23, s[48:51], s57 offen offset:0 sc1
  v_fma_f32 v44, v36, v18, v104
  v_fma_f32 v45, v37, v18, v105
  v_fma_f32 v46, v38, v18, v106
  v_fma_f32 v47, v39, v18, v107
  v_mul_f32 v44, v44, v56
  ds_read_b64_tr_b16 v[84:85], v11 offset:57344
  ds_read_b64_tr_b16 v[86:87], v11 offset:57856
  s_waitcnt lgkmcnt(7)
  v_mfma_f32_32x32x16_bf16 v[112:127], v[88:91], v[232:235], v[112:127]
  v_mul_f32 v45, v45, v57
  v_mul_f32 v46, v46, v58
  v_mul_f32 v47, v47, v59
  v_cvt_pk_bf16_f32 v56, v44, v45
  v_cvt_pk_bf16_f32 v57, v46, v47
  ds_read_b64_tr_b16 v[88:89], v12 offset:57344
  ds_read_b64_tr_b16 v[90:91], v12 offset:57856
  s_waitcnt lgkmcnt(6)
  v_mfma_f32_32x32x16_bf16 v[112:127], v[92:95], v[236:239], v[112:127]
  v_fma_f32 v44, v40, v18, v108
  v_fma_f32 v45, v41, v18, v109
  v_fma_f32 v46, v42, v18, v110
  v_fma_f32 v47, v43, v18, v111
  v_mul_f32 v44, v44, v60
  v_mul_f32 v45, v45, v61
  ds_read_b64_tr_b16 v[92:93], v13 offset:57344
  ds_read_b64_tr_b16 v[94:95], v13 offset:57856
  s_waitcnt lgkmcnt(6)
  v_mfma_f32_32x32x16_bf16 v[112:127], v[80:83], v[240:243], v[112:127]
  v_mfma_f32_16x16x32_bf16 v[28:31], v[80:83], v[24:27], v[28:31]
  v_mul_f32 v46, v46, v62
  v_mul_f32 v47, v47, v63
  v_cvt_pk_bf16_f32 v58, v44, v45
  v_cvt_pk_bf16_f32 v59, v46, v47
  buffer_store_dwordx4 v[56:59], v23, s[48:51], s57 offen offset:1024 sc1
  s_waitcnt lgkmcnt(4)
  v_mfma_f32_32x32x16_bf16 v[112:127], v[84:87], v[244:247], v[112:127]
  s_nop 1
  s_mov_b64 exec, s[74:75]
  ds_write_b32 v22, v28 offset:2048
  ds_write_b32 v22, v29 offset:2064
  ds_write_b32 v22, v30 offset:2080
  ds_write_b32 v22, v31 offset:2096
  s_mov_b64 exec, -1
  v_add_u32 v10, 0xffff8000, v10
  v_add_u32 v11, 0xffff8000, v11
  v_add_u32 v12, 0xffff8000, v12
  v_add_u32 v13, 0xffff8000, v13
  s_waitcnt vmcnt(2) lgkmcnt(0)
  s_barrier
  ds_read_b64_tr_b16 v[80:81], v10 offset:0
  ds_read_b64_tr_b16 v[82:83], v10 offset:512
  ds_read_b64_tr_b16 v[84:85], v11 offset:0
  ds_read_b64_tr_b16 v[86:87], v11 offset:512
  ds_read_b128 v[40:43], v3 offset:2048
  v_mfma_f32_32x32x16_bf16 v[112:127], v[88:91], v[248:251], v[112:127]
  ds_read_b64_tr_b16 v[88:89], v12 offset:0
  ds_read_b64_tr_b16 v[90:91], v12 offset:512
  v_mfma_f32_32x32x16_bf16 v[112:127], v[92:95], v[252:255], v[112:127]
  s_waitcnt lgkmcnt(2)
  v_add_f32 v40, v40, v41
  v_add_f32 v42, v42, v43
  v_add_f32 v44, v40, v42
  ds_write_b32 v14, v44
  ds_read_b64_tr_b16 v[92:93], v13 offset:0
  ds_read_b64_tr_b16 v[94:95], v13 offset:512
  v_mfma_f32_32x32x16_bf16 v[96:111], v[80:83], v[128:131], 0
  v_mfma_f32_16x16x32_bf16 v[28:31], v[80:83], v[24:27], 0
  ds_read_b128 v[36:39], v21 offset:0
  ds_read_b128 v[40:43], v21 offset:32
  ds_read_b64_tr_b16 v[80:81], v10 offset:8192
  ds_read_b64_tr_b16 v[82:83], v10 offset:8704
  v_mfma_f32_32x32x16_bf16 v[96:111], v[84:87], v[132:135], v[96:111]
  s_add_u32 m0, s66, 32768
  s_add_u32 s58, s64, 0
  buffer_load_dwordx4 v5, s[40:43], s58 offen lds
  ds_read_b64_tr_b16 v[84:85], v11 offset:8192
  ds_read_b64_tr_b16 v[86:87], v11 offset:8704
  s_waitcnt lgkmcnt(9)
  v_mfma_f32_32x32x16_bf16 v[96:111], v[88:91], v[136:139], v[96:111]
  ds_read_b64_tr_b16 v[88:89], v12 offset:8192
  ds_read_b64_tr_b16 v[90:91], v12 offset:8704
  s_waitcnt lgkmcnt(8)
  v_mfma_f32_32x32x16_bf16 v[96:111], v[92:95], v[140:143], v[96:111]
  s_add_u32 m0, s66, 40960
  s_add_u32 s58, s64, 176128
  buffer_load_dwordx4 v5, s[40:43], s58 offen lds
  s_waitcnt lgkmcnt(7)
  v_fma_f32 v44, v36, v18, v112
  v_fma_f32 v45, v37, v18, v113
  v_fma_f32 v46, v38, v18, v114
  ds_read_b64_tr_b16 v[92:93], v13 offset:8192
  ds_read_b64_tr_b16 v[94:95], v13 offset:8704
  s_waitcnt lgkmcnt(6)
  v_mfma_f32_32x32x16_bf16 v[96:111], v[80:83], v[144:147], v[96:111]
  v_mfma_f32_16x16x32_bf16 v[28:31], v[80:83], v[24:27], v[28:31]
  v_fma_f32 v47, v39, v18, v115
  ds_read_b128 v[36:39], v21 offset:64
  v_mul_f32 v48, v44, v44
  ds_read_b64_tr_b16 v[80:81], v10 offset:16384
  ds_read_b64_tr_b16 v[82:83], v10 offset:16896
  s_waitcnt lgkmcnt(7)
  v_mfma_f32_32x32x16_bf16 v[96:111], v[84:87], v[148:151], v[96:111]
  s_add_u32 m0, s66, 49152
  s_add_u32 s58, s64, 352256
  buffer_load_dwordx4 v5, s[40:43], s58 offen lds
  v_mul_f32 v49, v45, v45
  v_mul_f32 v50, v46, v46
  v_mul_f32 v51, v47, v47
  v_fma_f32 v48, v48, v2, v17
  ds_read_b64_tr_b16 v[84:85], v11 offset:16384
  ds_read_b64_tr_b16 v[86:87], v11 offset:16896
  s_waitcnt lgkmcnt(7)
  v_mfma_f32_32x32x16_bf16 v[96:111], v[88:91], v[152:155], v[96:111]
  v_fma_f32 v49, v49, v2, v17
  v_fma_f32 v50, v50, v2, v17
  v_fma_f32 v51, v51, v2, v17
  ds_read_b64_tr_b16 v[88:89], v12 offset:16384
  ds_read_b64_tr_b16 v[90:91], v12 offset:16896
  s_waitcnt lgkmcnt(7)
  v_mfma_f32_32x32x16_bf16 v[96:111], v[92:95], v[156:159], v[96:111]
  s_add_u32 m0, s66, 57344
  s_add_u32 s58, s64, 528384
  buffer_load_dwordx4 v5, s[40:43], s58 offen lds
  v_mul_f32 v48, v48, v44
  v_mul_f32 v49, v49, v45
  v_mul_f32 v50, v50, v46
  v_mul_f32 v51, v51, v47
  ds_read_b64_tr_b16 v[92:93], v13 offset:16384
  ds_read_b64_tr_b16 v[94:95], v13 offset:16896
  s_waitcnt lgkmcnt(6)
  v_mfma_f32_32x32x16_bf16 v[96:111], v[80:83], v[160:163], v[96:111]
  v_mfma_f32_16x16x32_bf16 v[28:31], v[80:83], v[24:27], v[28:31]
  v_exp_f32 v48, v48
  v_exp_f32 v49, v49
  ds_read_b64_tr_b16 v[80:81], v10 offset:24576
  ds_read_b64_tr_b16 v[82:83], v10 offset:25088
  s_waitcnt lgkmcnt(6)
  v_mfma_f32_32x32x16_bf16 v[96:111], v[84:87], v[164:167], v[96:111]
  s_add_u32 m0, s66, 65536
  s_add_u32 s58, s64, 704512
  buffer_load_dwordx4 v5, s[40:43], s58 offen lds
  v_exp_f32 v50, v50
  v_exp_f32 v51, v51
  ds_read_b64_tr_b16 v[84:85], v11 offset:24576
  ds_read_b64_tr_b16 v[86:87], v11 offset:25088
  s_waitcnt lgkmcnt(6)
  v_mfma_f32_32x32x16_bf16 v[96:111], v[88:91], v[168:171], v[96:111]
  v_fma_f32 v48, v48, v20, v20
  v_fma_f32 v49, v49, v20, v20
  v_fma_f32 v50, v50, v20, v20
  ds_read_b64_tr_b16 v[88:89], v12 offset:24576
  ds_read_b64_tr_b16 v[90:91], v12 offset:25088
  s_waitcnt lgkmcnt(6)
  v_mfma_f32_32x32x16_bf16 v[96:111], v[92:95], v[172:175], v[96:111]
  s_add_u32 m0, s66, 73728
  s_add_u32 s58, s64, 880640
  buffer_load_dwordx4 v5, s[40:43], s58 offen lds
  v_fma_f32 v51, v51, v20, v20
  v_rcp_f32 v48, v48
  ds_read_b64_tr_b16 v[92:93], v13 offset:24576
  ds_read_b64_tr_b16 v[94:95], v13 offset:25088
  s_waitcnt lgkmcnt(6)
  v_mfma_f32_32x32x16_bf16 v[96:111], v[80:83], v[176:179], v[96:111]
  v_mfma_f32_16x16x32_bf16 v[28:31], v[80:83], v[24:27], v[28:31]
  v_rcp_f32 v49, v49
  v_rcp_f32 v50, v50
  v_add_u32 v10, 0x10000, v10
  v_add_u32 v11, 0x10000, v11
  v_add_u32 v12, 0x10000, v12
  v_add_u32 v13, 0x10000, v13
  ds_read_b64_tr_b16 v[80:81], v10 offset:32768
  ds_read_b64_tr_b16 v[82:83], v10 offset:33280
  s_waitcnt lgkmcnt(6)
  v_mfma_f32_32x32x16_bf16 v[96:111], v[84:87], v[180:183], v[96:111]
  s_add_u32 m0, s66, 81920
  s_add_u32 s58, s64, 1056768
  buffer_load_dwordx4 v5, s[40:43], s58 offen lds
  v_rcp_f32 v51, v51
  v_mul_f32 v48, v48, v44
  ds_read_b64_tr_b16 v[84:85], v11 offset:32768
  ds_read_b64_tr_b16 v[86:87], v11 offset:33280
  s_waitcnt lgkmcnt(6)
  v_mfma_f32_32x32x16_bf16 v[96:111], v[88:91], v[184:187], v[96:111]
  v_mul_f32 v49, v49, v45
  v_mul_f32 v50, v50, v46
  v_mul_f32 v51, v51, v47
  ds_read_b64_tr_b16 v[88:89], v12 offset:32768
  ds_read_b64_tr_b16 v[90:91], v12 offset:33280
  s_waitcnt lgkmcnt(6)
  v_mfma_f32_32x32x16_bf16 v[96:111], v[92:95], v[188:191], v[96:111]
  s_add_u32 m0, s66, 90112
  s_add_u32 s58, s64, 1232896
  buffer_load_dwordx4 v5, s[40:43], s58 offen lds
  v_fma_f32 v44, v40, v18, v116
  v_fma_f32 v45, v41, v18, v117
  v_fma_f32 v46, v42, v18, v118
  v_fma_f32 v47, v43, v18, v119
  ds_read_b64_tr_b16 v[92:93], v13 offset:32768
  ds_read_b64_tr_b16 v[94:95], v13 offset:33280
  s_waitcnt lgkmcnt(6)
  v_mfma_f32_32x32x16_bf16 v[96:111], v[80:83], v[192:195], v[96:111]
  v_mfma_f32_16x16x32_bf16 v[28:31], v[80:83], v[24:27], v[28:31]
  ds_read_b128 v[40:43], v21 offset:96
  v_mul_f32 v52, v44, v44
  v_mul_f32 v53, v45, v45
  ds_read_b64_tr_b16 v[80:81], v10 offset:40960
  ds_read_b64_tr_b16 v[82:83], v10 offset:41472
  s_waitcnt lgkmcnt(7)
  v_mfma_f32_32x32x16_bf16 v[96:111], v[84:87], v[196:199], v[96:111]
  v_mul_f32 v54, v46, v46
  v_mul_f32 v55, v47, v47
  v_fma_f32 v52, v52, v2, v17
  v_fma_f32 v53, v53, v2, v17
  ds_read_b64_tr_b16 v[84:85], v11 offset:40960
  ds_read_b64_tr_b16 v[86:87], v11 offset:41472
  s_waitcnt lgkmcnt(7)
  v_mfma_f32_32x32x16_bf16 v[96:111], v[88:91], v[200:203], v[96:111]
  v_fma_f32 v54, v54, v2, v17
  v_fma_f32 v55, v55, v2, v17
  v_mul_f32 v52, v52, v44
  ds_read_b64_tr_b16 v[88:89], v12 offset:40960
  ds_read_b64_tr_b16 v[90:91], v12 offset:41472
  s_waitcnt lgkmcnt(7)
  v_mfma_f32_32x32x16_bf16 v[96:111], v[92:95], v[204:207], v[96:111]
  v_mul_f32 v53, v53, v45
  v_mul_f32 v54, v54, v46
  v_mul_f32 v55, v55, v47
  ds_read_b64_tr_b16 v[92:93], v13 offset:40960
  ds_read_b64_tr_b16 v[94:95], v13 offset:41472
  s_waitcnt lgkmcnt(6)
  v_mfma_f32_32x32x16_bf16 v[96:111], v[80:83], v[208:211], v[96:111]
  v_mfma_f32_16x16x32_bf16 v[28:31], v[80:83], v[24:27], v[28:31]
  v_exp_f32 v52, v52
  v_exp_f32 v53, v53
  ds_read_b64_tr_b16 v[80:81], v10 offset:49152
  ds_read_b64_tr_b16 v[82:83], v10 offset:49664
  s_waitcnt lgkmcnt(6)
  v_mfma_f32_32x32x16_bf16 v[96:111], v[84:87], v[212:215], v[96:111]
  v_exp_f32 v54, v54
  v_exp_f32 v55, v55
  ds_read_b64_tr_b16 v[84:85], v11 offset:49152
  ds_read_b64_tr_b16 v[86:87], v11 offset:49664
  s_waitcnt lgkmcnt(6)
  v_mfma_f32_32x32x16_bf16 v[96:111], v[88:91], v[216:219], v[96:111]
  v_fma_f32 v52, v52, v20, v20
  v_fma_f32 v53, v53, v20, v20
  v_fma_f32 v54, v54, v20, v20
  ds_read_b64_tr_b16 v[88:89], v12 offset:49152
  ds_read_b64_tr_b16 v[90:91], v12 offset:49664
  s_waitcnt lgkmcnt(6)
  v_mfma_f32_32x32x16_bf16 v[96:111], v[92:95], v[220:223], v[96:111]
  v_fma_f32 v55, v55, v20, v20
  v_rcp_f32 v52, v52
  ds_read_b64_tr_b16 v[92:93], v13 offset:49152
  ds_read_b64_tr_b16 v[94:95], v13 offset:49664
  s_waitcnt lgkmcnt(6)
  v_mfma_f32_32x32x16_bf16 v[96:111], v[80:83], v[224:227], v[96:111]
  v_mfma_f32_16x16x32_bf16 v[28:31], v[80:83], v[24:27], v[28:31]
  v_rcp_f32 v53, v53
  v_rcp_f32 v54, v54
  ds_read_b64_tr_b16 v[80:81], v10 offset:57344
  ds_read_b64_tr_b16 v[82:83], v10 offset:57856
  s_waitcnt lgkmcnt(6)
  v_mfma_f32_32x32x16_bf16 v[96:111], v[84:87], v[228:231], v[96:111]
  v_rcp_f32 v55, v55
  v_mul_f32 v52, v52, v44
  v_mul_f32 v53, v53, v45
  ds_read_b64_tr_b16 v[84:85], v11 offset:57344
  ds_read_b64_tr_b16 v[86:87], v11 offset:57856
  s_waitcnt lgkmcnt(6)
  v_mfma_f32_32x32x16_bf16 v[96:111], v[88:91], v[232:235], v[96:111]
  v_mul_f32 v54, v54, v46
  v_mul_f32 v55, v55, v47
  v_fma_f32 v56, v36, v18, v120
  ds_read_b64_tr_b16 v[88:89], v12 offset:57344
  ds_read_b64_tr_b16 v[90:91], v12 offset:57856
  s_waitcnt lgkmcnt(6)
  v_mfma_f32_32x32x16_bf16 v[96:111], v[92:95], v[236:239], v[96:111]
  v_fma_f32 v57, v37, v18, v121
  v_fma_f32 v58, v38, v18, v122
  v_fma_f32 v59, v39, v18, v123
  v_fma_f32 v60, v40, v18, v124
  ds_read_b64_tr_b16 v[92:93], v13 offset:57344
  ds_read_b64_tr_b16 v[94:95], v13 offset:57856
  s_waitcnt lgkmcnt(6)
  v_mfma_f32_32x32x16_bf16 v[96:111], v[80:83], v[240:243], v[96:111]
  v_mfma_f32_16x16x32_bf16 v[28:31], v[80:83], v[24:27], v[28:31]
  v_fma_f32 v61, v41, v18, v125
  v_fma_f32 v62, v42, v18, v126
  v_fma_f32 v63, v43, v18, v127
  s_waitcnt lgkmcnt(4)
  v_mfma_f32_32x32x16_bf16 v[96:111], v[84:87], v[244:247], v[96:111]
  s_nop 3
  s_mov_b64 exec, s[74:75]
  ds_write_b32 v22, v28 offset:3072
  ds_write_b32 v22, v29 offset:3088
  ds_write_b32 v22, v30 offset:3104
  ds_write_b32 v22, v31 offset:3120
  s_mov_b64 exec, -1
  v_add_u32 v10, 0xffff8000, v10
  v_add_u32 v11, 0xffff8000, v11
  v_add_u32 v12, 0xffff8000, v12
  v_add_u32 v13, 0xffff8000, v13
  s_waitcnt vmcnt(0) lgkmcnt(0)
  s_barrier
  ds_read_b64_tr_b16 v[80:81], v10 offset:0
  ds_read_b64_tr_b16 v[82:83], v10 offset:512
  ds_read_b64_tr_b16 v[84:85], v11 offset:0
  ds_read_b64_tr_b16 v[86:87], v11 offset:512
  ds_read_b128 v[40:43], v3 offset:3072
  v_mfma_f32_32x32x16_bf16 v[96:111], v[88:91], v[248:251], v[96:111]
  ds_read_b64_tr_b16 v[88:89], v12 offset:0
  ds_read_b64_tr_b16 v[90:91], v12 offset:512
  v_mfma_f32_32x32x16_bf16 v[96:111], v[92:95], v[252:255], v[96:111]
  s_waitcnt lgkmcnt(2)
  v_add_f32 v40, v40, v41
  v_add_f32 v42, v42, v43
  v_add_f32 v44, v40, v42
  ds_write_b32 v14, v44
  ds_read_b64_tr_b16 v[92:93], v13 offset:0
  ds_read_b64_tr_b16 v[94:95], v13 offset:512
  v_mfma_f32_32x32x16_bf16 v[112:127], v[80:83], v[128:131], 0
  v_mfma_f32_16x16x32_bf16 v[28:31], v[80:83], v[24:27], 0
  v_mul_f32 v44, v56, v56
  v_mul_f32 v45, v57, v57
  v_mul_f32 v46, v58, v58
  v_mul_f32 v47, v59, v59
  ds_read_b64_tr_b16 v[80:81], v10 offset:8192
  ds_read_b64_tr_b16 v[82:83], v10 offset:8704
  v_mfma_f32_32x32x16_bf16 v[112:127], v[84:87], v[132:135], v[112:127]
  s_add_u32 m0, s66, 0
  s_add_u32 s58, s73, 0
  buffer_load_dwordx4 v5, s[44:47], s58 offen lds
  v_fma_f32 v44, v44, v2, v17
  v_fma_f32 v45, v45, v2, v17
  v_fma_f32 v46, v46, v2, v17
  v_fma_f32 v47, v47, v2, v17
  ds_read_b64_tr_b16 v[84:85], v11 offset:8192
  ds_read_b64_tr_b16 v[86:87], v11 offset:8704
  s_waitcnt lgkmcnt(7)
  v_mfma_f32_32x32x16_bf16 v[112:127], v[88:91], v[136:139], v[112:127]
  v_mul_f32 v44, v44, v56
  v_mul_f32 v45, v45, v57
  v_mul_f32 v46, v46, v58
  v_mul_f32 v47, v47, v59
  ds_read_b64_tr_b16 v[88:89], v12 offset:8192
  ds_read_b64_tr_b16 v[90:91], v12 offset:8704
  s_waitcnt lgkmcnt(6)
  v_mfma_f32_32x32x16_bf16 v[112:127], v[92:95], v[140:143], v[112:127]
  s_add_u32 m0, s66, 8192
  s_add_u32 s58, s73, 176128
  buffer_load_dwordx4 v5, s[44:47], s58 offen lds
  v_exp_f32 v44, v44
  v_exp_f32 v45, v45
  ds_read_b64_tr_b16 v[92:93], v13 offset:8192
  ds_read_b64_tr_b16 v[94:95], v13 offset:8704
  s_waitcnt lgkmcnt(6)
  v_mfma_f32_32x32x16_bf16 v[112:127], v[80:83], v[144:147], v[112:127]
  v_mfma_f32_16x16x32_bf16 v[28:31], v[80:83], v[24:27], v[28:31]
  v_exp_f32 v46, v46
  v_exp_f32 v47, v47
  ds_read_b64_tr_b16 v[80:81], v10 offset:16384
  ds_read_b64_tr_b16 v[82:83], v10 offset:16896
  s_waitcnt lgkmcnt(6)
  v_mfma_f32_32x32x16_bf16 v[112:127], v[84:87], v[148:151], v[112:127]
  s_add_u32 m0, s66, 16384
  s_add_u32 s58, s73, 352256
  buffer_load_dwordx4 v5, s[44:47], s58 offen lds
  v_fma_f32 v44, v44, v20, v20
  v_fma_f32 v45, v45, v20, v20
  v_fma_f32 v46, v46, v20, v20
  v_fma_f32 v47, v47, v20, v20
  ds_read_b64_tr_b16 v[84:85], v11 offset:16384
  ds_read_b64_tr_b16 v[86:87], v11 offset:16896
  s_waitcnt lgkmcnt(6)
  v_mfma_f32_32x32x16_bf16 v[112:127], v[88:91], v[152:155], v[112:127]
  v_rcp_f32 v44, v44
  v_rcp_f32 v45, v45
  ds_read_b64_tr_b16 v[88:89], v12 offset:16384
  ds_read_b64_tr_b16 v[90:91], v12 offset:16896
  s_waitcnt lgkmcnt(6)
  v_mfma_f32_32x32x16_bf16 v[112:127], v[92:95], v[156:159], v[112:127]
  s_add_u32 m0, s66, 24576
  s_add_u32 s58, s73, 528384
  buffer_load_dwordx4 v5, s[44:47], s58 offen lds
  v_rcp_f32 v46, v46
  v_rcp_f32 v47, v47
  ds_read_b64_tr_b16 v[92:93], v13 offset:16384
  ds_read_b64_tr_b16 v[94:95], v13 offset:16896
  s_waitcnt lgkmcnt(6)
  v_mfma_f32_32x32x16_bf16 v[112:127], v[80:83], v[160:163], v[112:127]
  v_mfma_f32_16x16x32_bf16 v[28:31], v[80:83], v[24:27], v[28:31]
  v_mul_f32 v56, v56, v44
  v_mul_f32 v57, v57, v45
  v_mul_f32 v58, v58, v46
  v_mul_f32 v59, v59, v47
  ds_read_b64_tr_b16 v[80:81], v10 offset:24576
  ds_read_b64_tr_b16 v[82:83], v10 offset:25088
  s_waitcnt lgkmcnt(6)
  v_mfma_f32_32x32x16_bf16 v[112:127], v[84:87], v[164:167], v[112:127]
  s_add_u32 m0, s66, 98304
  s_add_u32 s58, s73, 704512
  buffer_load_dwordx4 v5, s[44:47], s58 offen lds
  v_mul_f32 v44, v60, v60
  v_mul_f32 v45, v61, v61
  v_mul_f32 v46, v62, v62
  v_mul_f32 v47, v63, v63
  ds_read_b64_tr_b16 v[84:85], v11 offset:24576
  ds_read_b64_tr_b16 v[86:87], v11 offset:25088
  s_waitcnt lgkmcnt(6)
  v_mfma_f32_32x32x16_bf16 v[112:127], v[88:91], v[168:171], v[112:127]
  v_fma_f32 v44, v44, v2, v17
  v_fma_f32 v45, v45, v2, v17
  v_fma_f32 v46, v46, v2, v17
  v_fma_f32 v47, v47, v2, v17
  ds_read_b64_tr_b16 v[88:89], v12 offset:24576
  ds_read_b64_tr_b16 v[90:91], v12 offset:25088
  s_waitcnt lgkmcnt(6)
  v_mfma_f32_32x32x16_bf16 v[112:127], v[92:95], v[172:175], v[112:127]
  s_add_u32 m0, s66, 106496
  s_add_u32 s58, s73, 880640
  buffer_load_dwordx4 v5, s[44:47], s58 offen lds
  v_mul_f32 v44, v44, v60
  v_mul_f32 v45, v45, v61
  v_mul_f32 v46, v46, v62
  v_mul_f32 v47, v47, v63
  ds_read_b64_tr_b16 v[92:93], v13 offset:24576
  ds_read_b64_tr_b16 v[94:95], v13 offset:25088
  s_waitcnt lgkmcnt(6)
  v_mfma_f32_32x32x16_bf16 v[112:127], v[80:83], v[176:179], v[112:127]
  v_mfma_f32_16x16x32_bf16 v[28:31], v[80:83], v[24:27], v[28:31]
  v_exp_f32 v44, v44
  v_exp_f32 v45, v45
  ds_read_b64_tr_b16 v[80:81], v10 offset:32768
  ds_read_b64_tr_b16 v[82:83], v10 offset:33280
  s_waitcnt lgkmcnt(6)
  v_mfma_f32_32x32x16_bf16 v[112:127], v[84:87], v[180:183], v[112:127]
  s_add_u32 m0, s66, 114688
  s_add_u32 s58, s73, 1056768
  buffer_load_dwordx4 v5, s[44:47], s58 offen lds
  v_exp_f32 v46, v46
  v_exp_f32 v47, v47
  ds_read_b64_tr_b16 v[84:85], v11 offset:32768
  ds_read_b64_tr_b16 v[86:87], v11 offset:33280
  s_waitcnt lgkmcnt(6)
  v_mfma_f32_32x32x16_bf16 v[112:127], v[88:91], v[184:187], v[112:127]
  v_fma_f32 v44, v44, v20, v20
  v_fma_f32 v45, v45, v20, v20
  v_fma_f32 v46, v46, v20, v20
  v_fma_f32 v47, v47, v20, v20
  ds_read_b64_tr_b16 v[88:89], v12 offset:32768
  ds_read_b64_tr_b16 v[90:91], v12 offset:33280
  s_waitcnt lgkmcnt(6)
  v_mfma_f32_32x32x16_bf16 v[112:127], v[92:95], v[188:191], v[112:127]
  s_add_u32 m0, s66, 122880
  s_add_u32 s58, s73, 1232896
  buffer_load_dwordx4 v5, s[44:47], s58 offen lds
  v_rcp_f32 v44, v44
  v_rcp_f32 v45, v45
  ds_read_b64_tr_b16 v[92:93], v13 offset:32768
  ds_read_b64_tr_b16 v[94:95], v13 offset:33280
  s_waitcnt lgkmcnt(6)
  v_mfma_f32_32x32x16_bf16 v[112:127], v[80:83], v[192:195], v[112:127]
  v_mfma_f32_16x16x32_bf16 v[28:31], v[80:83], v[24:27], v[28:31]
  v_rcp_f32 v46, v46
  v_rcp_f32 v47, v47
  ds_read_b64_tr_b16 v[80:81], v10 offset:40960
  ds_read_b64_tr_b16 v[82:83], v10 offset:41472
  s_waitcnt lgkmcnt(6)
  v_mfma_f32_32x32x16_bf16 v[112:127], v[84:87], v[196:199], v[112:127]
  v_mul_f32 v60, v60, v44
  v_mul_f32 v61, v61, v45
  v_mul_f32 v62, v62, v46
  v_mul_f32 v63, v63, v47
  ds_read_b64_tr_b16 v[84:85], v11 offset:40960
  ds_read_b64_tr_b16 v[86:87], v11 offset:41472
  s_waitcnt lgkmcnt(6)
  v_mfma_f32_32x32x16_bf16 v[112:127], v[88:91], v[200:203], v[112:127]
  s_lshl_b32 s57, s69, 12
  s_lshl_b32 s58, s5, 11
  s_add_u32 s57, s57, s58
  s_add_u32 s57, s57, s67
  ds_read_b128 v[36:39], v21 offset:0
  ds_read_b128 v[40:43], v21 offset:32
  ds_read_b64_tr_b16 v[88:89], v12 offset:40960
  ds_read_b64_tr_b16 v[90:91], v12 offset:41472
  s_waitcnt lgkmcnt(8)
  v_mfma_f32_32x32x16_bf16 v[112:127], v[92:95], v[204:207], v[112:127]
  ds_read_b64_tr_b16 v[92:93], v13 offset:40960
  ds_read_b64_tr_b16 v[94:95], v13 offset:41472
  s_waitcnt lgkmcnt(8)
  v_mfma_f32_32x32x16_bf16 v[112:127], v[80:83], v[208:211], v[112:127]
  v_mfma_f32_16x16x32_bf16 v[28:31], v[80:83], v[24:27], v[28:31]
  ds_read_b64_tr_b16 v[80:81], v10 offset:49152
  ds_read_b64_tr_b16 v[82:83], v10 offset:49664
  s_waitcnt lgkmcnt(8)
  v_mfma_f32_32x32x16_bf16 v[112:127], v[84:87], v[212:215], v[112:127]
  s_waitcnt lgkmcnt(7)
  v_fma_f32 v44, v36, v18, v96
  v_fma_f32 v45, v37, v18, v97
  v_fma_f32 v46, v38, v18, v98
  v_fma_f32 v47, v39, v18, v99
  ds_read_b128 v[36:39], v21 offset:64
  v_mul_f32 v44, v44, v48
  ds_read_b64_tr_b16 v[84:85], v11 offset:49152
  ds_read_b64_tr_b16 v[86:87], v11 offset:49664
  s_waitcnt lgkmcnt(7)
  v_mfma_f32_32x32x16_bf16 v[112:127], v[88:91], v[216:219], v[112:127]
  v_mul_f32 v45, v45, v49
  v_mul_f32 v46, v46, v50
  v_mul_f32 v47, v47, v51
  v_cvt_pk_bf16_f32 v48, v44, v45
  v_cvt_pk_bf16_f32 v49, v46, v47
  ds_read_b64_tr_b16 v[88:89], v12 offset:49152
  ds_read_b64_tr_b16 v[90:91], v12 offset:49664
  s_waitcnt lgkmcnt(7)
  v_mfma_f32_32x32x16_bf16 v[112:127], v[92:95], v[220:223], v[112:127]
  v_fma_f32 v44, v40, v18, v100
  v_fma_f32 v45, v41, v18, v101
  v_fma_f32 v46, v42, v18, v102
  v_fma_f32 v47, v43, v18, v103
  ds_read_b128 v[40:43], v21 offset:96
  v_mul_f32 v44, v44, v52
  ds_read_b64_tr_b16 v[92:93], v13 offset:49152
  ds_read_b64_tr_b16 v[94:95], v13 offset:49664
  s_waitcnt lgkmcnt(8)
  v_mfma_f32_32x32x16_bf16 v[112:127], v[80:83], v[224:227], v[112:127]
  v_mfma_f32_16x16x32_bf16 v[28:31], v[80:83], v[24:27], v[28:31]
  v_mul_f32 v45, v45, v53
  v_mul_f32 v46, v46, v54
  v_mul_f32 v47, v47, v55
  v_cvt_pk_bf16_f32 v50, v44, v45
  v_cvt_pk_bf16_f32 v51, v46, v47
  ds_read_b64_tr_b16 v[80:81], v10 offset:57344
  ds_read_b64_tr_b16 v[82:83], v10 offset:57856
  s_waitcnt lgkmcnt(7)
  v_mfma_f32_32x32x16_bf16 v[112:127], v[84:87], v[228:231], v[112:127]
  buffer_store_dwordx4 v[48:51], v23, s[48:51], s57 offen offset:0 sc1
  v_fma_f32 v44, v36, v18, v104
  v_fma_f32 v45, v37, v18, v105
  v_fma_f32 v46, v38, v18, v106
  v_fma_f32 v47, v39, v18, v107
  v_mul_f32 v44, v44, v56
  ds_read_b64_tr_b16 v[84:85], v11 offset:57344
  ds_read_b64_tr_b16 v[86:87], v11 offset:57856
  s_waitcnt lgkmcnt(7)
  v_mfma_f32_32x32x16_bf16 v[112:127], v[88:91], v[232:235], v[112:127]
  v_mul_f32 v45, v45, v57
  v_mul_f32 v46, v46, v58
  v_mul_f32 v47, v47, v59
  v_cvt_pk_bf16_f32 v56, v44, v45
  v_cvt_pk_bf16_f32 v57, v46, v47
  ds_read_b64_tr_b16 v[88:89], v12 offset:57344
  ds_read_b64_tr_b16 v[90:91], v12 offset:57856
  s_waitcnt lgkmcnt(6)
  v_mfma_f32_32x32x16_bf16 v[112:127], v[92:95], v[236:239], v[112:127]
  v_fma_f32 v44, v40, v18, v108
  v_fma_f32 v45, v41, v18, v109
  v_fma_f32 v46, v42, v18, v110
  v_fma_f32 v47, v43, v18, v111
  v_mul_f32 v44, v44, v60
  v_mul_f32 v45, v45, v61
  ds_read_b64_tr_b16 v[92:93], v13 offset:57344
  ds_read_b64_tr_b16 v[94:95], v13 offset:57856
  s_waitcnt lgkmcnt(6)
  v_mfma_f32_32x32x16_bf16 v[112:127], v[80:83], v[240:243], v[112:127]
  v_mfma_f32_16x16x32_bf16 v[28:31], v[80:83], v[24:27], v[28:31]
  v_mul_f32 v46, v46, v62
  v_mul_f32 v47, v47, v63
  v_cvt_pk_bf16_f32 v58, v44, v45
  v_cvt_pk_bf16_f32 v59, v46, v47
  buffer_store_dwordx4 v[56:59], v23, s[48:51], s57 offen offset:1024 sc1
  s_waitcnt lgkmcnt(4)
  v_mfma_f32_32x32x16_bf16 v[112:127], v[84:87], v[244:247], v[112:127]
  s_nop 1
  s_mov_b64 exec, s[74:75]
  ds_write_b32 v22, v28 offset:0
  ds_write_b32 v22, v29 offset:16
  ds_write_b32 v22, v30 offset:32
  ds_write_b32 v22, v31 offset:48
  s_mov_b64 exec, -1
  v_add_u32 v10, 0xffff8000, v10
  v_add_u32 v11, 0xffff8000, v11
  v_add_u32 v12, 0xffff8000, v12
  v_add_u32 v13, 0xffff8000, v13
  s_waitcnt vmcnt(2) lgkmcnt(0)
  s_barrier
  ds_read_b64_tr_b16 v[80:81], v10 offset:0
  ds_read_b64_tr_b16 v[82:83], v10 offset:512
  ds_read_b64_tr_b16 v[84:85], v11 offset:0
  ds_read_b64_tr_b16 v[86:87], v11 offset:512
  ds_read_b128 v[40:43], v3 offset:0
  v_mfma_f32_32x32x16_bf16 v[112:127], v[88:91], v[248:251], v[112:127]
  ds_read_b64_tr_b16 v[88:89], v12 offset:0
  ds_read_b64_tr_b16 v[90:91], v12 offset:512
  v_mfma_f32_32x32x16_bf16 v[112:127], v[92:95], v[252:255], v[112:127]
  s_waitcnt lgkmcnt(2)
  v_add_f32 v40, v40, v41
  v_add_f32 v42, v42, v43
  v_add_f32 v44, v40, v42
  ds_write_b32 v14, v44
  s_lshr_b32 s56, s2, 3
  s_lshr_b32 s57, s56, 4
  s_lshl_b32 s57, s57, 3
  s_and_b32 s56, s56, 7
  s_add_u32 s56, s56, s57
  s_lshl_b32 s56, s56, 3
  s_add_u32 s56, s56, s3
  s_lshl_b32 s56, s56, 14
  s_mov_b32 s99, 0x00020000
  s_cmp_ge_u32 s56, 1409024
  s_cbranch_scc1 p3w_23_o
  s_mov_b32 s96, s22
  s_mov_b32 s97, s23
  s_mov_b32 s98, 1409024
  s_branch p3w_23_g
p3w_23_o:
  s_sub_u32 s56, s56, 1409024
  s_mov_b32 s96, s14
  s_mov_b32 s97, s15
  s_mov_b32 s98, 524288
p3w_23_g:
  v_lshlrev_b32 v16, 7, v1
  buffer_load_dword v15, v16, s[96:99], s56 offen
  s_add_u32 s56, s56, 8192
  buffer_load_dword v15, v16, s[96:99], s56 offen
  v_mov_b32 v15, 0
  buffer_load_dword v16, v15, s[92:95], 0 offen sc1
  ds_read_b64_tr_b16 v[92:93], v13 offset:0
  ds_read_b64_tr_b16 v[94:95], v13 offset:512
  v_mfma_f32_32x32x16_bf16 v[96:111], v[80:83], v[128:131], 0
  v_mfma_f32_16x16x32_bf16 v[28:31], v[80:83], v[24:27], 0
  ds_read_b128 v[36:39], v21 offset:0
  ds_read_b128 v[40:43], v21 offset:32
  ds_read_b64_tr_b16 v[80:81], v10 offset:8192
  ds_read_b64_tr_b16 v[82:83], v10 offset:8704
  v_mfma_f32_32x32x16_bf16 v[96:111], v[84:87], v[132:135], v[96:111]
  ds_read_b64_tr_b16 v[84:85], v11 offset:8192
  ds_read_b64_tr_b16 v[86:87], v11 offset:8704
  s_waitcnt lgkmcnt(9)
  v_mfma_f32_32x32x16_bf16 v[96:111], v[88:91], v[136:139], v[96:111]
  ds_read_b64_tr_b16 v[88:89], v12 offset:8192
  ds_read_b64_tr_b16 v[90:91], v12 offset:8704
  s_waitcnt lgkmcnt(8)
  v_mfma_f32_32x32x16_bf16 v[96:111], v[92:95], v[140:143], v[96:111]
  s_waitcnt lgkmcnt(7)
  v_fma_f32 v44, v36, v18, v112
  v_fma_f32 v45, v37, v18, v113
  v_fma_f32 v46, v38, v18, v114
  v_fma_f32 v47, v39, v18, v115
  ds_read_b128 v[36:39], v21 offset:64
  v_mul_f32 v48, v44, v44
  ds_read_b64_tr_b16 v[92:93], v13 offset:8192
  ds_read_b64_tr_b16 v[94:95], v13 offset:8704
  s_waitcnt lgkmcnt(7)
  v_mfma_f32_32x32x16_bf16 v[96:111], v[80:83], v[144:147], v[96:111]
  v_mfma_f32_16x16x32_bf16 v[28:31], v[80:83], v[24:27], v[28:31]
  v_mul_f32 v49, v45, v45
  v_mul_f32 v50, v46, v46
  v_mul_f32 v51, v47, v47
  v_fma_f32 v48, v48, v2, v17
  v_fma_f32 v49, v49, v2, v17
  v_fma_f32 v50, v50, v2, v17
  ds_read_b64_tr_b16 v[80:81], v10 offset:16384
  ds_read_b64_tr_b16 v[82:83], v10 offset:16896
  s_waitcnt lgkmcnt(7)
  v_mfma_f32_32x32x16_bf16 v[96:111], v[84:87], v[148:151], v[96:111]
  v_fma_f32 v51, v51, v2, v17
  v_mul_f32 v48, v48, v44
  v_mul_f32 v49, v49, v45
  v_mul_f32 v50, v50, v46
  v_mul_f32 v51, v51, v47
  v_exp_f32 v48, v48
  ds_read_b64_tr_b16 v[84:85], v11 offset:16384
  ds_read_b64_tr_b16 v[86:87], v11 offset:16896
  s_waitcnt lgkmcnt(7)
  v_mfma_f32_32x32x16_bf16 v[96:111], v[88:91], v[152:155], v[96:111]
  v_exp_f32 v49, v49
  v_exp_f32 v50, v50
  v_exp_f32 v51, v51
  ds_read_b64_tr_b16 v[88:89], v12 offset:16384
  ds_read_b64_tr_b16 v[90:91], v12 offset:16896
  s_waitcnt lgkmcnt(6)
  v_mfma_f32_32x32x16_bf16 v[96:111], v[92:95], v[156:159], v[96:111]
  v_fma_f32 v48, v48, v20, v20
  v_fma_f32 v49, v49, v20, v20
  v_fma_f32 v50, v50, v20, v20
  v_fma_f32 v51, v51, v20, v20
  v_rcp_f32 v48, v48
  ds_read_b64_tr_b16 v[92:93], v13 offset:16384
  ds_read_b64_tr_b16 v[94:95], v13 offset:16896
  s_waitcnt lgkmcnt(6)
  v_mfma_f32_32x32x16_bf16 v[96:111], v[80:83], v[160:163], v[96:111]
  v_mfma_f32_16x16x32_bf16 v[28:31], v[80:83], v[24:27], v[28:31]
  v_rcp_f32 v49, v49
  v_rcp_f32 v50, v50
  v_rcp_f32 v51, v51
  ds_read_b64_tr_b16 v[80:81], v10 offset:24576
  ds_read_b64_tr_b16 v[82:83], v10 offset:25088
  s_waitcnt lgkmcnt(6)
  v_mfma_f32_32x32x16_bf16 v[96:111], v[84:87], v[164:167], v[96:111]
  v_mul_f32 v48, v48, v44
  v_mul_f32 v49, v49, v45
  v_mul_f32 v50, v50, v46
  v_mul_f32 v51, v51, v47
  v_fma_f32 v44, v40, v18, v116
  v_fma_f32 v45, v41, v18, v117
  ds_read_b64_tr_b16 v[84:85], v11 offset:24576
  ds_read_b64_tr_b16 v[86:87], v11 offset:25088
  s_waitcnt lgkmcnt(6)
  v_mfma_f32_32x32x16_bf16 v[96:111], v[88:91], v[168:171], v[96:111]
  v_fma_f32 v46, v42, v18, v118
  v_fma_f32 v47, v43, v18, v119
  ds_read_b128 v[40:43], v21 offset:96
  v_mul_f32 v52, v44, v44
  v_mul_f32 v53, v45, v45
  v_mul_f32 v54, v46, v46
  ds_read_b64_tr_b16 v[88:89], v12 offset:24576
  ds_read_b64_tr_b16 v[90:91], v12 offset:25088
  s_waitcnt lgkmcnt(7)
  v_mfma_f32_32x32x16_bf16 v[96:111], v[92:95], v[172:175], v[96:111]
  v_mul_f32 v55, v47, v47
  v_fma_f32 v52, v52, v2, v17
  v_fma_f32 v53, v53, v2, v17
  v_fma_f32 v54, v54, v2, v17
  v_fma_f32 v55, v55, v2, v17
  v_mul_f32 v52, v52, v44
  ds_read_b64_tr_b16 v[92:93], v13 offset:24576
  ds_read_b64_tr_b16 v[94:95], v13 offset:25088
  s_waitcnt lgkmcnt(7)
  v_mfma_f32_32x32x16_bf16 v[96:111], v[80:83], v[176:179], v[96:111]
  v_mfma_f32_16x16x32_bf16 v[28:31], v[80:83], v[24:27], v[28:31]
  v_mul_f32 v53, v53, v45
  v_mul_f32 v54, v54, v46
  v_mul_f32 v55, v55, v47
  v_exp_f32 v52, v52
  v_exp_f32 v53, v53
  v_add_u32 v10, 0x10000, v10
  v_add_u32 v11, 0x10000, v11
  v_add_u32 v12, 0x10000, v12
  v_add_u32 v13, 0x10000, v13
  ds_read_b64_tr_b16 v[80:81], v10 offset:32768
  ds_read_b64_tr_b16 v[82:83], v10 offset:33280
  s_waitcnt lgkmcnt(7)
  v_mfma_f32_32x32x16_bf16 v[96:111], v[84:87], v[180:183], v[96:111]
  v_exp_f32 v54, v54
  v_exp_f32 v55, v55
  v_fma_f32 v52, v52, v20, v20
  v_fma_f32 v53, v53, v20, v20
  ds_read_b64_tr_b16 v[84:85], v11 offset:32768
  ds_read_b64_tr_b16 v[86:87], v11 offset:33280
  s_waitcnt lgkmcnt(6)
  v_mfma_f32_32x32x16_bf16 v[96:111], v[88:91], v[184:187], v[96:111]
  v_fma_f32 v54, v54, v20, v20
  v_fma_f32 v55, v55, v20, v20
  v_rcp_f32 v52, v52
  v_rcp_f32 v53, v53
  ds_read_b64_tr_b16 v[88:89], v12 offset:32768
  ds_read_b64_tr_b16 v[90:91], v12 offset:33280
  s_waitcnt lgkmcnt(6)
  v_mfma_f32_32x32x16_bf16 v[96:111], v[92:95], v[188:191], v[96:111]
  v_rcp_f32 v54, v54
  v_rcp_f32 v55, v55
  v_mul_f32 v52, v52, v44
  v_mul_f32 v53, v53, v45
  ds_read_b64_tr_b16 v[92:93], v13 offset:32768
  ds_read_b64_tr_b16 v[94:95], v13 offset:33280
  s_waitcnt lgkmcnt(6)
  v_mfma_f32_32x32x16_bf16 v[96:111], v[80:83], v[192:195], v[96:111]
  v_mfma_f32_16x16x32_bf16 v[28:31], v[80:83], v[24:27], v[28:31]
  v_mul_f32 v54, v54, v46
  v_mul_f32 v55, v55, v47
  v_fma_f32 v44, v36, v18, v120
  v_fma_f32 v45, v37, v18, v121
  v_fma_f32 v46, v38, v18, v122
  v_fma_f32 v47, v39, v18, v123
  ds_read_b64_tr_b16 v[80:81], v10 offset:40960
  ds_read_b64_tr_b16 v[82:83], v10 offset:41472
  s_waitcnt lgkmcnt(6)
  v_mfma_f32_32x32x16_bf16 v[96:111], v[84:87], v[196:199], v[96:111]
  v_mul_f32 v56, v44, v44
  v_mul_f32 v57, v45, v45
  v_mul_f32 v58, v46, v46
  v_mul_f32 v59, v47, v47
  v_fma_f32 v56, v56, v2, v17
  v_fma_f32 v57, v57, v2, v17
  ds_read_b64_tr_b16 v[84:85], v11 offset:40960
  ds_read_b64_tr_b16 v[86:87], v11 offset:41472
  s_waitcnt lgkmcnt(6)
  v_mfma_f32_32x32x16_bf16 v[96:111], v[88:91], v[200:203], v[96:111]
  v_fma_f32 v58, v58, v2, v17
  v_fma_f32 v59, v59, v2, v17
  v_mul_f32 v56, v56, v44
  v_mul_f32 v57, v57, v45
  v_mul_f32 v58, v58, v46
  v_mul_f32 v59, v59, v47
  ds_read_b64_tr_b16 v[88:89], v12 offset:40960
  ds_read_b64_tr_b16 v[90:91], v12 offset:41472
  s_waitcnt lgkmcnt(6)
  v_mfma_f32_32x32x16_bf16 v[96:111], v[92:95], v[204:207], v[96:111]
  v_exp_f32 v56, v56
  v_exp_f32 v57, v57
  v_exp_f32 v58, v58
  ds_read_b64_tr_b16 v[92:93], v13 offset:40960
  ds_read_b64_tr_b16 v[94:95], v13 offset:41472
  s_waitcnt lgkmcnt(6)
  v_mfma_f32_32x32x16_bf16 v[96:111], v[80:83], v[208:211], v[96:111]
  v_mfma_f32_16x16x32_bf16 v[28:31], v[80:83], v[24:27], v[28:31]
  v_exp_f32 v59, v59
  v_fma_f32 v56, v56, v20, v20
  v_fma_f32 v57, v57, v20, v20
  v_fma_f32 v58, v58, v20, v20
  v_fma_f32 v59, v59, v20, v20
  ds_read_b64_tr_b16 v[80:81], v10 offset:49152
  ds_read_b64_tr_b16 v[82:83], v10 offset:49664
  s_waitcnt lgkmcnt(6)
  v_mfma_f32_32x32x16_bf16 v[96:111], v[84:87], v[212:215], v[96:111]
  v_rcp_f32 v56, v56
  v_rcp_f32 v57, v57
  v_rcp_f32 v58, v58
  ds_read_b64_tr_b16 v[84:85], v11 offset:49152
  ds_read_b64_tr_b16 v[86:87], v11 offset:49664
  s_waitcnt lgkmcnt(6)
  v_mfma_f32_32x32x16_bf16 v[96:111], v[88:91], v[216:219], v[96:111]
  v_rcp_f32 v59, v59
  v_mul_f32 v56, v56, v44
  v_mul_f32 v57, v57, v45
  v_mul_f32 v58, v58, v46
  v_mul_f32 v59, v59, v47
  v_fma_f32 v44, v40, v18, v124
  ds_read_b64_tr_b16 v[88:89], v12 offset:49152
  ds_read_b64_tr_b16 v[90:91], v12 offset:49664
  s_waitcnt lgkmcnt(6)
  v_mfma_f32_32x32x16_bf16 v[96:111], v[92:95], v[220:223], v[96:111]
  v_fma_f32 v45, v41, v18, v125
  v_fma_f32 v46, v42, v18, v126
  v_fma_f32 v47, v43, v18, v127
  v_mul_f32 v60, v44, v44
  v_mul_f32 v61, v45, v45
  v_mul_f32 v62, v46, v46
  v_mul_f32 v63, v47, v47
  ds_read_b64_tr_b16 v[92:93], v13 offset:49152
  ds_read_b64_tr_b16 v[94:95], v13 offset:49664
  s_waitcnt lgkmcnt(6)
  v_mfma_f32_32x32x16_bf16 v[96:111], v[80:83], v[224:227], v[96:111]
  v_mfma_f32_16x16x32_bf16 v[28:31], v[80:83], v[24:27], v[28:31]
  v_fma_f32 v60, v60, v2, v17
  v_fma_f32 v61, v61, v2, v17
  v_fma_f32 v62, v62, v2, v17
  v_fma_f32 v63, v63, v2, v17
  v_mul_f32 v60, v60, v44
  v_mul_f32 v61, v61, v45
  ds_read_b64_tr_b16 v[80:81], v10 offset:57344
  ds_read_b64_tr_b16 v[82:83], v10 offset:57856
  s_waitcnt lgkmcnt(6)
  v_mfma_f32_32x32x16_bf16 v[96:111], v[84:87], v[228:231], v[96:111]
  v_mul_f32 v62, v62, v46
  v_mul_f32 v63, v63, v47
  v_exp_f32 v60, v60
  v_exp_f32 v61, v61
  ds_read_b64_tr_b16 v[84:85], v11 offset:57344
  ds_read_b64_tr_b16 v[86:87], v11 offset:57856
  s_waitcnt lgkmcnt(6)
  v_mfma_f32_32x32x16_bf16 v[96:111], v[88:91], v[232:235], v[96:111]
  v_exp_f32 v62, v62
  v_exp_f32 v63, v63
  v_fma_f32 v60, v60, v20, v20
  v_fma_f32 v61, v61, v20, v20
  v_fma_f32 v62, v62, v20, v20
  ds_read_b64_tr_b16 v[88:89], v12 offset:57344
  ds_read_b64_tr_b16 v[90:91], v12 offset:57856
  s_waitcnt lgkmcnt(6)
  v_mfma_f32_32x32x16_bf16 v[96:111], v[92:95], v[236:239], v[96:111]
  v_fma_f32 v63, v63, v20, v20
  v_rcp_f32 v60, v60
  v_rcp_f32 v61, v61
  v_rcp_f32 v62, v62
  ds_read_b64_tr_b16 v[92:93], v13 offset:57344
  ds_read_b64_tr_b16 v[94:95], v13 offset:57856
  s_waitcnt lgkmcnt(6)
  v_mfma_f32_32x32x16_bf16 v[96:111], v[80:83], v[240:243], v[96:111]
  v_mfma_f32_16x16x32_bf16 v[28:31], v[80:83], v[24:27], v[28:31]
  v_rcp_f32 v63, v63
  v_mul_f32 v60, v60, v44
  v_mul_f32 v61, v61, v45
  v_mul_f32 v62, v62, v46
  v_mul_f32 v63, v63, v47
  s_waitcnt lgkmcnt(4)
  v_mfma_f32_32x32x16_bf16 v[96:111], v[84:87], v[244:247], v[96:111]
  s_nop 1
  s_mov_b64 exec, s[74:75]
  ds_write_b32 v22, v28 offset:1024
  ds_write_b32 v22, v29 offset:1040
  ds_write_b32 v22, v30 offset:1056
  ds_write_b32 v22, v31 offset:1072
  s_mov_b64 exec, -1
  s_waitcnt lgkmcnt(0)
  s_barrier
  ds_read_b128 v[40:43], v3 offset:1024
  v_mfma_f32_32x32x16_bf16 v[96:111], v[88:91], v[248:251], v[96:111]
  v_mfma_f32_32x32x16_bf16 v[96:111], v[92:95], v[252:255], v[96:111]
  s_waitcnt lgkmcnt(0)
  v_add_f32 v40, v40, v41
  v_add_f32 v42, v42, v43
  v_add_f32 v44, v40, v42
  ds_write_b32 v14, v44
  s_lshl_b32 s57, s77, 1
  s_add_u32 s57, s57, s5
  s_cmp_ge_u32 s57, 43
  s_cbranch_scc1 sk_24
  s_lshl_b32 s57, s77, 12
  s_lshl_b32 s58, s5, 11
  s_add_u32 s57, s57, s58
  s_add_u32 s57, s57, s67
  ds_read_b128 v[36:39], v21 offset:0
  ds_read_b128 v[40:43], v21 offset:32
  s_waitcnt lgkmcnt(1)
  s_nop 1
  v_fma_f32 v44, v36, v18, v96
  v_fma_f32 v45, v37, v18, v97
  v_fma_f32 v46, v38, v18, v98
  v_fma_f32 v47, v39, v18, v99
  ds_read_b128 v[36:39], v21 offset:64
  v_mul_f32 v44, v44, v48
  v_mul_f32 v45, v45, v49
  v_mul_f32 v46, v46, v50
  v_mul_f32 v47, v47, v51
  v_cvt_pk_bf16_f32 v48, v44, v45
  v_cvt_pk_bf16_f32 v49, v46, v47
  s_waitcnt lgkmcnt(1)
  v_fma_f32 v44, v40, v18, v100
  v_fma_f32 v45, v41, v18, v101
  v_fma_f32 v46, v42, v18, v102
  v_fma_f32 v47, v43, v18, v103
  ds_read_b128 v[40:43], v21 offset:96
  v_mul_f32 v44, v44, v52
  v_mul_f32 v45, v45, v53
  v_mul_f32 v46, v46, v54
  v_mul_f32 v47, v47, v55
  v_cvt_pk_bf16_f32 v50, v44, v45
  v_cvt_pk_bf16_f32 v51, v46, v47
  buffer_store_dwordx4 v[48:51], v23, s[48:51], s57 offen offset:0 sc1
  s_waitcnt lgkmcnt(1)
  v_fma_f32 v44, v36, v18, v104
  v_fma_f32 v45, v37, v18, v105
  v_fma_f32 v46, v38, v18, v106
  v_fma_f32 v47, v39, v18, v107
  v_mul_f32 v44, v44, v56
  v_mul_f32 v45, v45, v57
  v_mul_f32 v46, v46, v58
  v_mul_f32 v47, v47, v59
  v_cvt_pk_bf16_f32 v56, v44, v45
  v_cvt_pk_bf16_f32 v57, v46, v47
  s_waitcnt lgkmcnt(0)
  v_fma_f32 v44, v40, v18, v108
  v_fma_f32 v45, v41, v18, v109
  v_fma_f32 v46, v42, v18, v110
  v_fma_f32 v47, v43, v18, v111
  v_mul_f32 v44, v44, v60
  v_mul_f32 v45, v45, v61
  v_mul_f32 v46, v46, v62
  v_mul_f32 v47, v47, v63
  v_cvt_pk_bf16_f32 v58, v44, v45
  v_cvt_pk_bf16_f32 v59, v46, v47
  buffer_store_dwordx4 v[56:59], v23, s[48:51], s57 offen offset:1024 sc1
sk_24:
  s_waitcnt vmcnt(0)
  s_waitcnt vmcnt(2)
  v_readfirstlane_b32 s72, v16
  s_cmp_lg_u32 s72, 0
  s_cbranch_scc1 nr_25
  v_mov_b32 v36, 0
nn_26:
  buffer_load_dword v37, v36, s[92:95], 0 offen sc1
  s_waitcnt vmcnt(0)
  v_readfirstlane_b32 s72, v37
  s_cmp_lg_u32 s72, 0
  s_cbranch_scc1 nn_26_ok
  s_sleep 4
  s_branch nn_26
nn_26_ok:
nr_25:
  v_mov_b32 v36, 0
  v_mov_b32 v37, s72
  s_waitcnt vmcnt(0)
  s_lshl_b32 s56, s6, 3
  s_lshr_b32 s57, s7, 1
  s_add_u32 s56, s56, s57
  s_lshl_b32 s56, s56, 3
  s_add_u32 s56, s56, s3
  s_lshl_b32 s56, s56, 7
  s_add_u32 s56, s56, 24641536
  v_mov_b32 v36, 0
  v_mov_b32 v37, s72
  s_mov_b64 exec, 1
  buffer_store_dword v37, v36, s[48:51], s56 offen sc1
  s_mov_b64 exec, -1
  s_waitcnt lgkmcnt(0)
  s_barrier
  v_mov_b32 v38, 155648
  v_mov_b32 v39, 0
  ds_write_b32 v38, v39
  s_waitcnt lgkmcnt(0)
  s_barrier
  s_branch p3_entry
k1_ffn4:
  s_cmp_ge_u32 s3, 4
  s_cbranch_scc1 pf_27_w
  s_lshr_b32 s56, s2, 3
  s_lshl_b32 s56, s56, 15
  s_lshl_b32 s57, s3, 13
  s_add_u32 s56, s56, s57
  s_bfe_u32 s57, s2, 0x10002
  s_lshl_b32 s57, s57, 20
  s_add_u32 s56, s56, s57
  v_lshlrev_b32 v36, 7, v1
  buffer_load_dword v15, v36, s[32:35], s56 offen
  s_branch pf_27_e
pf_27_w:
  s_cmp_lg_u32 s3, 4
  s_cbranch_scc1 pfw_28
  s_and_b32 s56, s6, 7
  s_mul_i32 s56, s56, 176128
  s_add_u32 s56, s56, s60
  s_sub_u32 s56, s56, 88064
  v_mul_u32_u24 v45, 2752, v1
  buffer_load_dword v15, v45, s[40:43], s56 offen
  buffer_load_dword v15, v45, s[40:43], s56 offen offset:124
pfw_28:
pf_27_e:
  s_lshl_b32 s59, s66, 2
  s_add_u32 m0, s59, 65536
  s_add_u32 s58, s65, 0
  buffer_load_dwordx4 v2, s[32:35], s58 offen lds
  s_lshl_b32 s59, s66, 2
  s_add_u32 m0, s59, 66560
  s_add_u32 s58, s65, 4096
  v_xor_b32 v3, 64, v2
  buffer_load_dwordx4 v3, s[32:35], s58 offen lds
  s_lshl_b32 s59, s66, 2
  s_add_u32 m0, s59, 67584
  s_add_u32 s58, s65, 8192
  v_xor_b32 v3, 128, v2
  buffer_load_dwordx4 v3, s[32:35], s58 offen lds
  s_lshl_b32 s59, s66, 2
  s_add_u32 m0, s59, 68608
  s_add_u32 s58, s65, 12288
  v_xor_b32 v3, 192, v2
  buffer_load_dwordx4 v3, s[32:35], s58 offen lds
  s_add_u32 m0, s66, 0
  s_add_u32 s58, s60, 0
  buffer_load_dwordx4 v5, s[40:43], s58 offen lds
  s_add_u32 m0, s66, 8192
  s_add_u32 s58, s60, 176128
  buffer_load_dwordx4 v5, s[40:43], s58 offen lds
  v_lshlrev_b32 v23, 4, v1
  v_and_b32 v36, 31, v1
  v_lshrrev_b32 v37, 5, v1
  v_and_b32 v38, 15, v1
  v_xor_b32 v38, v38, v37
  s_lshl_b32 s56, s4, 13
  s_add_u32 s56, s56, 65536
  v_lshlrev_b32 v39, 8, v36
  v_add_u32 v39, s56, v39
  s_add_u32 s57, s4, 0
  s_and_b32 s57, s57, 3
  s_add_u32 s57, s57, 0
  s_lshl_b32 s57, s57, 1
  v_xor_b32 v40, s57, v38
  v_lshl_add_u32 v6, v40, 4, v39
  s_add_u32 s57, s4, 1
  s_and_b32 s57, s57, 3
  s_add_u32 s57, s57, 0
  s_lshl_b32 s57, s57, 1
  v_xor_b32 v40, s57, v38
  v_lshl_add_u32 v7, v40, 4, v39
  s_add_u32 s57, s4, 2
  s_and_b32 s57, s57, 3
  s_add_u32 s57, s57, 0
  s_lshl_b32 s57, s57, 1
  v_xor_b32 v40, s57, v38
  v_lshl_add_u32 v8, v40, 4, v39
  s_add_u32 s57, s4, 3
  s_and_b32 s57, s57, 3
  s_add_u32 s57, s57, 0
  s_lshl_b32 s57, s57, 1
  v_xor_b32 v40, s57, v38
  v_lshl_add_u32 v9, v40, 4, v39
  s_add_u32 s57, s4, 4
  s_and_b32 s57, s57, 3
  s_add_u32 s57, s57, 4
  s_lshl_b32 s57, s57, 1
  v_xor_b32 v40, s57, v38
  v_lshl_add_u32 v48, v40, 4, v39
  s_add_u32 s57, s4, 5
  s_and_b32 s57, s57, 3
  s_add_u32 s57, s57, 4
  s_lshl_b32 s57, s57, 1
  v_xor_b32 v40, s57, v38
  v_lshl_add_u32 v49, v40, 4, v39
  s_add_u32 s57, s4, 6
  s_and_b32 s57, s57, 3
  s_add_u32 s57, s57, 4
  s_lshl_b32 s57, s57, 1
  v_xor_b32 v40, s57, v38
  v_lshl_add_u32 v50, v40, 4, v39
  s_add_u32 s57, s4, 7
  s_and_b32 s57, s57, 3
  s_add_u32 s57, s57, 4
  s_lshl_b32 s57, s57, 1
  v_xor_b32 v40, s57, v38
  v_lshl_add_u32 v51, v40, 4, v39
  v_bfe_u32 v40, v1, 2, 2
  v_lshl_add_u32 v41, v37, 3, v40
  v_lshlrev_b32 v41, 7, v41
  v_bfe_u32 v42, v1, 4, 1
  v_lshlrev_b32 v42, 1, v42
  v_bfe_u32 v43, v1, 1, 1
  v_add_u32 v42, v42, v43
  s_lshl_b32 s56, s5, 2
  v_add_u32 v42, s56, v42
  v_lshrrev_b32 v43, 1, v40
  v_lshlrev_b32 v43, 2, v43
  v_xor_b32 v42, v42, v43
  v_lshl_add_u32 v41, v42, 4, v41
  v_and_b32 v43, 1, v1
  v_lshl_add_u32 v41, v43, 3, v41
  s_add_u32 s57, s4, 0
  s_and_b32 s57, s57, 3
  s_lshl_b32 s57, s57, 11
  v_add_u32 v10, s57, v41
  s_add_u32 s57, s4, 1
  s_and_b32 s57, s57, 3
  s_lshl_b32 s57, s57, 11
  v_add_u32 v11, s57, v41
  s_add_u32 s57, s4, 2
  s_and_b32 s57, s57, 3
  s_lshl_b32 s57, s57, 11
  v_add_u32 v12, s57, v41
  s_add_u32 s57, s4, 3
  s_and_b32 s57, s57, 3
  s_lshl_b32 s57, s57, 11
  v_add_u32 v13, s57, v41
  v_and_b32 v40, 15, v1
  v_bfe_u32 v42, v1, 4, 1
  v_cmp_eq_u32 vcc, v40, v42
  v_mov_b32 v43, 0x3f803f80
  v_lshrrev_b32 v42, 4, v1
  v_cndmask_b32 v24, 0, v43, vcc
  v_mov_b32 v25, v24
  v_mov_b32 v26, v24
  v_mov_b32 v27, v24
  v_mov_b32 v46, 0x3f803f80
  v_mov_b32 v47, 0x3f803f80
  v_lshlrev_b32 v42, 6, v42
  v_lshl_add_u32 v42, v40, 8, v42
  s_lshl_b32 s56, s5, 9
  s_lshl_b32 s57, s4, 2
  s_add_u32 s57, s56, s57
  s_add_u32 s57, s57, 131072
  v_add_u32 v22, s57, v42
  v_lshlrev_b32 v42, 4, v37
  s_lshl_b32 s57, s3, 7
  s_add_u32 s57, s57, 136192
  v_add_u32 v21, s57, v42
  v_lshlrev_b32 v42, 2, v36
  v_add_u32 v14, s57, v42
  s_mov_b32 s74, 0x00030003
  s_mov_b32 s75, 0x00030003
  s_mov_b32 s78, 0x0001ffff
  s_mov_b32 s80, 0xffff0001
  s_lshl_b32 s76, s6, 2
  s_add_u32 s76, s76, s4
  s_mul_i32 s67, s76, 88064
  s_waitcnt vmcnt(0)
  s_lshl_b32 s59, s66, 2
  s_add_u32 m0, s59, 98304
  s_add_u32 s58, s65, 256
  buffer_load_dwordx4 v2, s[32:35], s58 offen lds
  s_lshl_b32 s59, s66, 2
  s_add_u32 m0, s59, 99328
  s_add_u32 s58, s65, 4352
  v_xor_b32 v3, 64, v2
  buffer_load_dwordx4 v3, s[32:35], s58 offen lds
  s_lshl_b32 s59, s66, 2
  s_add_u32 m0, s59, 100352
  s_add_u32 s58, s65, 8448
  v_xor_b32 v3, 128, v2
  buffer_load_dwordx4 v3, s[32:35], s58 offen lds
  s_lshl_b32 s59, s66, 2
  s_add_u32 m0, s59, 101376
  s_add_u32 s58, s65, 12544
  v_xor_b32 v3, 192, v2
  buffer_load_dwordx4 v3, s[32:35], s58 offen lds
  s_add_u32 m0, s66, 16384
  s_add_u32 s58, s60, 352256
  buffer_load_dwordx4 v5, s[40:43], s58 offen lds
  s_add_u32 m0, s66, 24576
  s_add_u32 s58, s60, 528384
  buffer_load_dwordx4 v5, s[40:43], s58 offen lds
  s_cmp_eq_u32 s5, 0
  s_cbranch_scc1 su_29_A
  s_barrier
  s_cmp_lg_u32 s3, 5
  s_cbranch_scc1 pfw_30
  s_and_b32 s56, s6, 7
  s_mul_i32 s56, s56, 176128
  s_add_u32 s56, s56, s61
  s_sub_u32 s56, s56, 110080
  v_mul_u32_u24 v45, 2752, v1
  buffer_load_dword v15, v45, s[44:47], s56 offen
  buffer_load_dword v15, v45, s[44:47], s56 offen offset:124
pfw_30:
  ds_read_b128 v[128:131], v6 offset:0
  ds_read_b64_tr_b16 v[80:81], v10 offset:0
  ds_read_b64_tr_b16 v[82:83], v10 offset:512
  ds_read_b128 v[132:135], v7 offset:0
  ds_read_b64_tr_b16 v[84:85], v11 offset:0
  ds_read_b64_tr_b16 v[86:87], v11 offset:512
  ds_read_b128 v[136:139], v8 offset:0
  ds_read_b64_tr_b16 v[88:89], v12 offset:0
  ds_read_b64_tr_b16 v[90:91], v12 offset:512
  ds_read_b128 v[140:143], v9 offset:0
  ds_read_b64_tr_b16 v[92:93], v13 offset:0
  ds_read_b64_tr_b16 v[94:95], v13 offset:512
  s_waitcnt lgkmcnt(9)
  v_mfma_f32_32x32x16_bf16 v[112:127], v[80:83], v[128:131], 0
  v_mfma_f32_16x16x32_bf16 v[28:31], v[80:83], v[24:27], 0
  v_mfma_f32_4x4x4_16b_bf16 v[32:35], v[128:129], v[128:129], 0
  v_mfma_f32_4x4x4_16b_bf16 v[40:43], v[130:131], v[130:131], 0
  s_lshl_b32 s59, s66, 2
  s_add_u32 m0, s59, 131072
  s_add_u32 s58, s65, 512
  buffer_load_dwordx4 v2, s[32:35], s58 offen lds
  ds_read_b128 v[144:147], v48 offset:0
  ds_read_b64_tr_b16 v[80:81], v10 offset:8192
  ds_read_b64_tr_b16 v[82:83], v10 offset:8704
  s_waitcnt lgkmcnt(9)
  v_mfma_f32_32x32x16_bf16 v[112:127], v[84:87], v[132:135], v[112:127]
  v_mfma_f32_4x4x4_16b_bf16 v[32:35], v[132:133], v[132:133], v[32:35]
  v_mfma_f32_4x4x4_16b_bf16 v[40:43], v[134:135], v[134:135], v[40:43]
  s_lshl_b32 s59, s66, 2
  s_add_u32 m0, s59, 132096
  s_add_u32 s58, s65, 4608
  v_xor_b32 v3, 64, v2
  buffer_load_dwordx4 v3, s[32:35], s58 offen lds
  ds_read_b128 v[148:151], v49 offset:0
  ds_read_b64_tr_b16 v[84:85], v11 offset:8192
  ds_read_b64_tr_b16 v[86:87], v11 offset:8704
  s_waitcnt lgkmcnt(9)
  v_mfma_f32_32x32x16_bf16 v[112:127], v[88:91], v[136:139], v[112:127]
  v_mfma_f32_4x4x4_16b_bf16 v[32:35], v[136:137], v[136:137], v[32:35]
  v_mfma_f32_4x4x4_16b_bf16 v[40:43], v[138:139], v[138:139], v[40:43]
  s_lshl_b32 s59, s66, 2
  s_add_u32 m0, s59, 133120
  s_add_u32 s58, s65, 8704
  v_xor_b32 v3, 128, v2
  buffer_load_dwordx4 v3, s[32:35], s58 offen lds
  ds_read_b128 v[152:155], v50 offset:0
  ds_read_b64_tr_b16 v[88:89], v12 offset:8192
  ds_read_b64_tr_b16 v[90:91], v12 offset:8704
  s_waitcnt lgkmcnt(9)
  v_mfma_f32_32x32x16_bf16 v[112:127], v[92:95], v[140:143], v[112:127]
  v_mfma_f32_4x4x4_16b_bf16 v[32:35], v[140:141], v[140:141], v[32:35]
  v_mfma_f32_4x4x4_16b_bf16 v[40:43], v[142:143], v[142:143], v[40:43]
  s_lshl_b32 s59, s66, 2
  s_add_u32 m0, s59, 134144
  s_add_u32 s58, s65, 12800
  v_xor_b32 v3, 192, v2
  buffer_load_dwordx4 v3, s[32:35], s58 offen lds
  ds_read_b128 v[156:159], v51 offset:0
  ds_read_b64_tr_b16 v[92:93], v13 offset:8192
  ds_read_b64_tr_b16 v[94:95], v13 offset:8704
  s_waitcnt lgkmcnt(9)
  v_mfma_f32_32x32x16_bf16 v[112:127], v[80:83], v[144:147], v[112:127]
  v_mfma_f32_16x16x32_bf16 v[28:31], v[80:83], v[24:27], v[28:31]
  v_mfma_f32_4x4x4_16b_bf16 v[32:35], v[144:145], v[144:145], v[32:35]
  v_mfma_f32_4x4x4_16b_bf16 v[40:43], v[146:147], v[146:147], v[40:43]
  s_add_u32 m0, s66, 32768
  s_add_u32 s58, s60, 704512
  buffer_load_dwordx4 v5, s[40:43], s58 offen lds
  s_waitcnt lgkmcnt(6)
  v_mfma_f32_32x32x16_bf16 v[112:127], v[84:87], v[148:151], v[112:127]
  v_mfma_f32_4x4x4_16b_bf16 v[32:35], v[148:149], v[148:149], v[32:35]
  v_mfma_f32_4x4x4_16b_bf16 v[40:43], v[150:151], v[150:151], v[40:43]
  s_add_u32 m0, s66, 40960
  s_add_u32 s58, s60, 880640
  buffer_load_dwordx4 v5, s[40:43], s58 offen lds
  s_add_u32 m0, s66, 49152
  s_add_u32 s58, s60, 1056768
  buffer_load_dwordx4 v5, s[40:43], s58 offen lds
  s_waitcnt lgkmcnt(3)
  v_mfma_f32_32x32x16_bf16 v[112:127], v[88:91], v[152:155], v[112:127]
  v_mfma_f32_4x4x4_16b_bf16 v[32:35], v[152:153], v[152:153], v[32:35]
  v_mfma_f32_4x4x4_16b_bf16 v[40:43], v[154:155], v[154:155], v[40:43]
  s_add_u32 m0, s66, 57344
  s_add_u32 s58, s60, 1232896
  buffer_load_dwordx4 v5, s[40:43], s58 offen lds
  s_waitcnt lgkmcnt(0)
  v_mfma_f32_32x32x16_bf16 v[112:127], v[92:95], v[156:159], v[112:127]
  v_mfma_f32_4x4x4_16b_bf16 v[32:35], v[156:157], v[156:157], v[32:35]
  v_mfma_f32_4x4x4_16b_bf16 v[40:43], v[158:159], v[158:159], v[40:43]
  s_waitcnt vmcnt(8)
  s_barrier
  s_cmp_lg_u32 s3, 6
  s_cbranch_scc1 pfw_31
  s_and_b32 s56, s6, 7
  s_mul_i32 s56, s56, 176128
  s_add_u32 s56, s56, s62
  s_sub_u32 s56, s56, 132096
  v_mul_u32_u24 v45, 2752, v1
  buffer_load_dword v15, v45, s[40:43], s56 offen
  buffer_load_dword v15, v45, s[40:43], s56 offen offset:124
pfw_31:
  ds_read_b128 v[160:163], v6 offset:32768
  ds_read_b64_tr_b16 v[80:81], v10 offset:16384
  ds_read_b64_tr_b16 v[82:83], v10 offset:16896
  ds_read_b128 v[164:167], v7 offset:32768
  ds_read_b64_tr_b16 v[84:85], v11 offset:16384
  ds_read_b64_tr_b16 v[86:87], v11 offset:16896
  ds_read_b128 v[168:171], v8 offset:32768
  ds_read_b64_tr_b16 v[88:89], v12 offset:16384
  ds_read_b64_tr_b16 v[90:91], v12 offset:16896
  ds_read_b128 v[172:175], v9 offset:32768
  ds_read_b64_tr_b16 v[92:93], v13 offset:16384
  ds_read_b64_tr_b16 v[94:95], v13 offset:16896
  s_waitcnt lgkmcnt(9)
  v_mfma_f32_32x32x16_bf16 v[112:127], v[80:83], v[160:163], v[112:127]
  v_mfma_f32_16x16x32_bf16 v[28:31], v[80:83], v[24:27], v[28:31]
  v_mfma_f32_4x4x4_16b_bf16 v[32:35], v[160:161], v[160:161], v[32:35]
  v_mfma_f32_4x4x4_16b_bf16 v[40:43], v[162:163], v[162:163], v[40:43]
  s_lshl_b32 s59, s66, 2
  s_add_u32 m0, s59, 65536
  s_add_u32 s58, s65, 768
  buffer_load_dwordx4 v2, s[32:35], s58 offen lds
  ds_read_b128 v[176:179], v48 offset:32768
  ds_read_b64_tr_b16 v[80:81], v10 offset:24576
  ds_read_b64_tr_b16 v[82:83], v10 offset:25088
  s_waitcnt lgkmcnt(9)
  v_mfma_f32_32x32x16_bf16 v[112:127], v[84:87], v[164:167], v[112:127]
  v_mfma_f32_4x4x4_16b_bf16 v[32:35], v[164:165], v[164:165], v[32:35]
  v_mfma_f32_4x4x4_16b_bf16 v[40:43], v[166:167], v[166:167], v[40:43]
  s_lshl_b32 s59, s66, 2
  s_add_u32 m0, s59, 66560
  s_add_u32 s58, s65, 4864
  v_xor_b32 v3, 64, v2
  buffer_load_dwordx4 v3, s[32:35], s58 offen lds
  ds_read_b128 v[180:183], v49 offset:32768
  ds_read_b64_tr_b16 v[84:85], v11 offset:24576
  ds_read_b64_tr_b16 v[86:87], v11 offset:25088
  s_waitcnt lgkmcnt(9)
  v_mfma_f32_32x32x16_bf16 v[112:127], v[88:91], v[168:171], v[112:127]
  v_mfma_f32_4x4x4_16b_bf16 v[32:35], v[168:169], v[168:169], v[32:35]
  v_mfma_f32_4x4x4_16b_bf16 v[40:43], v[170:171], v[170:171], v[40:43]
  s_lshl_b32 s59, s66, 2
  s_add_u32 m0, s59, 67584
  s_add_u32 s58, s65, 8960
  v_xor_b32 v3, 128, v2
  buffer_load_dwordx4 v3, s[32:35], s58 offen lds
  ds_read_b128 v[184:187], v50 offset:32768
  ds_read_b64_tr_b16 v[88:89], v12 offset:24576
  ds_read_b64_tr_b16 v[90:91], v12 offset:25088
  s_waitcnt lgkmcnt(9)
  v_mfma_f32_32x32x16_bf16 v[112:127], v[92:95], v[172:175], v[112:127]
  v_mfma_f32_4x4x4_16b_bf16 v[32:35], v[172:173], v[172:173], v[32:35]
  v_mfma_f32_4x4x4_16b_bf16 v[40:43], v[174:175], v[174:175], v[40:43]
  s_lshl_b32 s59, s66, 2
  s_add_u32 m0, s59, 68608
  s_add_u32 s58, s65, 13056
  v_xor_b32 v3, 192, v2
  buffer_load_dwordx4 v3, s[32:35], s58 offen lds
  ds_read_b128 v[188:191], v51 offset:32768
  ds_read_b64_tr_b16 v[92:93], v13 offset:24576
  ds_read_b64_tr_b16 v[94:95], v13 offset:25088
  s_waitcnt lgkmcnt(9)
  v_mfma_f32_32x32x16_bf16 v[112:127], v[80:83], v[176:179], v[112:127]
  v_mfma_f32_16x16x32_bf16 v[28:31], v[80:83], v[24:27], v[28:31]
  v_mfma_f32_4x4x4_16b_bf16 v[32:35], v[176:177], v[176:177], v[32:35]
  v_mfma_f32_4x4x4_16b_bf16 v[40:43], v[178:179], v[178:179], v[40:43]
  s_add_u32 m0, s66, 0
  s_add_u32 s58, s61, 0
  buffer_load_dwordx4 v5, s[44:47], s58 offen lds
  s_waitcnt lgkmcnt(6)
  v_mfma_f32_32x32x16_bf16 v[112:127], v[84:87], v[180:183], v[112:127]
  v_mfma_f32_4x4x4_16b_bf16 v[32:35], v[180:181], v[180:181], v[32:35]
  v_mfma_f32_4x4x4_16b_bf16 v[40:43], v[182:183], v[182:183], v[40:43]
  s_add_u32 m0, s66, 8192
  s_add_u32 s58, s61, 176128
  buffer_load_dwordx4 v5, s[44:47], s58 offen lds
  s_waitcnt lgkmcnt(3)
  v_mfma_f32_32x32x16_bf16 v[112:127], v[88:91], v[184:187], v[112:127]
  v_mfma_f32_4x4x4_16b_bf16 v[32:35], v[184:185], v[184:185], v[32:35]
  v_mfma_f32_4x4x4_16b_bf16 v[40:43], v[186:187], v[186:187], v[40:43]
  s_waitcnt lgkmcnt(0)
  v_mfma_f32_32x32x16_bf16 v[112:127], v[92:95], v[188:191], v[112:127]
  v_mfma_f32_4x4x4_16b_bf16 v[32:35], v[188:189], v[188:189], v[32:35]
  v_mfma_f32_4x4x4_16b_bf16 v[40:43], v[190:191], v[190:191], v[40:43]
  s_waitcnt vmcnt(8)
  s_barrier
  v_add_u32 v6, 0x10000, v6
  v_add_u32 v7, 0x10000, v7
  v_add_u32 v8, 0x10000, v8
  v_add_u32 v9, 0x10000, v9
  v_add_u32 v48, 0x10000, v48
  v_add_u32 v49, 0x10000, v49
  v_add_u32 v50, 0x10000, v50
  v_add_u32 v51, 0x10000, v51
  ds_read_b128 v[192:195], v6 offset:0
  ds_read_b64_tr_b16 v[80:81], v10 offset:32768
  ds_read_b64_tr_b16 v[82:83], v10 offset:33280
  ds_read_b128 v[196:199], v7 offset:0
  ds_read_b64_tr_b16 v[84:85], v11 offset:32768
  ds_read_b64_tr_b16 v[86:87], v11 offset:33280
  ds_read_b128 v[200:203], v8 offset:0
  ds_read_b64_tr_b16 v[88:89], v12 offset:32768
  ds_read_b64_tr_b16 v[90:91], v12 offset:33280
  ds_read_b128 v[204:207], v9 offset:0
  ds_read_b64_tr_b16 v[92:93], v13 offset:32768
  ds_read_b64_tr_b16 v[94:95], v13 offset:33280
  s_waitcnt lgkmcnt(9)
  v_mfma_f32_32x32x16_bf16 v[112:127], v[80:83], v[192:195], v[112:127]
  v_mfma_f32_16x16x32_bf16 v[28:31], v[80:83], v[24:27], v[28:31]
  v_mfma_f32_4x4x4_16b_bf16 v[32:35], v[192:193], v[192:193], v[32:35]
  v_mfma_f32_4x4x4_16b_bf16 v[40:43], v[194:195], v[194:195], v[40:43]
  s_add_u32 m0, s66, 16384
  s_add_u32 s58, s61, 352256
  buffer_load_dwordx4 v5, s[44:47], s58 offen lds
  ds_read_b128 v[208:211], v48 offset:0
  ds_read_b64_tr_b16 v[80:81], v10 offset:40960
  ds_read_b64_tr_b16 v[82:83], v10 offset:41472
  s_waitcnt lgkmcnt(9)
  v_mfma_f32_32x32x16_bf16 v[112:127], v[84:87], v[196:199], v[112:127]
  v_mfma_f32_4x4x4_16b_bf16 v[32:35], v[196:197], v[196:197], v[32:35]
  v_mfma_f32_4x4x4_16b_bf16 v[40:43], v[198:199], v[198:199], v[40:43]
  s_add_u32 m0, s66, 24576
  s_add_u32 s58, s61, 528384
  buffer_load_dwordx4 v5, s[44:47], s58 offen lds
  ds_read_b128 v[212:215], v49 offset:0
  ds_read_b64_tr_b16 v[84:85], v11 offset:40960
  ds_read_b64_tr_b16 v[86:87], v11 offset:41472
  s_waitcnt lgkmcnt(9)
  v_mfma_f32_32x32x16_bf16 v[112:127], v[88:91], v[200:203], v[112:127]
  v_mfma_f32_4x4x4_16b_bf16 v[32:35], v[200:201], v[200:201], v[32:35]
  v_mfma_f32_4x4x4_16b_bf16 v[40:43], v[202:203], v[202:203], v[40:43]
  s_add_u32 m0, s66, 98304
  s_add_u32 s58, s61, 704512
  buffer_load_dwordx4 v5, s[44:47], s58 offen lds
  ds_read_b128 v[216:219], v50 offset:0
  ds_read_b64_tr_b16 v[88:89], v12 offset:40960
  ds_read_b64_tr_b16 v[90:91], v12 offset:41472
  s_waitcnt lgkmcnt(9)
  v_mfma_f32_32x32x16_bf16 v[112:127], v[92:95], v[204:207], v[112:127]
  v_mfma_f32_4x4x4_16b_bf16 v[32:35], v[204:205], v[204:205], v[32:35]
  v_mfma_f32_4x4x4_16b_bf16 v[40:43], v[206:207], v[206:207], v[40:43]
  s_add_u32 m0, s66, 106496
  s_add_u32 s58, s61, 880640
  buffer_load_dwordx4 v5, s[44:47], s58 offen lds
  ds_read_b128 v[220:223], v51 offset:0
  ds_read_b64_tr_b16 v[92:93], v13 offset:40960
  ds_read_b64_tr_b16 v[94:95], v13 offset:41472
  s_waitcnt lgkmcnt(9)
  v_mfma_f32_32x32x16_bf16 v[112:127], v[80:83], v[208:211], v[112:127]
  v_mfma_f32_16x16x32_bf16 v[28:31], v[80:83], v[24:27], v[28:31]
  v_mfma_f32_4x4x4_16b_bf16 v[32:35], v[208:209], v[208:209], v[32:35]
  v_mfma_f32_4x4x4_16b_bf16 v[40:43], v[210:211], v[210:211], v[40:43]
  s_add_u32 m0, s66, 114688
  s_add_u32 s58, s61, 1056768
  buffer_load_dwordx4 v5, s[44:47], s58 offen lds
  s_waitcnt lgkmcnt(6)
  v_mfma_f32_32x32x16_bf16 v[112:127], v[84:87], v[212:215], v[112:127]
  v_mfma_f32_4x4x4_16b_bf16 v[32:35], v[212:213], v[212:213], v[32:35]
  v_mfma_f32_4x4x4_16b_bf16 v[40:43], v[214:215], v[214:215], v[40:43]
  s_add_u32 m0, s66, 122880
  s_add_u32 s58, s61, 1232896
  buffer_load_dwordx4 v5, s[44:47], s58 offen lds
  s_waitcnt lgkmcnt(3)
  v_mfma_f32_32x32x16_bf16 v[112:127], v[88:91], v[216:219], v[112:127]
  v_mfma_f32_4x4x4_16b_bf16 v[32:35], v[216:217], v[216:217], v[32:35]
  v_mfma_f32_4x4x4_16b_bf16 v[40:43], v[218:219], v[218:219], v[40:43]
  s_waitcnt lgkmcnt(0)
  v_mfma_f32_32x32x16_bf16 v[112:127], v[92:95], v[220:223], v[112:127]
  v_mfma_f32_4x4x4_16b_bf16 v[32:35], v[220:221], v[220:221], v[32:35]
  v_mfma_f32_4x4x4_16b_bf16 v[40:43], v[222:223], v[222:223], v[40:43]
  s_waitcnt vmcnt(8)
  s_barrier
  s_cmp_lg_u32 s3, 7
  s_cbranch_scc1 pfw_32
  s_and_b32 s56, s6, 7
  s_mul_i32 s56, s56, 176128
  s_add_u32 s56, s56, s63
  s_sub_u32 s56, s56, 154112
  v_mul_u32_u24 v45, 2752, v1
  buffer_load_dword v15, v45, s[44:47], s56 offen
  buffer_load_dword v15, v45, s[44:47], s56 offen offset:124
pfw_32:
  v_add_u32 v6, 0xffff0000, v6
  v_add_u32 v7, 0xffff0000, v7
  v_add_u32 v8, 0xffff0000, v8
  v_add_u32 v9, 0xffff0000, v9
  v_add_u32 v48, 0xffff0000, v48
  v_add_u32 v49, 0xffff0000, v49
  v_add_u32 v50, 0xffff0000, v50
  v_add_u32 v51, 0xffff0000, v51
  ds_read_b128 v[224:227], v6 offset:0
  ds_read_b64_tr_b16 v[80:81], v10 offset:49152
  ds_read_b64_tr_b16 v[82:83], v10 offset:49664
  ds_read_b128 v[228:231], v7 offset:0
  ds_read_b64_tr_b16 v[84:85], v11 offset:49152
  ds_read_b64_tr_b16 v[86:87], v11 offset:49664
  ds_read_b128 v[232:235], v8 offset:0
  ds_read_b64_tr_b16 v[88:89], v12 offset:49152
  ds_read_b64_tr_b16 v[90:91], v12 offset:49664
  ds_read_b128 v[236:239], v9 offset:0
  ds_read_b64_tr_b16 v[92:93], v13 offset:49152
  ds_read_b64_tr_b16 v[94:95], v13 offset:49664
  s_waitcnt lgkmcnt(9)
  v_mfma_f32_32x32x16_bf16 v[112:127], v[80:83], v[224:227], v[112:127]
  v_mfma_f32_16x16x32_bf16 v[28:31], v[80:83], v[24:27], v[28:31]
  v_mfma_f32_4x4x4_16b_bf16 v[32:35], v[224:225], v[224:225], v[32:35]
  v_mfma_f32_4x4x4_16b_bf16 v[40:43], v[226:227], v[226:227], v[40:43]
  ds_read_b128 v[240:243], v48 offset:0
  ds_read_b64_tr_b16 v[80:81], v10 offset:57344
  ds_read_b64_tr_b16 v[82:83], v10 offset:57856
  s_waitcnt lgkmcnt(9)
  v_mfma_f32_32x32x16_bf16 v[112:127], v[84:87], v[228:231], v[112:127]
  v_mfma_f32_4x4x4_16b_bf16 v[32:35], v[228:229], v[228:229], v[32:35]
  v_mfma_f32_4x4x4_16b_bf16 v[40:43], v[230:231], v[230:231], v[40:43]
  ds_read_b128 v[244:247], v49 offset:0
  ds_read_b64_tr_b16 v[84:85], v11 offset:57344
  ds_read_b64_tr_b16 v[86:87], v11 offset:57856
  s_waitcnt lgkmcnt(9)
  v_mfma_f32_32x32x16_bf16 v[112:127], v[88:91], v[232:235], v[112:127]
  v_mfma_f32_4x4x4_16b_bf16 v[32:35], v[232:233], v[232:233], v[32:35]
  v_mfma_f32_4x4x4_16b_bf16 v[40:43], v[234:235], v[234:235], v[40:43]
  ds_read_b128 v[248:251], v50 offset:0
  ds_read_b64_tr_b16 v[88:89], v12 offset:57344
  ds_read_b64_tr_b16 v[90:91], v12 offset:57856
  s_waitcnt lgkmcnt(9)
  v_mfma_f32_32x32x16_bf16 v[112:127], v[92:95], v[236:239], v[112:127]
  v_mfma_f32_4x4x4_16b_bf16 v[32:35], v[236:237], v[236:237], v[32:35]
  v_mfma_f32_4x4x4_16b_bf16 v[40:43], v[238:239], v[238:239], v[40:43]
  ds_read_b128 v[252:255], v51 offset:0
  ds_read_b64_tr_b16 v[92:93], v13 offset:57344
  ds_read_b64_tr_b16 v[94:95], v13 offset:57856
  s_waitcnt lgkmcnt(9)
  v_mfma_f32_32x32x16_bf16 v[112:127], v[80:83], v[240:243], v[112:127]
  v_mfma_f32_16x16x32_bf16 v[28:31], v[80:83], v[24:27], v[28:31]
  v_mfma_f32_4x4x4_16b_bf16 v[32:35], v[240:241], v[240:241], v[32:35]
  v_mfma_f32_4x4x4_16b_bf16 v[40:43], v[242:243], v[242:243], v[40:43]
  s_waitcnt lgkmcnt(6)
  v_mfma_f32_32x32x16_bf16 v[112:127], v[84:87], v[244:247], v[112:127]
  v_mfma_f32_4x4x4_16b_bf16 v[32:35], v[244:245], v[244:245], v[32:35]
  v_mfma_f32_4x4x4_16b_bf16 v[40:43], v[246:247], v[246:247], v[40:43]
  s_waitcnt lgkmcnt(3)
  v_mfma_f32_32x32x16_bf16 v[112:127], v[88:91], v[248:251], v[112:127]
  v_mfma_f32_4x4x4_16b_bf16 v[32:35], v[248:249], v[248:249], v[32:35]
  v_mfma_f32_4x4x4_16b_bf16 v[40:43], v[250:251], v[250:251], v[40:43]
  s_waitcnt lgkmcnt(0)
  v_mfma_f32_32x32x16_bf16 v[112:127], v[92:95], v[252:255], v[112:127]
  v_mfma_f32_4x4x4_16b_bf16 v[32:35], v[252:253], v[252:253], v[32:35]
  v_mfma_f32_4x4x4_16b_bf16 v[40:43], v[254:255], v[254:255], v[40:43]
  s_branch su_29_J
su_29_A:
  s_barrier
  s_cmp_lg_u32 s3, 5
  s_cbranch_scc1 pfw_33
  s_and_b32 s56, s6, 7
  s_mul_i32 s56, s56, 176128
  s_add_u32 s56, s56, s61
  s_sub_u32 s56, s56, 110080
  v_mul_u32_u24 v45, 2752, v1
  buffer_load_dword v15, v45, s[44:47], s56 offen
  buffer_load_dword v15, v45, s[44:47], s56 offen offset:124
pfw_33:
  ds_read_b128 v[128:131], v6 offset:0
  ds_read_b64_tr_b16 v[80:81], v10 offset:0
  ds_read_b64_tr_b16 v[82:83], v10 offset:512
  ds_read_b128 v[132:135], v7 offset:0
  ds_read_b64_tr_b16 v[84:85], v11 offset:0
  ds_read_b64_tr_b16 v[86:87], v11 offset:512
  ds_read_b128 v[136:139], v8 offset:0
  ds_read_b64_tr_b16 v[88:89], v12 offset:0
  ds_read_b64_tr_b16 v[90:91], v12 offset:512
  ds_read_b128 v[140:143], v9 offset:0
  ds_read_b64_tr_b16 v[92:93], v13 offset:0
  ds_read_b64_tr_b16 v[94:95], v13 offset:512
  s_waitcnt lgkmcnt(9)
  v_mfma_f32_32x32x16_bf16 v[112:127], v[80:83], v[128:131], 0
  v_mfma_f32_16x16x32_bf16 v[28:31], v[80:83], v[24:27], 0
  v_mfma_f32_4x4x4_16b_bf16 v[32:35], v[128:129], v[46:47], 0
  v_mfma_f32_4x4x4_16b_bf16 v[40:43], v[130:131], v[46:47], 0
  s_lshl_b32 s59, s66, 2
  s_add_u32 m0, s59, 131072
  s_add_u32 s58, s65, 512
  buffer_load_dwordx4 v2, s[32:35], s58 offen lds
  ds_read_b128 v[144:147], v48 offset:0
  ds_read_b64_tr_b16 v[80:81], v10 offset:8192
  ds_read_b64_tr_b16 v[82:83], v10 offset:8704
  s_waitcnt lgkmcnt(9)
  v_mfma_f32_32x32x16_bf16 v[112:127], v[84:87], v[132:135], v[112:127]
  v_mfma_f32_4x4x4_16b_bf16 v[32:35], v[132:133], v[46:47], v[32:35]
  v_mfma_f32_4x4x4_16b_bf16 v[40:43], v[134:135], v[46:47], v[40:43]
  s_lshl_b32 s59, s66, 2
  s_add_u32 m0, s59, 132096
  s_add_u32 s58, s65, 4608
  v_xor_b32 v3, 64, v2
  buffer_load_dwordx4 v3, s[32:35], s58 offen lds
  ds_read_b128 v[148:151], v49 offset:0
  ds_read_b64_tr_b16 v[84:85], v11 offset:8192
  ds_read_b64_tr_b16 v[86:87], v11 offset:8704
  s_waitcnt lgkmcnt(9)
  v_mfma_f32_32x32x16_bf16 v[112:127], v[88:91], v[136:139], v[112:127]
  v_mfma_f32_4x4x4_16b_bf16 v[32:35], v[136:137], v[46:47], v[32:35]
  v_mfma_f32_4x4x4_16b_bf16 v[40:43], v[138:139], v[46:47], v[40:43]
  s_lshl_b32 s59, s66, 2
  s_add_u32 m0, s59, 133120
  s_add_u32 s58, s65, 8704
  v_xor_b32 v3, 128, v2
  buffer_load_dwordx4 v3, s[32:35], s58 offen lds
  ds_read_b128 v[152:155], v50 offset:0
  ds_read_b64_tr_b16 v[88:89], v12 offset:8192
  ds_read_b64_tr_b16 v[90:91], v12 offset:8704
  s_waitcnt lgkmcnt(9)
  v_mfma_f32_32x32x16_bf16 v[112:127], v[92:95], v[140:143], v[112:127]
  v_mfma_f32_4x4x4_16b_bf16 v[32:35], v[140:141], v[46:47], v[32:35]
  v_mfma_f32_4x4x4_16b_bf16 v[40:43], v[142:143], v[46:47], v[40:43]
  s_lshl_b32 s59, s66, 2
  s_add_u32 m0, s59, 134144
  s_add_u32 s58, s65, 12800
  v_xor_b32 v3, 192, v2
  buffer_load_dwordx4 v3, s[32:35], s58 offen lds
  ds_read_b128 v[156:159], v51 offset:0
  ds_read_b64_tr_b16 v[92:93], v13 offset:8192
  ds_read_b64_tr_b16 v[94:95], v13 offset:8704
  s_waitcnt lgkmcnt(9)
  v_mfma_f32_32x32x16_bf16 v[112:127], v[80:83], v[144:147], v[112:127]
  v_mfma_f32_16x16x32_bf16 v[28:31], v[80:83], v[24:27], v[28:31]
  v_mfma_f32_4x4x4_16b_bf16 v[32:35], v[144:145], v[46:47], v[32:35]
  v_mfma_f32_4x4x4_16b_bf16 v[40:43], v[146:147], v[46:47], v[40:43]
  s_add_u32 m0, s66, 32768
  s_add_u32 s58, s60, 704512
  buffer_load_dwordx4 v5, s[40:43], s58 offen lds
  s_waitcnt lgkmcnt(6)
  v_mfma_f32_32x32x16_bf16 v[112:127], v[84:87], v[148:151], v[112:127]
  v_mfma_f32_4x4x4_16b_bf16 v[32:35], v[148:149], v[46:47], v[32:35]
  v_mfma_f32_4x4x4_16b_bf16 v[40:43], v[150:151], v[46:47], v[40:43]
  s_add_u32 m0, s66, 40960
  s_add_u32 s58, s60, 880640
  buffer_load_dwordx4 v5, s[40:43], s58 offen lds
  s_add_u32 m0, s66, 49152
  s_add_u32 s58, s60, 1056768
  buffer_load_dwordx4 v5, s[40:43], s58 offen lds
  s_waitcnt lgkmcnt(3)
  v_mfma_f32_32x32x16_bf16 v[112:127], v[88:91], v[152:155], v[112:127]
  v_mfma_f32_4x4x4_16b_bf16 v[32:35], v[152:153], v[46:47], v[32:35]
  v_mfma_f32_4x4x4_16b_bf16 v[40:43], v[154:155], v[46:47], v[40:43]
  s_add_u32 m0, s66, 57344
  s_add_u32 s58, s60, 1232896
  buffer_load_dwordx4 v5, s[40:43], s58 offen lds
  s_waitcnt lgkmcnt(0)
  v_mfma_f32_32x32x16_bf16 v[112:127], v[92:95], v[156:159], v[112:127]
  v_mfma_f32_4x4x4_16b_bf16 v[32:35], v[156:157], v[46:47], v[32:35]
  v_mfma_f32_4x4x4_16b_bf16 v[40:43], v[158:159], v[46:47], v[40:43]
  s_waitcnt vmcnt(8)
  s_barrier
  s_cmp_lg_u32 s3, 6
  s_cbranch_scc1 pfw_34
  s_and_b32 s56, s6, 7
  s_mul_i32 s56, s56, 176128
  s_add_u32 s56, s56, s62
  s_sub_u32 s56, s56, 132096
  v_mul_u32_u24 v45, 2752, v1
  buffer_load_dword v15, v45, s[40:43], s56 offen
  buffer_load_dword v15, v45, s[40:43], s56 offen offset:124
pfw_34:
  ds_read_b128 v[160:163], v6 offset:32768
  ds_read_b64_tr_b16 v[80:81], v10 offset:16384
  ds_read_b64_tr_b16 v[82:83], v10 offset:16896
  ds_read_b128 v[164:167], v7 offset:32768
  ds_read_b64_tr_b16 v[84:85], v11 offset:16384
  ds_read_b64_tr_b16 v[86:87], v11 offset:16896
  ds_read_b128 v[168:171], v8 offset:32768
  ds_read_b64_tr_b16 v[88:89], v12 offset:16384
  ds_read_b64_tr_b16 v[90:91], v12 offset:16896
  ds_read_b128 v[172:175], v9 offset:32768
  ds_read_b64_tr_b16 v[92:93], v13 offset:16384
  ds_read_b64_tr_b16 v[94:95], v13 offset:16896
  s_waitcnt lgkmcnt(9)
  v_mfma_f32_32x32x16_bf16 v[112:127], v[80:83], v[160:163], v[112:127]
  v_mfma_f32_16x16x32_bf16 v[28:31], v[80:83], v[24:27], v[28:31]
  v_mfma_f32_4x4x4_16b_bf16 v[32:35], v[160:161], v[46:47], v[32:35]
  v_mfma_f32_4x4x4_16b_bf16 v[40:43], v[162:163], v[46:47], v[40:43]
  s_lshl_b32 s59, s66, 2
  s_add_u32 m0, s59, 65536
  s_add_u32 s58, s65, 768
  buffer_load_dwordx4 v2, s[32:35], s58 offen lds
  ds_read_b128 v[176:179], v48 offset:32768
  ds_read_b64_tr_b16 v[80:81], v10 offset:24576
  ds_read_b64_tr_b16 v[82:83], v10 offset:25088
  s_waitcnt lgkmcnt(9)
  v_mfma_f32_32x32x16_bf16 v[112:127], v[84:87], v[164:167], v[112:127]
  v_mfma_f32_4x4x4_16b_bf16 v[32:35], v[164:165], v[46:47], v[32:35]
  v_mfma_f32_4x4x4_16b_bf16 v[40:43], v[166:167], v[46:47], v[40:43]
  s_lshl_b32 s59, s66, 2
  s_add_u32 m0, s59, 66560
  s_add_u32 s58, s65, 4864
  v_xor_b32 v3, 64, v2
  buffer_load_dwordx4 v3, s[32:35], s58 offen lds
  ds_read_b128 v[180:183], v49 offset:32768
  ds_read_b64_tr_b16 v[84:85], v11 offset:24576
  ds_read_b64_tr_b16 v[86:87], v11 offset:25088
  s_waitcnt lgkmcnt(9)
  v_mfma_f32_32x32x16_bf16 v[112:127], v[88:91], v[168:171], v[112:127]
  v_mfma_f32_4x4x4_16b_bf16 v[32:35], v[168:169], v[46:47], v[32:35]
  v_mfma_f32_4x4x4_16b_bf16 v[40:43], v[170:171], v[46:47], v[40:43]
  s_lshl_b32 s59, s66, 2
  s_add_u32 m0, s59, 67584
  s_add_u32 s58, s65, 8960
  v_xor_b32 v3, 128, v2
  buffer_load_dwordx4 v3, s[32:35], s58 offen lds
  ds_read_b128 v[184:187], v50 offset:32768
  ds_read_b64_tr_b16 v[88:89], v12 offset:24576
  ds_read_b64_tr_b16 v[90:91], v12 offset:25088
  s_waitcnt lgkmcnt(9)
  v_mfma_f32_32x32x16_bf16 v[112:127], v[92:95], v[172:175], v[112:127]
  v_mfma_f32_4x4x4_16b_bf16 v[32:35], v[172:173], v[46:47], v[32:35]
  v_mfma_f32_4x4x4_16b_bf16 v[40:43], v[174:175], v[46:47], v[40:43]
  s_lshl_b32 s59, s66, 2
  s_add_u32 m0, s59, 68608
  s_add_u32 s58, s65, 13056
  v_xor_b32 v3, 192, v2
  buffer_load_dwordx4 v3, s[32:35], s58 offen lds
  ds_read_b128 v[188:191], v51 offset:32768
  ds_read_b64_tr_b16 v[92:93], v13 offset:24576
  ds_read_b64_tr_b16 v[94:95], v13 offset:25088
  s_waitcnt lgkmcnt(9)
  v_mfma_f32_32x32x16_bf16 v[112:127], v[80:83], v[176:179], v[112:127]
  v_mfma_f32_16x16x32_bf16 v[28:31], v[80:83], v[24:27], v[28:31]
  v_mfma_f32_4x4x4_16b_bf16 v[32:35], v[176:177], v[46:47], v[32:35]
  v_mfma_f32_4x4x4_16b_bf16 v[40:43], v[178:179], v[46:47], v[40:43]
  s_add_u32 m0, s66, 0
  s_add_u32 s58, s61, 0
  buffer_load_dwordx4 v5, s[44:47], s58 offen lds
  s_waitcnt lgkmcnt(6)
  v_mfma_f32_32x32x16_bf16 v[112:127], v[84:87], v[180:183], v[112:127]
  v_mfma_f32_4x4x4_16b_bf16 v[32:35], v[180:181], v[46:47], v[32:35]
  v_mfma_f32_4x4x4_16b_bf16 v[40:43], v[182:183], v[46:47], v[40:43]
  s_add_u32 m0, s66, 8192
  s_add_u32 s58, s61, 176128
  buffer_load_dwordx4 v5, s[44:47], s58 offen lds
  s_waitcnt lgkmcnt(3)
  v_mfma_f32_32x32x16_bf16 v[112:127], v[88:91], v[184:187], v[112:127]
  v_mfma_f32_4x4x4_16b_bf16 v[32:35], v[184:185], v[46:47], v[32:35]
  v_mfma_f32_4x4x4_16b_bf16 v[40:43], v[186:187], v[46:47], v[40:43]
  s_waitcnt lgkmcnt(0)
  v_mfma_f32_32x32x16_bf16 v[112:127], v[92:95], v[188:191], v[112:127]
  v_mfma_f32_4x4x4_16b_bf16 v[32:35], v[188:189], v[46:47], v[32:35]
  v_mfma_f32_4x4x4_16b_bf16 v[40:43], v[190:191], v[46:47], v[40:43]
  s_waitcnt vmcnt(8)
  s_barrier
  v_add_u32 v6, 0x10000, v6
  v_add_u32 v7, 0x10000, v7
  v_add_u32 v8, 0x10000, v8
  v_add_u32 v9, 0x10000, v9
  v_add_u32 v48, 0x10000, v48
  v_add_u32 v49, 0x10000, v49
  v_add_u32 v50, 0x10000, v50
  v_add_u32 v51, 0x10000, v51
  ds_read_b128 v[192:195], v6 offset:0
  ds_read_b64_tr_b16 v[80:81], v10 offset:32768
  ds_read_b64_tr_b16 v[82:83], v10 offset:33280
  ds_read_b128 v[196:199], v7 offset:0
  ds_read_b64_tr_b16 v[84:85], v11 offset:32768
  ds_read_b64_tr_b16 v[86:87], v11 offset:33280
  ds_read_b128 v[200:203], v8 offset:0
  ds_read_b64_tr_b16 v[88:89], v12 offset:32768
  ds_read_b64_tr_b16 v[90:91], v12 offset:33280
  ds_read_b128 v[204:207], v9 offset:0
  ds_read_b64_tr_b16 v[92:93], v13 offset:32768
  ds_read_b64_tr_b16 v[94:95], v13 offset:33280
  s_waitcnt lgkmcnt(9)
  v_mfma_f32_32x32x16_bf16 v[112:127], v[80:83], v[192:195], v[112:127]
  v_mfma_f32_16x16x32_bf16 v[28:31], v[80:83], v[24:27], v[28:31]
  v_mfma_f32_4x4x4_16b_bf16 v[32:35], v[192:193], v[46:47], v[32:35]
  v_mfma_f32_4x4x4_16b_bf16 v[40:43], v[194:195], v[46:47], v[40:43]
  s_add_u32 m0, s66, 16384
  s_add_u32 s58, s61, 352256
  buffer_load_dwordx4 v5, s[44:47], s58 offen lds
  ds_read_b128 v[208:211], v48 offset:0
  ds_read_b64_tr_b16 v[80:81], v10 offset:40960
  ds_read_b64_tr_b16 v[82:83], v10 offset:41472
  s_waitcnt lgkmcnt(9)
  v_mfma_f32_32x32x16_bf16 v[112:127], v[84:87], v[196:199], v[112:127]
  v_mfma_f32_4x4x4_16b_bf16 v[32:35], v[196:197], v[46:47], v[32:35]
  v_mfma_f32_4x4x4_16b_bf16 v[40:43], v[198:199], v[46:47], v[40:43]
  s_add_u32 m0, s66, 24576
  s_add_u32 s58, s61, 528384
  buffer_load_dwordx4 v5, s[44:47], s58 offen lds
  ds_read_b128 v[212:215], v49 offset:0
  ds_read_b64_tr_b16 v[84:85], v11 offset:40960
  ds_read_b64_tr_b16 v[86:87], v11 offset:41472
  s_waitcnt lgkmcnt(9)
  v_mfma_f32_32x32x16_bf16 v[112:127], v[88:91], v[200:203], v[112:127]
  v_mfma_f32_4x4x4_16b_bf16 v[32:35], v[200:201], v[46:47], v[32:35]
  v_mfma_f32_4x4x4_16b_bf16 v[40:43], v[202:203], v[46:47], v[40:43]
  s_add_u32 m0, s66, 98304
  s_add_u32 s58, s61, 704512
  buffer_load_dwordx4 v5, s[44:47], s58 offen lds
  ds_read_b128 v[216:219], v50 offset:0
  ds_read_b64_tr_b16 v[88:89], v12 offset:40960
  ds_read_b64_tr_b16 v[90:91], v12 offset:41472
  s_waitcnt lgkmcnt(9)
  v_mfma_f32_32x32x16_bf16 v[112:127], v[92:95], v[204:207], v[112:127]
  v_mfma_f32_4x4x4_16b_bf16 v[32:35], v[204:205], v[46:47], v[32:35]
  v_mfma_f32_4x4x4_16b_bf16 v[40:43], v[206:207], v[46:47], v[40:43]
  s_add_u32 m0, s66, 106496
  s_add_u32 s58, s61, 880640
  buffer_load_dwordx4 v5, s[44:47], s58 offen lds
  ds_read_b128 v[220:223], v51 offset:0
  ds_read_b64_tr_b16 v[92:93], v13 offset:40960
  ds_read_b64_tr_b16 v[94:95], v13 offset:41472
  s_waitcnt lgkmcnt(9)
  v_mfma_f32_32x32x16_bf16 v[112:127], v[80:83], v[208:211], v[112:127]
  v_mfma_f32_16x16x32_bf16 v[28:31], v[80:83], v[24:27], v[28:31]
  v_mfma_f32_4x4x4_16b_bf16 v[32:35], v[208:209], v[46:47], v[32:35]
  v_mfma_f32_4x4x4_16b_bf16 v[40:43], v[210:211], v[46:47], v[40:43]
  s_add_u32 m0, s66, 114688
  s_add_u32 s58, s61, 1056768
  buffer_load_dwordx4 v5, s[44:47], s58 offen lds
  s_waitcnt lgkmcnt(6)
  v_mfma_f32_32x32x16_bf16 v[112:127], v[84:87], v[212:215], v[112:127]
  v_mfma_f32_4x4x4_16b_bf16 v[32:35], v[212:213], v[46:47], v[32:35]
  v_mfma_f32_4x4x4_16b_bf16 v[40:43], v[214:215], v[46:47], v[40:43]
  s_add_u32 m0, s66, 122880
  s_add_u32 s58, s61, 1232896
  buffer_load_dwordx4 v5, s[44:47], s58 offen lds
  s_waitcnt lgkmcnt(3)
  v_mfma_f32_32x32x16_bf16 v[112:127], v[88:91], v[216:219], v[112:127]
  v_mfma_f32_4x4x4_16b_bf16 v[32:35], v[216:217], v[46:47], v[32:35]
  v_mfma_f32_4x4x4_16b_bf16 v[40:43], v[218:219], v[46:47], v[40:43]
  s_waitcnt lgkmcnt(0)
  v_mfma_f32_32x32x16_bf16 v[112:127], v[92:95], v[220:223], v[112:127]
  v_mfma_f32_4x4x4_16b_bf16 v[32:35], v[220:221], v[46:47], v[32:35]
  v_mfma_f32_4x4x4_16b_bf16 v[40:43], v[222:223], v[46:47], v[40:43]
  s_waitcnt vmcnt(8)
  s_barrier
  s_cmp_lg_u32 s3, 7
  s_cbranch_scc1 pfw_35
  s_and_b32 s56, s6, 7
  s_mul_i32 s56, s56, 176128
  s_add_u32 s56, s56, s63
  s_sub_u32 s56, s56, 154112
  v_mul_u32_u24 v45, 2752, v1
  buffer_load_dword v15, v45, s[44:47], s56 offen
  buffer_load_dword v15, v45, s[44:47], s56 offen offset:124
pfw_35:
  v_add_u32 v6, 0xffff0000, v6
  v_add_u32 v7, 0xffff0000, v7
  v_add_u32 v8, 0xffff0000, v8
  v_add_u32 v9, 0xffff0000, v9
  v_add_u32 v48, 0xffff0000, v48
  v_add_u32 v49, 0xffff0000, v49
  v_add_u32 v50, 0xffff0000, v50
  v_add_u32 v51, 0xffff0000, v51
  ds_read_b128 v[224:227], v6 offset:0
  ds_read_b64_tr_b16 v[80:81], v10 offset:49152
  ds_read_b64_tr_b16 v[82:83], v10 offset:49664
  ds_read_b128 v[228:231], v7 offset:0
  ds_read_b64_tr_b16 v[84:85], v11 offset:49152
  ds_read_b64_tr_b16 v[86:87], v11 offset:49664
  ds_read_b128 v[232:235], v8 offset:0
  ds_read_b64_tr_b16 v[88:89], v12 offset:49152
  ds_read_b64_tr_b16 v[90:91], v12 offset:49664
  ds_read_b128 v[236:239], v9 offset:0
  ds_read_b64_tr_b16 v[92:93], v13 offset:49152
  ds_read_b64_tr_b16 v[94:95], v13 offset:49664
  s_waitcnt lgkmcnt(9)
  v_mfma_f32_32x32x16_bf16 v[112:127], v[80:83], v[224:227], v[112:127]
  v_mfma_f32_16x16x32_bf16 v[28:31], v[80:83], v[24:27], v[28:31]
  v_mfma_f32_4x4x4_16b_bf16 v[32:35], v[224:225], v[46:47], v[32:35]
  v_mfma_f32_4x4x4_16b_bf16 v[40:43], v[226:227], v[46:47], v[40:43]
  ds_read_b128 v[240:243], v48 offset:0
  ds_read_b64_tr_b16 v[80:81], v10 offset:57344
  ds_read_b64_tr_b16 v[82:83], v10 offset:57856
  s_waitcnt lgkmcnt(9)
  v_mfma_f32_32x32x16_bf16 v[112:127], v[84:87], v[228:231], v[112:127]
  v_mfma_f32_4x4x4_16b_bf16 v[32:35], v[228:229], v[46:47], v[32:35]
  v_mfma_f32_4x4x4_16b_bf16 v[40:43], v[230:231], v[46:47], v[40:43]
  ds_read_b128 v[244:247], v49 offset:0
  ds_read_b64_tr_b16 v[84:85], v11 offset:57344
  ds_read_b64_tr_b16 v[86:87], v11 offset:57856
  s_waitcnt lgkmcnt(9)
  v_mfma_f32_32x32x16_bf16 v[112:127], v[88:91], v[232:235], v[112:127]
  v_mfma_f32_4x4x4_16b_bf16 v[32:35], v[232:233], v[46:47], v[32:35]
  v_mfma_f32_4x4x4_16b_bf16 v[40:43], v[234:235], v[46:47], v[40:43]
  ds_read_b128 v[248:251], v50 offset:0
  ds_read_b64_tr_b16 v[88:89], v12 offset:57344
  ds_read_b64_tr_b16 v[90:91], v12 offset:57856
  s_waitcnt lgkmcnt(9)
  v_mfma_f32_32x32x16_bf16 v[112:127], v[92:95], v[236:239], v[112:127]
  v_mfma_f32_4x4x4_16b_bf16 v[32:35], v[236:237], v[46:47], v[32:35]
  v_mfma_f32_4x4x4_16b_bf16 v[40:43], v[238:239], v[46:47], v[40:43]
  ds_read_b128 v[252:255], v51 offset:0
  ds_read_b64_tr_b16 v[92:93], v13 offset:57344
  ds_read_b64_tr_b16 v[94:95], v13 offset:57856
  s_waitcnt lgkmcnt(9)
  v_mfma_f32_32x32x16_bf16 v[112:127], v[80:83], v[240:243], v[112:127]
  v_mfma_f32_16x16x32_bf16 v[28:31], v[80:83], v[24:27], v[28:31]
  v_mfma_f32_4x4x4_16b_bf16 v[32:35], v[240:241], v[46:47], v[32:35]
  v_mfma_f32_4x4x4_16b_bf16 v[40:43], v[242:243], v[46:47], v[40:43]
  s_waitcnt lgkmcnt(6)
  v_mfma_f32_32x32x16_bf16 v[112:127], v[84:87], v[244:247], v[112:127]
  v_mfma_f32_4x4x4_16b_bf16 v[32:35], v[244:245], v[46:47], v[32:35]
  v_mfma_f32_4x4x4_16b_bf16 v[40:43], v[246:247], v[46:47], v[40:43]
  s_waitcnt lgkmcnt(3)
  v_mfma_f32_32x32x16_bf16 v[112:127], v[88:91], v[248:251], v[112:127]
  v_mfma_f32_4x4x4_16b_bf16 v[32:35], v[248:249], v[46:47], v[32:35]
  v_mfma_f32_4x4x4_16b_bf16 v[40:43], v[250:251], v[46:47], v[40:43]
  s_waitcnt lgkmcnt(0)
  v_mfma_f32_32x32x16_bf16 v[112:127], v[92:95], v[252:255], v[112:127]
  v_mfma_f32_4x4x4_16b_bf16 v[32:35], v[252:253], v[46:47], v[32:35]
  v_mfma_f32_4x4x4_16b_bf16 v[40:43], v[254:255], v[46:47], v[40:43]
su_29_J:
  s_nop 7
  s_mov_b64 exec, s[74:75]
  ds_write_b32 v22, v28 offset:0
  ds_write_b32 v22, v29 offset:16
  ds_write_b32 v22, v30 offset:32
  ds_write_b32 v22, v31 offset:48
  s_mov_b64 exec, -1
  v_add_f32 v32, v32, v40
  v_add_f32 v33, v33, v41
  v_add_f32 v34, v34, v42
  v_add_f32 v35, v35, v43
  v_and_b32 v36, 3, v1
  v_cmp_eq_u32 vcc, 1, v36
  v_cmp_eq_u32 s[82:83], 2, v36
  v_cmp_eq_u32 s[70:71], 3, v36
  s_nop 1
  v_cndmask_b32 v32, v32, v33, vcc
  v_cndmask_b32 v32, v32, v34, s[82:83]
  v_cndmask_b32 v32, v32, v35, s[70:71]
  v_mov_b32 v33, v32
  s_nop 1
  v_permlane32_swap_b32 v32, v33
  v_add_f32 v32, v32, v33
  v_and_b32 v36, 31, v1
  v_lshlrev_b32 v3, 4, v36
  s_lshl_b32 s56, s4, 5
  v_add_u32 v36, s56, v36
  v_lshlrev_b32 v36, 2, v36
  v_add_u32 v36, 137216, v36
  s_lshl_b32 s56, s5, 9
  v_add_u32 v37, s56, v36
  ds_write_b32 v37, v32
  s_add_u32 s56, s56, 131072
  v_add_u32 v3, s56, v3
  s_waitcnt vmcnt(0) lgkmcnt(0)
  s_barrier
  ds_read_b32 v38, v36
  ds_read_b32 v39, v36 offset:512
  ds_read_b64_tr_b16 v[80:81], v10 offset:0
  ds_read_b64_tr_b16 v[82:83], v10 offset:512
  ds_read_b64_tr_b16 v[84:85], v11 offset:0
  ds_read_b64_tr_b16 v[86:87], v11 offset:512
  ds_read_b64_tr_b16 v[88:89], v12 offset:0
  ds_read_b64_tr_b16 v[90:91], v12 offset:512
  ds_read_b128 v[40:43], v3 offset:0
  s_waitcnt lgkmcnt(0)
  v_add_f32 v40, v40, v41
  v_add_f32 v42, v42, v43
  v_add_f32 v44, v40, v42
  ds_write_b32 v14, v44
  v_mul_f32 v38, 0x3b000000, v38
  v_mul_f32 v39, 0x3b000000, v39
  v_fma_f32 v39, -v38, v38, v39
  v_max_f32 v39, 0, v39
  v_add_f32 v39, 0x3727c5ac, v39
  v_sub_f32 v18, 0, v38
  v_rsq_f32 v19, v39
  v_mov_b32 v20, v39
  s_nop 0
  v_mul_f32 v17, 0xc0135761, v19
  v_mul_f32 v2, v19, v19
  v_mul_f32 v2, v2, v19
  v_mul_f32 v2, 0xbdd2d3e8, v2
  ds_read_b64_tr_b16 v[92:93], v13 offset:0
  ds_read_b64_tr_b16 v[94:95], v13 offset:512
  v_mfma_f32_32x32x16_bf16 v[96:111], v[80:83], v[128:131], 0
  v_mfma_f32_16x16x32_bf16 v[28:31], v[80:83], v[24:27], 0
  ds_read_b128 v[36:39], v21 offset:0
  ds_read_b128 v[40:43], v21 offset:32
  ds_read_b64_tr_b16 v[80:81], v10 offset:8192
  ds_read_b64_tr_b16 v[82:83], v10 offset:8704
  v_mfma_f32_32x32x16_bf16 v[96:111], v[84:87], v[132:135], v[96:111]
  s_add_u32 m0, s66, 32768
  s_add_u32 s58, s62, 0
  buffer_load_dwordx4 v5, s[40:43], s58 offen lds
  ds_read_b64_tr_b16 v[84:85], v11 offset:8192
  ds_read_b64_tr_b16 v[86:87], v11 offset:8704
  v_mfma_f32_32x32x16_bf16 v[96:111], v[88:91], v[136:139], v[96:111]
  ds_read_b64_tr_b16 v[88:89], v12 offset:8192
  ds_read_b64_tr_b16 v[90:91], v12 offset:8704
  s_waitcnt lgkmcnt(8)
  v_mfma_f32_32x32x16_bf16 v[96:111], v[92:95], v[140:143], v[96:111]
  s_add_u32 m0, s66, 40960
  s_add_u32 s58, s62, 176128
  buffer_load_dwordx4 v5, s[40:43], s58 offen lds
  s_waitcnt lgkmcnt(7)
  v_fma_f32 v44, v36, v18, v112
  v_fma_f32 v45, v37, v18, v113
  v_fma_f32 v46, v38, v18, v114
  ds_read_b64_tr_b16 v[92:93], v13 offset:8192
  ds_read_b64_tr_b16 v[94:95], v13 offset:8704
  s_waitcnt lgkmcnt(6)
  v_mfma_f32_32x32x16_bf16 v[96:111], v[80:83], v[144:147], v[96:111]
  v_mfma_f32_16x16x32_bf16 v[28:31], v[80:83], v[24:27], v[28:31]
  v_fma_f32 v47, v39, v18, v115
  ds_read_b128 v[36:39], v21 offset:64
  v_mul_f32 v48, v44, v44
  ds_read_b64_tr_b16 v[80:81], v10 offset:16384
  ds_read_b64_tr_b16 v[82:83], v10 offset:16896
  s_waitcnt lgkmcnt(7)
  v_mfma_f32_32x32x16_bf16 v[96:111], v[84:87], v[148:151], v[96:111]
  s_add_u32 m0, s66, 49152
  s_add_u32 s58, s62, 352256
  buffer_load_dwordx4 v5, s[40:43], s58 offen lds
  v_mul_f32 v49, v45, v45
  v_mul_f32 v50, v46, v46
  v_mul_f32 v51, v47, v47
  v_fma_f32 v48, v48, v2, v17
  ds_read_b64_tr_b16 v[84:85], v11 offset:16384
  ds_read_b64_tr_b16 v[86:87], v11 offset:16896
  s_waitcnt lgkmcnt(7)
  v_mfma_f32_32x32x16_bf16 v[96:111], v[88:91], v[152:155], v[96:111]
  v_fma_f32 v49, v49, v2, v17
  v_fma_f32 v50, v50, v2, v17
  v_fma_f32 v51, v51, v2, v17
  ds_read_b64_tr_b16 v[88:89], v12 offset:16384
  ds_read_b64_tr_b16 v[90:91], v12 offset:16896
  s_waitcnt lgkmcnt(7)
  v_mfma_f32_32x32x16_bf16 v[96:111], v[92:95], v[156:159], v[96:111]
  s_add_u32 m0, s66, 57344
  s_add_u32 s58, s62, 528384
  buffer_load_dwordx4 v5, s[40:43], s58 offen lds
  v_mul_f32 v48, v48, v44
  v_mul_f32 v49, v49, v45
  v_mul_f32 v50, v50, v46
  v_mul_f32 v51, v51, v47
  ds_read_b64_tr_b16 v[92:93], v13 offset:16384
  ds_read_b64_tr_b16 v[94:95], v13 offset:16896
  s_waitcnt lgkmcnt(6)
  v_mfma_f32_32x32x16_bf16 v[96:111], v[80:83], v[160:163], v[96:111]
  v_mfma_f32_16x16x32_bf16 v[28:31], v[80:83], v[24:27], v[28:31]
  v_exp_f32 v48, v48
  v_exp_f32 v49, v49
  ds_read_b64_tr_b16 v[80:81], v10 offset:24576
  ds_read_b64_tr_b16 v[82:83], v10 offset:25088
  s_waitcnt lgkmcnt(6)
  v_mfma_f32_32x32x16_bf16 v[96:111], v[84:87], v[164:167], v[96:111]
  s_add_u32 m0, s66, 65536
  s_add_u32 s58, s62, 704512
  buffer_load_dwordx4 v5, s[40:43], s58 offen lds
  v_exp_f32 v50, v50
  v_exp_f32 v51, v51
  ds_read_b64_tr_b16 v[84:85], v11 offset:24576
  ds_read_b64_tr_b16 v[86:87], v11 offset:25088
  s_waitcnt lgkmcnt(6)
  v_mfma_f32_32x32x16_bf16 v[96:111], v[88:91], v[168:171], v[96:111]
  v_fma_f32 v48, v48, v20, v20
  v_fma_f32 v49, v49, v20, v20
  v_fma_f32 v50, v50, v20, v20
  ds_read_b64_tr_b16 v[88:89], v12 offset:24576
  ds_read_b64_tr_b16 v[90:91], v12 offset:25088
  s_waitcnt lgkmcnt(6)
  v_mfma_f32_32x32x16_bf16 v[96:111], v[92:95], v[172:175], v[96:111]
  s_add_u32 m0, s66, 73728
  s_add_u32 s58, s62, 880640
  buffer_load_dwordx4 v5, s[40:43], s58 offen lds
  v_fma_f32 v51, v51, v20, v20
  v_rcp_f32 v48, v48
  ds_read_b64_tr_b16 v[92:93], v13 offset:24576
  ds_read_b64_tr_b16 v[94:95], v13 offset:25088
  s_waitcnt lgkmcnt(6)
  v_mfma_f32_32x32x16_bf16 v[96:111], v[80:83], v[176:179], v[96:111]
  v_mfma_f32_16x16x32_bf16 v[28:31], v[80:83], v[24:27], v[28:31]
  v_rcp_f32 v49, v49
  v_rcp_f32 v50, v50
  v_add_u32 v10, 0x10000, v10
  v_add_u32 v11, 0x10000, v11
  v_add_u32 v12, 0x10000, v12
  v_add_u32 v13, 0x10000, v13
  ds_read_b64_tr_b16 v[80:81], v10 offset:32768
  ds_read_b64_tr_b16 v[82:83], v10 offset:33280
  s_waitcnt lgkmcnt(6)
  v_mfma_f32_32x32x16_bf16 v[96:111], v[84:87], v[180:183], v[96:111]
  s_add_u32 m0, s66, 81920
  s_add_u32 s58, s62, 1056768
  buffer_load_dwordx4 v5, s[40:43], s58 offen lds
  v_rcp_f32 v51, v51
  v_mul_f32 v48, v48, v44
  ds_read_b64_tr_b16 v[84:85], v11 offset:32768
  ds_read_b64_tr_b16 v[86:87], v11 offset:33280
  s_waitcnt lgkmcnt(6)
  v_mfma_f32_32x32x16_bf16 v[96:111], v[88:91], v[184:187], v[96:111]
  v_mul_f32 v49, v49, v45
  v_mul_f32 v50, v50, v46
  v_mul_f32 v51, v51, v47
  ds_read_b64_tr_b16 v[88:89], v12 offset:32768
  ds_read_b64_tr_b16 v[90:91], v12 offset:33280
  s_waitcnt lgkmcnt(6)
  v_mfma_f32_32x32x16_bf16 v[96:111], v[92:95], v[188:191], v[96:111]
  s_add_u32 m0, s66, 90112
  s_add_u32 s58, s62, 1232896
  buffer_load_dwordx4 v5, s[40:43], s58 offen lds
  v_fma_f32 v44, v40, v18, v116
  v_fma_f32 v45, v41, v18, v117
  v_fma_f32 v46, v42, v18, v118
  v_fma_f32 v47, v43, v18, v119
  ds_read_b64_tr_b16 v[92:93], v13 offset:32768
  ds_read_b64_tr_b16 v[94:95], v13 offset:33280
  s_waitcnt lgkmcnt(6)
  v_mfma_f32_32x32x16_bf16 v[96:111], v[80:83], v[192:195], v[96:111]
  v_mfma_f32_16x16x32_bf16 v[28:31], v[80:83], v[24:27], v[28:31]
  ds_read_b128 v[40:43], v21 offset:96
  v_mul_f32 v52, v44, v44
  v_mul_f32 v53, v45, v45
  ds_read_b64_tr_b16 v[80:81], v10 offset:40960
  ds_read_b64_tr_b16 v[82:83], v10 offset:41472
  s_waitcnt lgkmcnt(7)
  v_mfma_f32_32x32x16_bf16 v[96:111], v[84:87], v[196:199], v[96:111]
  v_mul_f32 v54, v46, v46
  v_mul_f32 v55, v47, v47
  v_fma_f32 v52, v52, v2, v17
  v_fma_f32 v53, v53, v2, v17
  ds_read_b64_tr_b16 v[84:85], v11 offset:40960
  ds_read_b64_tr_b16 v[86:87], v11 offset:41472
  s_waitcnt lgkmcnt(7)
  v_mfma_f32_32x32x16_bf16 v[96:111], v[88:91], v[200:203], v[96:111]
  v_fma_f32 v54, v54, v2, v17
  v_fma_f32 v55, v55, v2, v17
  v_mul_f32 v52, v52, v44
  ds_read_b64_tr_b16 v[88:89], v12 offset:40960
  ds_read_b64_tr_b16 v[90:91], v12 offset:41472
  s_waitcnt lgkmcnt(7)
  v_mfma_f32_32x32x16_bf16 v[96:111], v[92:95], v[204:207], v[96:111]
  v_mul_f32 v53, v53, v45
  v_mul_f32 v54, v54, v46
  v_mul_f32 v55, v55, v47
  ds_read_b64_tr_b16 v[92:93], v13 offset:40960
  ds_read_b64_tr_b16 v[94:95], v13 offset:41472
  s_waitcnt lgkmcnt(6)
  v_mfma_f32_32x32x16_bf16 v[96:111], v[80:83], v[208:211], v[96:111]
  v_mfma_f32_16x16x32_bf16 v[28:31], v[80:83], v[24:27], v[28:31]
  v_exp_f32 v52, v52
  v_exp_f32 v53, v53
  ds_read_b64_tr_b16 v[80:81], v10 offset:49152
  ds_read_b64_tr_b16 v[82:83], v10 offset:49664
  s_waitcnt lgkmcnt(6)
  v_mfma_f32_32x32x16_bf16 v[96:111], v[84:87], v[212:215], v[96:111]
  v_exp_f32 v54, v54
  v_exp_f32 v55, v55
  ds_read_b64_tr_b16 v[84:85], v11 offset:49152
  ds_read_b64_tr_b16 v[86:87], v11 offset:49664
  s_waitcnt lgkmcnt(6)
  v_mfma_f32_32x32x16_bf16 v[96:111], v[88:91], v[216:219], v[96:111]
  v_fma_f32 v52, v52, v20, v20
  v_fma_f32 v53, v53, v20, v20
  v_fma_f32 v54, v54, v20, v20
  ds_read_b64_tr_b16 v[88:89], v12 offset:49152
  ds_read_b64_tr_b16 v[90:91], v12 offset:49664
  s_waitcnt lgkmcnt(6)
  v_mfma_f32_32x32x16_bf16 v[96:111], v[92:95], v[220:223], v[96:111]
  v_fma_f32 v55, v55, v20, v20
  v_rcp_f32 v52, v52
  ds_read_b64_tr_b16 v[92:93], v13 offset:49152
  ds_read_b64_tr_b16 v[94:95], v13 offset:49664
  s_waitcnt lgkmcnt(6)
  v_mfma_f32_32x32x16_bf16 v[96:111], v[80:83], v[224:227], v[96:111]
  v_mfma_f32_16x16x32_bf16 v[28:31], v[80:83], v[24:27], v[28:31]
  v_rcp_f32 v53, v53
  v_rcp_f32 v54, v54
  ds_read_b64_tr_b16 v[80:81], v10 offset:57344
  ds_read_b64_tr_b16 v[82:83], v10 offset:57856
  s_waitcnt lgkmcnt(6)
  v_mfma_f32_32x32x16_bf16 v[96:111], v[84:87], v[228:231], v[96:111]
  v_rcp_f32 v55, v55
  v_mul_f32 v52, v52, v44
  v_mul_f32 v53, v53, v45
  ds_read_b64_tr_b16 v[84:85], v11 offset:57344
  ds_read_b64_tr_b16 v[86:87], v11 offset:57856
  s_waitcnt lgkmcnt(6)
  v_mfma_f32_32x32x16_bf16 v[96:111], v[88:91], v[232:235], v[96:111]
  v_mul_f32 v54, v54, v46
  v_mul_f32 v55, v55, v47
  v_fma_f32 v56, v36, v18, v120
  ds_read_b64_tr_b16 v[88:89], v12 offset:57344
  ds_read_b64_tr_b16 v[90:91], v12 offset:57856
  s_waitcnt lgkmcnt(6)
  v_mfma_f32_32x32x16_bf16 v[96:111], v[92:95], v[236:239], v[96:111]
  v_fma_f32 v57, v37, v18, v121
  v_fma_f32 v58, v38, v18, v122
  v_fma_f32 v59, v39, v18, v123
  v_fma_f32 v60, v40, v18, v124
  ds_read_b64_tr_b16 v[92:93], v13 offset:57344
  ds_read_b64_tr_b16 v[94:95], v13 offset:57856
  s_waitcnt lgkmcnt(6)
  v_mfma_f32_32x32x16_bf16 v[96:111], v[80:83], v[240:243], v[96:111]
  v_mfma_f32_16x16x32_bf16 v[28:31], v[80:83], v[24:27], v[28:31]
  v_fma_f32 v61, v41, v18, v125
  v_fma_f32 v62, v42, v18, v126
  v_fma_f32 v63, v43, v18, v127
  s_waitcnt lgkmcnt(4)
  v_mfma_f32_32x32x16_bf16 v[96:111], v[84:87], v[244:247], v[96:111]
  s_nop 3
  s_mov_b64 exec, s[74:75]
  ds_write_b32 v22, v28 offset:1024
  ds_write_b32 v22, v29 offset:1040
  ds_write_b32 v22, v30 offset:1056
  ds_write_b32 v22, v31 offset:1072
  s_mov_b64 exec, -1
  v_add_u32 v10, 0xffff8000, v10
  v_add_u32 v11, 0xffff8000, v11
  v_add_u32 v12, 0xffff8000, v12
  v_add_u32 v13, 0xffff8000, v13
  s_waitcnt vmcnt(0) lgkmcnt(0)
  s_barrier
  ds_read_b64_tr_b16 v[80:81], v10 offset:0
  ds_read_b64_tr_b16 v[82:83], v10 offset:512
  ds_read_b64_tr_b16 v[84:85], v11 offset:0
  ds_read_b64_tr_b16 v[86:87], v11 offset:512
  ds_read_b128 v[40:43], v3 offset:1024
  v_mfma_f32_32x32x16_bf16 v[96:111], v[88:91], v[248:251], v[96:111]
  ds_read_b64_tr_b16 v[88:89], v12 offset:0
  ds_read_b64_tr_b16 v[90:91], v12 offset:512
  v_mfma_f32_32x32x16_bf16 v[96:111], v[92:95], v[252:255], v[96:111]
  s_waitcnt lgkmcnt(2)
  v_add_f32 v40, v40, v41
  v_add_f32 v42, v42, v43
  v_add_f32 v44, v40, v42
  ds_write_b32 v14, v44
  ds_read_b64_tr_b16 v[92:93], v13 offset:0
  ds_read_b64_tr_b16 v[94:95], v13 offset:512
  v_mfma_f32_32x32x16_bf16 v[112:127], v[80:83], v[128:131], 0
  v_mfma_f32_16x16x32_bf16 v[28:31], v[80:83], v[24:27], 0
  v_mul_f32 v44, v56, v56
  v_mul_f32 v45, v57, v57
  v_mul_f32 v46, v58, v58
  v_mul_f32 v47, v59, v59
  ds_read_b64_tr_b16 v[80:81], v10 offset:8192
  ds_read_b64_tr_b16 v[82:83], v10 offset:8704
  v_mfma_f32_32x32x16_bf16 v[112:127], v[84:87], v[132:135], v[112:127]
  s_add_u32 m0, s66, 0
  s_add_u32 s58, s63, 0
  buffer_load_dwordx4 v5, s[44:47], s58 offen lds
  v_fma_f32 v44, v44, v2, v17
  v_fma_f32 v45, v45, v2, v17
  v_fma_f32 v46, v46, v2, v17
  v_fma_f32 v47, v47, v2, v17
  ds_read_b64_tr_b16 v[84:85], v11 offset:8192
  ds_read_b64_tr_b16 v[86:87], v11 offset:8704
  s_waitcnt lgkmcnt(7)
  v_mfma_f32_32x32x16_bf16 v[112:127], v[88:91], v[136:139], v[112:127]
  v_mul_f32 v44, v44, v56
  v_mul_f32 v45, v45, v57
  v_mul_f32 v46, v46, v58
  v_mul_f32 v47, v47, v59
  ds_read_b64_tr_b16 v[88:89], v12 offset:8192
  ds_read_b64_tr_b16 v[90:91], v12 offset:8704
  s_waitcnt lgkmcnt(6)
  v_mfma_f32_32x32x16_bf16 v[112:127], v[92:95], v[140:143], v[112:127]
  s_add_u32 m0, s66, 8192
  s_add_u32 s58, s63, 176128
  buffer_load_dwordx4 v5, s[44:47], s58 offen lds
  v_exp_f32 v44, v44
  v_exp_f32 v45, v45
  ds_read_b64_tr_b16 v[92:93], v13 offset:8192
  ds_read_b64_tr_b16 v[94:95], v13 offset:8704
  s_waitcnt lgkmcnt(6)
  v_mfma_f32_32x32x16_bf16 v[112:127], v[80:83], v[144:147], v[112:127]
  v_mfma_f32_16x16x32_bf16 v[28:31], v[80:83], v[24:27], v[28:31]
  v_exp_f32 v46, v46
  v_exp_f32 v47, v47
  ds_read_b64_tr_b16 v[80:81], v10 offset:16384
  ds_read_b64_tr_b16 v[82:83], v10 offset:16896
  s_waitcnt lgkmcnt(6)
  v_mfma_f32_32x32x16_bf16 v[112:127], v[84:87], v[148:151], v[112:127]
  s_add_u32 m0, s66, 16384
  s_add_u32 s58, s63, 352256
  buffer_load_dwordx4 v5, s[44:47], s58 offen lds
  v_fma_f32 v44, v44, v20, v20
  v_fma_f32 v45, v45, v20, v20
  v_fma_f32 v46, v46, v20, v20
  v_fma_f32 v47, v47, v20, v20
  ds_read_b64_tr_b16 v[84:85], v11 offset:16384
  ds_read_b64_tr_b16 v[86:87], v11 offset:16896
  s_waitcnt lgkmcnt(6)
  v_mfma_f32_32x32x16_bf16 v[112:127], v[88:91], v[152:155], v[112:127]
  v_rcp_f32 v44, v44
  v_rcp_f32 v45, v45
  ds_read_b64_tr_b16 v[88:89], v12 offset:16384
  ds_read_b64_tr_b16 v[90:91], v12 offset:16896
  s_waitcnt lgkmcnt(6)
  v_mfma_f32_32x32x16_bf16 v[112:127], v[92:95], v[156:159], v[112:127]
  s_add_u32 m0, s66, 24576
  s_add_u32 s58, s63, 528384
  buffer_load_dwordx4 v5, s[44:47], s58 offen lds
  v_rcp_f32 v46, v46
  v_rcp_f32 v47, v47
  ds_read_b64_tr_b16 v[92:93], v13 offset:16384
  ds_read_b64_tr_b16 v[94:95], v13 offset:16896
  s_waitcnt lgkmcnt(6)
  v_mfma_f32_32x32x16_bf16 v[112:127], v[80:83], v[160:163], v[112:127]
  v_mfma_f32_16x16x32_bf16 v[28:31], v[80:83], v[24:27], v[28:31]
  v_mul_f32 v56, v56, v44
  v_mul_f32 v57, v57, v45
  v_mul_f32 v58, v58, v46
  v_mul_f32 v59, v59, v47
  ds_read_b64_tr_b16 v[80:81], v10 offset:24576
  ds_read_b64_tr_b16 v[82:83], v10 offset:25088
  s_waitcnt lgkmcnt(6)
  v_mfma_f32_32x32x16_bf16 v[112:127], v[84:87], v[164:167], v[112:127]
  s_add_u32 m0, s66, 98304
  s_add_u32 s58, s63, 704512
  buffer_load_dwordx4 v5, s[44:47], s58 offen lds
  v_mul_f32 v44, v60, v60
  v_mul_f32 v45, v61, v61
  v_mul_f32 v46, v62, v62
  v_mul_f32 v47, v63, v63
  ds_read_b64_tr_b16 v[84:85], v11 offset:24576
  ds_read_b64_tr_b16 v[86:87], v11 offset:25088
  s_waitcnt lgkmcnt(6)
  v_mfma_f32_32x32x16_bf16 v[112:127], v[88:91], v[168:171], v[112:127]
  v_fma_f32 v44, v44, v2, v17
  v_fma_f32 v45, v45, v2, v17
  v_fma_f32 v46, v46, v2, v17
  v_fma_f32 v47, v47, v2, v17
  ds_read_b64_tr_b16 v[88:89], v12 offset:24576
  ds_read_b64_tr_b16 v[90:91], v12 offset:25088
  s_waitcnt lgkmcnt(6)
  v_mfma_f32_32x32x16_bf16 v[112:127], v[92:95], v[172:175], v[112:127]
  s_add_u32 m0, s66, 106496
  s_add_u32 s58, s63, 880640
  buffer_load_dwordx4 v5, s[44:47], s58 offen lds
  v_mul_f32 v44, v44, v60
  v_mul_f32 v45, v45, v61
  v_mul_f32 v46, v46, v62
  v_mul_f32 v47, v47, v63
  ds_read_b64_tr_b16 v[92:93], v13 offset:24576
  ds_read_b64_tr_b16 v[94:95], v13 offset:25088
  s_waitcnt lgkmcnt(6)
  v_mfma_f32_32x32x16_bf16 v[112:127], v[80:83], v[176:179], v[112:127]
  v_mfma_f32_16x16x32_bf16 v[28:31], v[80:83], v[24:27], v[28:31]
  v_exp_f32 v44, v44
  v_exp_f32 v45, v45
  ds_read_b64_tr_b16 v[80:81], v10 offset:32768
  ds_read_b64_tr_b16 v[82:83], v10 offset:33280
  s_waitcnt lgkmcnt(6)
  v_mfma_f32_32x32x16_bf16 v[112:127], v[84:87], v[180:183], v[112:127]
  s_add_u32 m0, s66, 114688
  s_add_u32 s58, s63, 1056768
  buffer_load_dwordx4 v5, s[44:47], s58 offen lds
  v_exp_f32 v46, v46
  v_exp_f32 v47, v47
  ds_read_b64_tr_b16 v[84:85], v11 offset:32768
  ds_read_b64_tr_b16 v[86:87], v11 offset:33280
  s_waitcnt lgkmcnt(6)
  v_mfma_f32_32x32x16_bf16 v[112:127], v[88:91], v[184:187], v[112:127]
  v_fma_f32 v44, v44, v20, v20
  v_fma_f32 v45, v45, v20, v20
  v_fma_f32 v46, v46, v20, v20
  v_fma_f32 v47, v47, v20, v20
  ds_read_b64_tr_b16 v[88:89], v12 offset:32768
  ds_read_b64_tr_b16 v[90:91], v12 offset:33280
  s_waitcnt lgkmcnt(6)
  v_mfma_f32_32x32x16_bf16 v[112:127], v[92:95], v[188:191], v[112:127]
  s_add_u32 m0, s66, 122880
  s_add_u32 s58, s63, 1232896
  buffer_load_dwordx4 v5, s[44:47], s58 offen lds
  v_rcp_f32 v44, v44
  v_rcp_f32 v45, v45
  ds_read_b64_tr_b16 v[92:93], v13 offset:32768
  ds_read_b64_tr_b16 v[94:95], v13 offset:33280
  s_waitcnt lgkmcnt(6)
  v_mfma_f32_32x32x16_bf16 v[112:127], v[80:83], v[192:195], v[112:127]
  v_mfma_f32_16x16x32_bf16 v[28:31], v[80:83], v[24:27], v[28:31]
  v_rcp_f32 v46, v46
  v_rcp_f32 v47, v47
  ds_read_b64_tr_b16 v[80:81], v10 offset:40960
  ds_read_b64_tr_b16 v[82:83], v10 offset:41472
  s_waitcnt lgkmcnt(6)
  v_mfma_f32_32x32x16_bf16 v[112:127], v[84:87], v[196:199], v[112:127]
  v_mul_f32 v60, v60, v44
  v_mul_f32 v61, v61, v45
  v_mul_f32 v62, v62, v46
  v_mul_f32 v63, v63, v47
  ds_read_b64_tr_b16 v[84:85], v11 offset:40960
  ds_read_b64_tr_b16 v[86:87], v11 offset:41472
  s_waitcnt lgkmcnt(6)
  v_mfma_f32_32x32x16_bf16 v[112:127], v[88:91], v[200:203], v[112:127]
  s_lshl_b32 s57, s68, 12
  s_lshl_b32 s58, s5, 11
  s_add_u32 s57, s57, s58
  s_add_u32 s57, s57, s67
  ds_read_b128 v[36:39], v21 offset:0
  ds_read_b128 v[40:43], v21 offset:32
  ds_read_b64_tr_b16 v[88:89], v12 offset:40960
  ds_read_b64_tr_b16 v[90:91], v12 offset:41472
  s_waitcnt lgkmcnt(8)
  v_mfma_f32_32x32x16_bf16 v[112:127], v[92:95], v[204:207], v[112:127]
  ds_read_b64_tr_b16 v[92:93], v13 offset:40960
  ds_read_b64_tr_b16 v[94:95], v13 offset:41472
  s_waitcnt lgkmcnt(8)
  v_mfma_f32_32x32x16_bf16 v[112:127], v[80:83], v[208:211], v[112:127]
  v_mfma_f32_16x16x32_bf16 v[28:31], v[80:83], v[24:27], v[28:31]
  ds_read_b64_tr_b16 v[80:81], v10 offset:49152
  ds_read_b64_tr_b16 v[82:83], v10 offset:49664
  s_waitcnt lgkmcnt(8)
  v_mfma_f32_32x32x16_bf16 v[112:127], v[84:87], v[212:215], v[112:127]
  s_waitcnt lgkmcnt(7)
  v_fma_f32 v44, v36, v18, v96
  v_fma_f32 v45, v37, v18, v97
  v_fma_f32 v46, v38, v18, v98
  v_fma_f32 v47, v39, v18, v99
  ds_read_b128 v[36:39], v21 offset:64
  v_mul_f32 v44, v44, v48
  ds_read_b64_tr_b16 v[84:85], v11 offset:49152
  ds_read_b64_tr_b16 v[86:87], v11 offset:49664
  s_waitcnt lgkmcnt(7)
  v_mfma_f32_32x32x16_bf16 v[112:127], v[88:91], v[216:219], v[112:127]
  v_mul_f32 v45, v45, v49
  v_mul_f32 v46, v46, v50
  v_mul_f32 v47, v47, v51
  v_cvt_pk_bf16_f32 v48, v44, v45
  v_cvt_pk_bf16_f32 v49, v46, v47
  ds_read_b64_tr_b16 v[88:89], v12 offset:49152
  ds_read_b64_tr_b16 v[90:91], v12 offset:49664
  s_waitcnt lgkmcnt(7)
  v_mfma_f32_32x32x16_bf16 v[112:127], v[92:95], v[220:223], v[112:127]
  v_fma_f32 v44, v40, v18, v100
  v_fma_f32 v45, v41, v18, v101
  v_fma_f32 v46, v42, v18, v102
  v_fma_f32 v47, v43, v18, v103
  ds_read_b128 v[40:43], v21 offset:96
  v_mul_f32 v44, v44, v52
  ds_read_b64_tr_b16 v[92:93], v13 offset:49152
  ds_read_b64_tr_b16 v[94:95], v13 offset:49664
  s_waitcnt lgkmcnt(8)
  v_mfma_f32_32x32x16_bf16 v[112:127], v[80:83], v[224:227], v[112:127]
  v_mfma_f32_16x16x32_bf16 v[28:31], v[80:83], v[24:27], v[28:31]
  v_mul_f32 v45, v45, v53
  v_mul_f32 v46, v46, v54
  v_mul_f32 v47, v47, v55
  v_cvt_pk_bf16_f32 v50, v44, v45
  v_cvt_pk_bf16_f32 v51, v46, v47
  ds_read_b64_tr_b16 v[80:81], v10 offset:57344
  ds_read_b64_tr_b16 v[82:83], v10 offset:57856
  s_waitcnt lgkmcnt(7)
  v_mfma_f32_32x32x16_bf16 v[112:127], v[84:87], v[228:231], v[112:127]
  buffer_store_dwordx4 v[48:51], v23, s[48:51], s57 offen offset:0 sc1
  v_fma_f32 v44, v36, v18, v104
  v_fma_f32 v45, v37, v18, v105
  v_fma_f32 v46, v38, v18, v106
  v_fma_f32 v47, v39, v18, v107
  v_mul_f32 v44, v44, v56
  ds_read_b64_tr_b16 v[84:85], v11 offset:57344
  ds_read_b64_tr_b16 v[86:87], v11 offset:57856
  s_waitcnt lgkmcnt(7)
  v_mfma_f32_32x32x16_bf16 v[112:127], v[88:91], v[232:235], v[112:127]
  v_mul_f32 v45, v45, v57
  v_mul_f32 v46, v46, v58
  v_mul_f32 v47, v47, v59
  v_cvt_pk_bf16_f32 v56, v44, v45
  v_cvt_pk_bf16_f32 v57, v46, v47
  ds_read_b64_tr_b16 v[88:89], v12 offset:57344
  ds_read_b64_tr_b16 v[90:91], v12 offset:57856
  s_waitcnt lgkmcnt(6)
  v_mfma_f32_32x32x16_bf16 v[112:127], v[92:95], v[236:239], v[112:127]
  v_fma_f32 v44, v40, v18, v108
  v_fma_f32 v45, v41, v18, v109
  v_fma_f32 v46, v42, v18, v110
  v_fma_f32 v47, v43, v18, v111
  v_mul_f32 v44, v44, v60
  v_mul_f32 v45, v45, v61
  ds_read_b64_tr_b16 v[92:93], v13 offset:57344
  ds_read_b64_tr_b16 v[94:95], v13 offset:57856
  s_waitcnt lgkmcnt(6)
  v_mfma_f32_32x32x16_bf16 v[112:127], v[80:83], v[240:243], v[112:127]
  v_mfma_f32_16x16x32_bf16 v[28:31], v[80:83], v[24:27], v[28:31]
  v_mul_f32 v46, v46, v62
  v_mul_f32 v47, v47, v63
  v_cvt_pk_bf16_f32 v58, v44, v45
  v_cvt_pk_bf16_f32 v59, v46, v47
  buffer_store_dwordx4 v[56:59], v23, s[48:51], s57 offen offset:1024 sc1
  s_waitcnt lgkmcnt(4)
  v_mfma_f32_32x32x16_bf16 v[112:127], v[84:87], v[244:247], v[112:127]
  s_nop 1
  s_mov_b64 exec, s[74:75]
  ds_write_b32 v22, v28 offset:2048
  ds_write_b32 v22, v29 offset:2064
  ds_write_b32 v22, v30 offset:2080
  ds_write_b32 v22, v31 offset:2096
  s_mov_b64 exec, -1
  v_add_u32 v10, 0xffff8000, v10
  v_add_u32 v11, 0xffff8000, v11
  v_add_u32 v12, 0xffff8000, v12
  v_add_u32 v13, 0xffff8000, v13
  s_waitcnt vmcnt(2) lgkmcnt(0)
  s_barrier
  ds_read_b64_tr_b16 v[80:81], v10 offset:0
  ds_read_b64_tr_b16 v[82:83], v10 offset:512
  ds_read_b64_tr_b16 v[84:85], v11 offset:0
  ds_read_b64_tr_b16 v[86:87], v11 offset:512
  ds_read_b128 v[40:43], v3 offset:2048
  v_mfma_f32_32x32x16_bf16 v[112:127], v[88:91], v[248:251], v[112:127]
  ds_read_b64_tr_b16 v[88:89], v12 offset:0
  ds_read_b64_tr_b16 v[90:91], v12 offset:512
  v_mfma_f32_32x32x16_bf16 v[112:127], v[92:95], v[252:255], v[112:127]
  s_waitcnt lgkmcnt(2)
  v_add_f32 v40, v40, v41
  v_add_f32 v42, v42, v43
  v_add_f32 v44, v40, v42
  ds_write_b32 v14, v44
  s_lshr_b32 s56, s2, 3
  s_lshr_b32 s57, s56, 4
  s_lshl_b32 s57, s57, 3
  s_and_b32 s56, s56, 7
  s_add_u32 s56, s56, s57
  s_lshl_b32 s56, s56, 3
  s_add_u32 s56, s56, s3
  s_lshl_b32 s56, s56, 14
  s_mov_b32 s99, 0x00020000
  s_cmp_ge_u32 s56, 1409024
  s_cbranch_scc1 p3w_36_o
  s_mov_b32 s96, s22
  s_mov_b32 s97, s23
  s_mov_b32 s98, 1409024
  s_branch p3w_36_g
p3w_36_o:
  s_sub_u32 s56, s56, 1409024
  s_mov_b32 s96, s14
  s_mov_b32 s97, s15
  s_mov_b32 s98, 524288
p3w_36_g:
  v_lshlrev_b32 v16, 7, v1
  buffer_load_dword v15, v16, s[96:99], s56 offen
  s_add_u32 s56, s56, 8192
  buffer_load_dword v15, v16, s[96:99], s56 offen
  v_mov_b32 v15, 0
  buffer_load_dword v16, v15, s[92:95], 0 offen sc1
  ds_read_b64_tr_b16 v[92:93], v13 offset:0
  ds_read_b64_tr_b16 v[94:95], v13 offset:512
  v_mfma_f32_32x32x16_bf16 v[96:111], v[80:83], v[128:131], 0
  v_mfma_f32_16x16x32_bf16 v[28:31], v[80:83], v[24:27], 0
  ds_read_b128 v[36:39], v21 offset:0
  ds_read_b128 v[40:43], v21 offset:32
  ds_read_b64_tr_b16 v[80:81], v10 offset:8192
  ds_read_b64_tr_b16 v[82:83], v10 offset:8704
  v_mfma_f32_32x32x16_bf16 v[96:111], v[84:87], v[132:135], v[96:111]
  ds_read_b64_tr_b16 v[84:85], v11 offset:8192
  ds_read_b64_tr_b16 v[86:87], v11 offset:8704
  s_waitcnt lgkmcnt(9)
  v_mfma_f32_32x32x16_bf16 v[96:111], v[88:91], v[136:139], v[96:111]
  ds_read_b64_tr_b16 v[88:89], v12 offset:8192
  ds_read_b64_tr_b16 v[90:91], v12 offset:8704
  s_waitcnt lgkmcnt(8)
  v_mfma_f32_32x32x16_bf16 v[96:111], v[92:95], v[140:143], v[96:111]
  s_waitcnt lgkmcnt(7)
  v_fma_f32 v44, v36, v18, v112
  v_fma_f32 v45, v37, v18, v113
  v_fma_f32 v46, v38, v18, v114
  v_fma_f32 v47, v39, v18, v115
  ds_read_b128 v[36:39], v21 offset:64
  v_mul_f32 v48, v44, v44
  ds_read_b64_tr_b16 v[92:93], v13 offset:8192
  ds_read_b64_tr_b16 v[94:95], v13 offset:8704
  s_waitcnt lgkmcnt(7)
  v_mfma_f32_32x32x16_bf16 v[96:111], v[80:83], v[144:147], v[96:111]
  v_mfma_f32_16x16x32_bf16 v[28:31], v[80:83], v[24:27], v[28:31]
  v_mul_f32 v49, v45, v45
  v_mul_f32 v50, v46, v46
  v_mul_f32 v51, v47, v47
  v_fma_f32 v48, v48, v2, v17
  v_fma_f32 v49, v49, v2, v17
  v_fma_f32 v50, v50, v2, v17
  ds_read_b64_tr_b16 v[80:81], v10 offset:16384
  ds_read_b64_tr_b16 v[82:83], v10 offset:16896
  s_waitcnt lgkmcnt(7)
  v_mfma_f32_32x32x16_bf16 v[96:111], v[84:87], v[148:151], v[96:111]
  v_fma_f32 v51, v51, v2, v17
  v_mul_f32 v48, v48, v44
  v_mul_f32 v49, v49, v45
  v_mul_f32 v50, v50, v46
  v_mul_f32 v51, v51, v47
  v_exp_f32 v48, v48
  ds_read_b64_tr_b16 v[84:85], v11 offset:16384
  ds_read_b64_tr_b16 v[86:87], v11 offset:16896
  s_waitcnt lgkmcnt(7)
  v_mfma_f32_32x32x16_bf16 v[96:111], v[88:91], v[152:155], v[96:111]
  v_exp_f32 v49, v49
  v_exp_f32 v50, v50
  v_exp_f32 v51, v51
  ds_read_b64_tr_b16 v[88:89], v12 offset:16384
  ds_read_b64_tr_b16 v[90:91], v12 offset:16896
  s_waitcnt lgkmcnt(6)
  v_mfma_f32_32x32x16_bf16 v[96:111], v[92:95], v[156:159], v[96:111]
  v_fma_f32 v48, v48, v20, v20
  v_fma_f32 v49, v49, v20, v20
  v_fma_f32 v50, v50, v20, v20
  v_fma_f32 v51, v51, v20, v20
  v_rcp_f32 v48, v48
  ds_read_b64_tr_b16 v[92:93], v13 offset:16384
  ds_read_b64_tr_b16 v[94:95], v13 offset:16896
  s_waitcnt lgkmcnt(6)
  v_mfma_f32_32x32x16_bf16 v[96:111], v[80:83], v[160:163], v[96:111]
  v_mfma_f32_16x16x32_bf16 v[28:31], v[80:83], v[24:27], v[28:31]
  v_rcp_f32 v49, v49
  v_rcp_f32 v50, v50
  v_rcp_f32 v51, v51
  ds_read_b64_tr_b16 v[80:81], v10 offset:24576
  ds_read_b64_tr_b16 v[82:83], v10 offset:25088
  s_waitcnt lgkmcnt(6)
  v_mfma_f32_32x32x16_bf16 v[96:111], v[84:87], v[164:167], v[96:111]
  v_mul_f32 v48, v48, v44
  v_mul_f32 v49, v49, v45
  v_mul_f32 v50, v50, v46
  v_mul_f32 v51, v51, v47
  v_fma_f32 v44, v40, v18, v116
  v_fma_f32 v45, v41, v18, v117
  ds_read_b64_tr_b16 v[84:85], v11 offset:24576
  ds_read_b64_tr_b16 v[86:87], v11 offset:25088
  s_waitcnt lgkmcnt(6)
  v_mfma_f32_32x32x16_bf16 v[96:111], v[88:91], v[168:171], v[96:111]
  v_fma_f32 v46, v42, v18, v118
  v_fma_f32 v47, v43, v18, v119
  ds_read_b128 v[40:43], v21 offset:96
  v_mul_f32 v52, v44, v44
  v_mul_f32 v53, v45, v45
  v_mul_f32 v54, v46, v46
  ds_read_b64_tr_b16 v[88:89], v12 offset:24576
  ds_read_b64_tr_b16 v[90:91], v12 offset:25088
  s_waitcnt lgkmcnt(7)
  v_mfma_f32_32x32x16_bf16 v[96:111], v[92:95], v[172:175], v[96:111]
  v_mul_f32 v55, v47, v47
  v_fma_f32 v52, v52, v2, v17
  v_fma_f32 v53, v53, v2, v17
  v_fma_f32 v54, v54, v2, v17
  v_fma_f32 v55, v55, v2, v17
  v_mul_f32 v52, v52, v44
  ds_read_b64_tr_b16 v[92:93], v13 offset:24576
  ds_read_b64_tr_b16 v[94:95], v13 offset:25088
  s_waitcnt lgkmcnt(7)
  v_mfma_f32_32x32x16_bf16 v[96:111], v[80:83], v[176:179], v[96:111]
  v_mfma_f32_16x16x32_bf16 v[28:31], v[80:83], v[24:27], v[28:31]
  v_mul_f32 v53, v53, v45
  v_mul_f32 v54, v54, v46
  v_mul_f32 v55, v55, v47
  v_exp_f32 v52, v52
  v_exp_f32 v53, v53
  v_add_u32 v10, 0x10000, v10
  v_add_u32 v11, 0x10000, v11
  v_add_u32 v12, 0x10000, v12
  v_add_u32 v13, 0x10000, v13
  ds_read_b64_tr_b16 v[80:81], v10 offset:32768
  ds_read_b64_tr_b16 v[82:83], v10 offset:33280
  s_waitcnt lgkmcnt(7)
  v_mfma_f32_32x32x16_bf16 v[96:111], v[84:87], v[180:183], v[96:111]
  v_exp_f32 v54, v54
  v_exp_f32 v55, v55
  v_fma_f32 v52, v52, v20, v20
  v_fma_f32 v53, v53, v20, v20
  ds_read_b64_tr_b16 v[84:85], v11 offset:32768
  ds_read_b64_tr_b16 v[86:87], v11 offset:33280
  s_waitcnt lgkmcnt(6)
  v_mfma_f32_32x32x16_bf16 v[96:111], v[88:91], v[184:187], v[96:111]
  v_fma_f32 v54, v54, v20, v20
  v_fma_f32 v55, v55, v20, v20
  v_rcp_f32 v52, v52
  v_rcp_f32 v53, v53
  ds_read_b64_tr_b16 v[88:89], v12 offset:32768
  ds_read_b64_tr_b16 v[90:91], v12 offset:33280
  s_waitcnt lgkmcnt(6)
  v_mfma_f32_32x32x16_bf16 v[96:111], v[92:95], v[188:191], v[96:111]
  v_rcp_f32 v54, v54
  v_rcp_f32 v55, v55
  v_mul_f32 v52, v52, v44
  v_mul_f32 v53, v53, v45
  ds_read_b64_tr_b16 v[92:93], v13 offset:32768
  ds_read_b64_tr_b16 v[94:95], v13 offset:33280
  s_waitcnt lgkmcnt(6)
  v_mfma_f32_32x32x16_bf16 v[96:111], v[80:83], v[192:195], v[96:111]
  v_mfma_f32_16x16x32_bf16 v[28:31], v[80:83], v[24:27], v[28:31]
  v_mul_f32 v54, v54, v46
  v_mul_f32 v55, v55, v47
  v_fma_f32 v44, v36, v18, v120
  v_fma_f32 v45, v37, v18, v121
  v_fma_f32 v46, v38, v18, v122
  v_fma_f32 v47, v39, v18, v123
  ds_read_b64_tr_b16 v[80:81], v10 offset:40960
  ds_read_b64_tr_b16 v[82:83], v10 offset:41472
  s_waitcnt lgkmcnt(6)
  v_mfma_f32_32x32x16_bf16 v[96:111], v[84:87], v[196:199], v[96:111]
  v_mul_f32 v56, v44, v44
  v_mul_f32 v57, v45, v45
  v_mul_f32 v58, v46, v46
  v_mul_f32 v59, v47, v47
  v_fma_f32 v56, v56, v2, v17
  v_fma_f32 v57, v57, v2, v17
  ds_read_b64_tr_b16 v[84:85], v11 offset:40960
  ds_read_b64_tr_b16 v[86:87], v11 offset:41472
  s_waitcnt lgkmcnt(6)
  v_mfma_f32_32x32x16_bf16 v[96:111], v[88:91], v[200:203], v[96:111]
  v_fma_f32 v58, v58, v2, v17
  v_fma_f32 v59, v59, v2, v17
  v_mul_f32 v56, v56, v44
  v_mul_f32 v57, v57, v45
  v_mul_f32 v58, v58, v46
  v_mul_f32 v59, v59, v47
  ds_read_b64_tr_b16 v[88:89], v12 offset:40960
  ds_read_b64_tr_b16 v[90:91], v12 offset:41472
  s_waitcnt lgkmcnt(6)
  v_mfma_f32_32x32x16_bf16 v[96:111], v[92:95], v[204:207], v[96:111]
  v_exp_f32 v56, v56
  v_exp_f32 v57, v57
  v_exp_f32 v58, v58
  ds_read_b64_tr_b16 v[92:93], v13 offset:40960
  ds_read_b64_tr_b16 v[94:95], v13 offset:41472
  s_waitcnt lgkmcnt(6)
  v_mfma_f32_32x32x16_bf16 v[96:111], v[80:83], v[208:211], v[96:111]
  v_mfma_f32_16x16x32_bf16 v[28:31], v[80:83], v[24:27], v[28:31]
  v_exp_f32 v59, v59
  v_fma_f32 v56, v56, v20, v20
  v_fma_f32 v57, v57, v20, v20
  v_fma_f32 v58, v58, v20, v20
  v_fma_f32 v59, v59, v20, v20
  ds_read_b64_tr_b16 v[80:81], v10 offset:49152
  ds_read_b64_tr_b16 v[82:83], v10 offset:49664
  s_waitcnt lgkmcnt(6)
  v_mfma_f32_32x32x16_bf16 v[96:111], v[84:87], v[212:215], v[96:111]
  v_rcp_f32 v56, v56
  v_rcp_f32 v57, v57
  v_rcp_f32 v58, v58
  ds_read_b64_tr_b16 v[84:85], v11 offset:49152
  ds_read_b64_tr_b16 v[86:87], v11 offset:49664
  s_waitcnt lgkmcnt(6)
  v_mfma_f32_32x32x16_bf16 v[96:111], v[88:91], v[216:219], v[96:111]
  v_rcp_f32 v59, v59
  v_mul_f32 v56, v56, v44
  v_mul_f32 v57, v57, v45
  v_mul_f32 v58, v58, v46
  v_mul_f32 v59, v59, v47
  v_fma_f32 v44, v40, v18, v124
  ds_read_b64_tr_b16 v[88:89], v12 offset:49152
  ds_read_b64_tr_b16 v[90:91], v12 offset:49664
  s_waitcnt lgkmcnt(6)
  v_mfma_f32_32x32x16_bf16 v[96:111], v[92:95], v[220:223], v[96:111]
  v_fma_f32 v45, v41, v18, v125
  v_fma_f32 v46, v42, v18, v126
  v_fma_f32 v47, v43, v18, v127
  v_mul_f32 v60, v44, v44
  v_mul_f32 v61, v45, v45
  v_mul_f32 v62, v46, v46
  v_mul_f32 v63, v47, v47
  ds_read_b64_tr_b16 v[92:93], v13 offset:49152
  ds_read_b64_tr_b16 v[94:95], v13 offset:49664
  s_waitcnt lgkmcnt(6)
  v_mfma_f32_32x32x16_bf16 v[96:111], v[80:83], v[224:227], v[96:111]
  v_mfma_f32_16x16x32_bf16 v[28:31], v[80:83], v[24:27], v[28:31]
  v_fma_f32 v60, v60, v2, v17
  v_fma_f32 v61, v61, v2, v17
  v_fma_f32 v62, v62, v2, v17
  v_fma_f32 v63, v63, v2, v17
  v_mul_f32 v60, v60, v44
  v_mul_f32 v61, v61, v45
  ds_read_b64_tr_b16 v[80:81], v10 offset:57344
  ds_read_b64_tr_b16 v[82:83], v10 offset:57856
  s_waitcnt lgkmcnt(6)
  v_mfma_f32_32x32x16_bf16 v[96:111], v[84:87], v[228:231], v[96:111]
  v_mul_f32 v62, v62, v46
  v_mul_f32 v63, v63, v47
  v_exp_f32 v60, v60
  v_exp_f32 v61, v61
  ds_read_b64_tr_b16 v[84:85], v11 offset:57344
  ds_read_b64_tr_b16 v[86:87], v11 offset:57856
  s_waitcnt lgkmcnt(6)
  v_mfma_f32_32x32x16_bf16 v[96:111], v[88:91], v[232:235], v[96:111]
  v_exp_f32 v62, v62
  v_exp_f32 v63, v63
  v_fma_f32 v60, v60, v20, v20
  v_fma_f32 v61, v61, v20, v20
  v_fma_f32 v62, v62, v20, v20
  ds_read_b64_tr_b16 v[88:89], v12 offset:57344
  ds_read_b64_tr_b16 v[90:91], v12 offset:57856
  s_waitcnt lgkmcnt(6)
  v_mfma_f32_32x32x16_bf16 v[96:111], v[92:95], v[236:239], v[96:111]
  v_fma_f32 v63, v63, v20, v20
  v_rcp_f32 v60, v60
  v_rcp_f32 v61, v61
  v_rcp_f32 v62, v62
  ds_read_b64_tr_b16 v[92:93], v13 offset:57344
  ds_read_b64_tr_b16 v[94:95], v13 offset:57856
  s_waitcnt lgkmcnt(6)
  v_mfma_f32_32x32x16_bf16 v[96:111], v[80:83], v[240:243], v[96:111]
  v_mfma_f32_16x16x32_bf16 v[28:31], v[80:83], v[24:27], v[28:31]
  v_rcp_f32 v63, v63
  v_mul_f32 v60, v60, v44
  v_mul_f32 v61, v61, v45
  v_mul_f32 v62, v62, v46
  v_mul_f32 v63, v63, v47
  s_waitcnt lgkmcnt(4)
  v_mfma_f32_32x32x16_bf16 v[96:111], v[84:87], v[244:247], v[96:111]
  s_nop 1
  s_mov_b64 exec, s[74:75]
  ds_write_b32 v22, v28 offset:3072
  ds_write_b32 v22, v29 offset:3088
  ds_write_b32 v22, v30 offset:3104
  ds_write_b32 v22, v31 offset:3120
  s_mov_b64 exec, -1
  s_waitcnt lgkmcnt(0)
  s_barrier
  ds_read_b128 v[40:43], v3 offset:3072
  v_mfma_f32_32x32x16_bf16 v[96:111], v[88:91], v[248:251], v[96:111]
  v_mfma_f32_32x32x16_bf16 v[96:111], v[92:95], v[252:255], v[96:111]
  s_waitcnt lgkmcnt(0)
  v_add_f32 v40, v40, v41
  v_add_f32 v42, v42, v43
  v_add_f32 v44, v40, v42
  ds_write_b32 v14, v44
  s_lshl_b32 s57, s69, 1
  s_add_u32 s57, s57, s5
  s_cmp_ge_u32 s57, 43
  s_cbranch_scc1 sk_37
  s_lshl_b32 s57, s69, 12
  s_lshl_b32 s58, s5, 11
  s_add_u32 s57, s57, s58
  s_add_u32 s57, s57, s67
  ds_read_b128 v[36:39], v21 offset:0
  ds_read_b128 v[40:43], v21 offset:32
  s_waitcnt lgkmcnt(1)
  s_nop 1
  v_fma_f32 v44, v36, v18, v96
  v_fma_f32 v45, v37, v18, v97
  v_fma_f32 v46, v38, v18, v98
  v_fma_f32 v47, v39, v18, v99
  ds_read_b128 v[36:39], v21 offset:64
  v_mul_f32 v44, v44, v48
  v_mul_f32 v45, v45, v49
  v_mul_f32 v46, v46, v50
  v_mul_f32 v47, v47, v51
  v_cvt_pk_bf16_f32 v48, v44, v45
  v_cvt_pk_bf16_f32 v49, v46, v47
  s_waitcnt lgkmcnt(1)
  v_fma_f32 v44, v40, v18, v100
  v_fma_f32 v45, v41, v18, v101
  v_fma_f32 v46, v42, v18, v102
  v_fma_f32 v47, v43, v18, v103
  ds_read_b128 v[40:43], v21 offset:96
  v_mul_f32 v44, v44, v52
  v_mul_f32 v45, v45, v53
  v_mul_f32 v46, v46, v54
  v_mul_f32 v47, v47, v55
  v_cvt_pk_bf16_f32 v50, v44, v45
  v_cvt_pk_bf16_f32 v51, v46, v47
  buffer_store_dwordx4 v[48:51], v23, s[48:51], s57 offen offset:0 sc1
  s_waitcnt lgkmcnt(1)
  v_fma_f32 v44, v36, v18, v104
  v_fma_f32 v45, v37, v18, v105
  v_fma_f32 v46, v38, v18, v106
  v_fma_f32 v47, v39, v18, v107
  v_mul_f32 v44, v44, v56
  v_mul_f32 v45, v45, v57
  v_mul_f32 v46, v46, v58
  v_mul_f32 v47, v47, v59
  v_cvt_pk_bf16_f32 v56, v44, v45
  v_cvt_pk_bf16_f32 v57, v46, v47
  s_waitcnt lgkmcnt(0)
  v_fma_f32 v44, v40, v18, v108
  v_fma_f32 v45, v41, v18, v109
  v_fma_f32 v46, v42, v18, v110
  v_fma_f32 v47, v43, v18, v111
  v_mul_f32 v44, v44, v60
  v_mul_f32 v45, v45, v61
  v_mul_f32 v46, v46, v62
  v_mul_f32 v47, v47, v63
  v_cvt_pk_bf16_f32 v58, v44, v45
  v_cvt_pk_bf16_f32 v59, v46, v47
  buffer_store_dwordx4 v[56:59], v23, s[48:51], s57 offen offset:1024 sc1
sk_37:
  s_waitcnt vmcnt(0)
  s_waitcnt vmcnt(2)
  v_readfirstlane_b32 s72, v16
  s_cmp_lg_u32 s72, 0
  s_cbranch_scc1 nr_38
  v_mov_b32 v36, 0
nn_39:
  buffer_load_dword v37, v36, s[92:95], 0 offen sc1
  s_waitcnt vmcnt(0)
  v_readfirstlane_b32 s72, v37
  s_cmp_lg_u32 s72, 0
  s_cbranch_scc1 nn_39_ok
  s_sleep 4
  s_branch nn_39
nn_39_ok:
nr_38:
  v_mov_b32 v36, 0
  v_mov_b32 v37, s72
  s_waitcnt vmcnt(0)
  s_lshl_b32 s56, s6, 3
  s_lshr_b32 s57, s7, 1
  s_add_u32 s56, s56, s57
  s_lshl_b32 s56, s56, 3
  s_add_u32 s56, s56, s3
  s_lshl_b32 s56, s56, 7
  s_add_u32 s56, s56, 24641536
  v_mov_b32 v36, 0
  v_mov_b32 v37, s72
  s_mov_b64 exec, 1
  buffer_store_dword v37, v36, s[48:51], s56 offen sc1
  s_mov_b64 exec, -1
  s_waitcnt lgkmcnt(0)
  s_barrier
  v_mov_b32 v38, 155648
  v_mov_b32 v39, 0
  ds_write_b32 v38, v39
  s_waitcnt lgkmcnt(0)
  s_barrier
  s_branch p3_entry
k1_exit:
  s_endpgm
p3_entry:
  v_mbcnt_lo_u32_b32 v1, -1, 0
  v_mbcnt_hi_u32_b32 v1, -1, v1
  s_and_b32 s56, s2, 7
  s_lshr_b32 s57, s2, 3
  s_and_b32 s6, s57, 3
  s_lshl_b32 s56, s56, 2
  s_add_u32 s6, s6, s56
  s_lshr_b32 s7, s57, 2
  v_lshlrev_b32 v2, 4, v1
  v_lshrrev_b32 v6, 3, v1
  v_and_b32 v7, 7, v1
  v_bfe_u32 v8, v1, 4, 1
  v_lshlrev_b32 v8, 2, v8
  v_xor_b32 v7, v7, v8
  v_lshlrev_b32 v7, 4, v7
  v_lshl_add_u32 v3, v6, 10, v7
  s_mov_b32 s32, s28
  s_mov_b32 s33, s29
  s_mov_b32 s34, 0x10000000
  s_mov_b32 s35, 0x00020000
  s_cmp_ge_u32 s3, 4
  s_cbranch_scc1 p3_p2
  s_mul_i32 s51, s3, 18432
  s_mov_b32 s36, s22
  s_mov_b32 s37, s23
  s_mov_b32 s38, 1409024
  s_mov_b32 s39, 0x00020000
  s_mul_i32 s56, s3, 22
  s_cmp_eq_u32 s3, 3
  s_cselect_b32 s57, 1, 0
  s_sub_u32 s56, s56, s57
  s_cmp_ge_u32 s3, 2
  s_cselect_b32 s50, 21, 22
  s_lshl_b32 s58, s6, 1
  s_mul_i32 s48, s58, 88064
  s_lshl_b32 s57, s56, 10
  s_add_u32 s48, s48, s57
  s_add_u32 s54, s48, 88064
  s_lshl_b32 s49, s56, 14
  s_lshl_b32 s56, s7, 7
  s_add_u32 s49, s49, s56
  v_lshrrev_b32 v6, 5, v1
  v_bfe_u32 v7, v1, 2, 2
  v_lshl_add_u32 v8, v6, 2, v7
  v_lshlrev_b32 v8, 7, v8
  v_bfe_u32 v9, v1, 4, 1
  v_lshlrev_b32 v9, 1, v9
  v_bfe_u32 v10, v1, 1, 1
  v_add_u32 v9, v9, v10
  v_lshrrev_b32 v10, 1, v7
  v_lshlrev_b32 v10, 2, v10
  v_xor_b32 v9, v9, v10
  v_lshl_add_u32 v8, v9, 4, v8
  v_and_b32 v10, 1, v1
  v_lshl_add_u32 v8, v10, 3, v8
  v_add_u32 v4, s51, v8
  v_xor_b32 v5, 64, v4
  s_add_u32 m0, s51, 0
  s_add_u32 s56, s49, 0
  buffer_load_dwordx4 v3, s[36:39], s56 offen lds
  s_add_u32 m0, s51, 1024
  s_add_u32 s56, s49, 8192
  buffer_load_dwordx4 v3, s[36:39], s56 offen lds
  s_add_u32 m0, s51, 2048
  s_add_u32 s56, s49, 16384
  buffer_load_dwordx4 v3, s[36:39], s56 offen lds
  s_add_u32 m0, s51, 3072
  s_add_u32 s56, s49, 24576
  buffer_load_dwordx4 v3, s[36:39], s56 offen lds
  s_add_u32 m0, s51, 4096
  s_add_u32 s56, s49, 32768
  buffer_load_dwordx4 v3, s[36:39], s56 offen lds
  s_add_u32 m0, s51, 5120
  s_add_u32 s56, s49, 40960
  buffer_load_dwordx4 v3, s[36:39], s56 offen lds
  s_add_u32 m0, s51, 6144
  s_add_u32 s56, s49, 49152
  buffer_load_dwordx4 v3, s[36:39], s56 offen lds
  s_add_u32 m0, s51, 7168
  s_add_u32 s56, s49, 57344
  buffer_load_dwordx4 v3, s[36:39], s56 offen lds
  s_add_u32 m0, s51, 8192
  s_add_u32 s56, s49, 65536
  buffer_load_dwordx4 v3, s[36:39], s56 offen lds
  s_add_u32 m0, s51, 9216
  s_add_u32 s56, s49, 73728
  buffer_load_dwordx4 v3, s[36:39], s56 offen lds
  s_add_u32 m0, s51, 10240
  s_add_u32 s56, s49, 81920
  buffer_load_dwordx4 v3, s[36:39], s56 offen lds
  s_add_u32 m0, s51, 11264
  s_add_u32 s56, s49, 90112
  buffer_load_dwordx4 v3, s[36:39], s56 offen lds
  s_add_u32 m0, s51, 12288
  s_add_u32 s56, s49, 98304
  buffer_load_dwordx4 v3, s[36:39], s56 offen lds
  s_add_u32 m0, s51, 13312
  s_add_u32 s56, s49, 106496
  buffer_load_dwordx4 v3, s[36:39], s56 offen lds
  s_add_u32 m0, s51, 14336
  s_add_u32 s56, s49, 114688
  buffer_load_dwordx4 v3, s[36:39], s56 offen lds
  s_add_u32 m0, s51, 15360
  s_add_u32 s56, s49, 122880
  buffer_load_dwordx4 v3, s[36:39], s56 offen lds
  s_lshr_b32 s56, s6, 1
  s_lshl_b32 s56, s56, 13
  s_add_u32 s56, s56, 24641536
  v_lshlrev_b32 v6, 7, v1
p3_pollh:
  buffer_load_dword v7, v6, s[32:35], s56 offen sc1
  s_waitcnt vmcnt(0)
  v_cmp_ne_u32 vcc, s72, v7
  s_nop 1
  s_cbranch_vccz p3_pollh_ok
  s_sleep 3
  s_branch p3_pollh
p3_pollh_ok:
  s_add_u32 s56, s48, 0
  buffer_load_dwordx4 v[112:115], v2, s[32:35], s56 offen sc1
  s_add_u32 s56, s54, 0
  buffer_load_dwordx4 v[116:119], v2, s[32:35], s56 offen sc1
  s_add_u32 s56, s48, 1024
  buffer_load_dwordx4 v[120:123], v2, s[32:35], s56 offen sc1
  s_add_u32 s56, s54, 1024
  buffer_load_dwordx4 v[124:127], v2, s[32:35], s56 offen sc1
  s_add_u32 s56, s48, 2048
  buffer_load_dwordx4 v[128:131], v2, s[32:35], s56 offen sc1
  s_add_u32 s56, s54, 2048
  buffer_load_dwordx4 v[132:135], v2, s[32:35], s56 offen sc1
  s_add_u32 s56, s48, 3072
  buffer_load_dwordx4 v[136:139], v2, s[32:35], s56 offen sc1
  s_add_u32 s56, s54, 3072
  buffer_load_dwordx4 v[140:143], v2, s[32:35], s56 offen sc1
  s_add_u32 s56, s48, 4096
  buffer_load_dwordx4 v[144:147], v2, s[32:35], s56 offen sc1
  s_add_u32 s56, s54, 4096
  buffer_load_dwordx4 v[148:151], v2, s[32:35], s56 offen sc1
  s_add_u32 s56, s48, 5120
  buffer_load_dwordx4 v[152:155], v2, s[32:35], s56 offen sc1
  s_add_u32 s56, s54, 5120
  buffer_load_dwordx4 v[156:159], v2, s[32:35], s56 offen sc1
  s_add_u32 s56, s48, 6144
  buffer_load_dwordx4 v[160:163], v2, s[32:35], s56 offen sc1
  s_add_u32 s56, s54, 6144
  buffer_load_dwordx4 v[164:167], v2, s[32:35], s56 offen sc1
  s_add_u32 s56, s48, 7168
  buffer_load_dwordx4 v[168:171], v2, s[32:35], s56 offen sc1
  s_add_u32 s56, s54, 7168
  buffer_load_dwordx4 v[172:175], v2, s[32:35], s56 offen sc1
  ds_read_b64_tr_b16 v[16:17], v4 offset:0
  ds_read_b64_tr_b16 v[18:19], v4 offset:1024
  ds_read_b64_tr_b16 v[20:21], v5 offset:0
  ds_read_b64_tr_b16 v[22:23], v5 offset:1024
  s_waitcnt vmcnt(14)
  ds_read_b64_tr_b16 v[24:25], v4 offset:2048
  ds_read_b64_tr_b16 v[26:27], v4 offset:3072
  ds_read_b64_tr_b16 v[28:29], v5 offset:2048
  ds_read_b64_tr_b16 v[30:31], v5 offset:3072
  s_waitcnt lgkmcnt(6)
  v_mfma_f32_32x32x16_bf16 v[48:63], v[16:19], v[112:115], 0
  s_waitcnt lgkmcnt(4)
  v_mfma_f32_32x32x16_bf16 v[64:79], v[20:23], v[112:115], 0
  v_mfma_f32_32x32x16_bf16 v[80:95], v[16:19], v[116:119], 0
  v_mfma_f32_32x32x16_bf16 v[96:111], v[20:23], v[116:119], 0
  s_add_u32 m0, s51, 16384
  s_add_u32 s56, s49, 131072
  buffer_load_dwordx4 v3, s[36:39], s56 offen lds
  s_add_u32 m0, s51, 17408
  s_add_u32 s56, s49, 139264
  buffer_load_dwordx4 v3, s[36:39], s56 offen lds
  s_add_u32 s56, s48, 8192
  buffer_load_dwordx4 v[176:179], v2, s[32:35], s56 offen sc1
  s_add_u32 s56, s54, 8192
  buffer_load_dwordx4 v[180:183], v2, s[32:35], s56 offen sc1
  s_waitcnt vmcnt(16)
  ds_read_b64_tr_b16 v[16:17], v4 offset:4096
  ds_read_b64_tr_b16 v[18:19], v4 offset:5120
  ds_read_b64_tr_b16 v[20:21], v5 offset:4096
  ds_read_b64_tr_b16 v[22:23], v5 offset:5120
  s_waitcnt lgkmcnt(6)
  v_mfma_f32_32x32x16_bf16 v[48:63], v[24:27], v[120:123], v[48:63]
  s_waitcnt lgkmcnt(4)
  v_mfma_f32_32x32x16_bf16 v[64:79], v[28:31], v[120:123], v[64:79]
  v_mfma_f32_32x32x16_bf16 v[80:95], v[24:27], v[124:127], v[80:95]
  v_mfma_f32_32x32x16_bf16 v[96:111], v[28:31], v[124:127], v[96:111]
  s_add_u32 m0, s51, 0
  s_add_u32 s56, s49, 147456
  buffer_load_dwordx4 v3, s[36:39], s56 offen lds
  s_add_u32 m0, s51, 1024
  s_add_u32 s56, s49, 155648
  buffer_load_dwordx4 v3, s[36:39], s56 offen lds
  s_add_u32 s56, s48, 9216
  buffer_load_dwordx4 v[184:187], v2, s[32:35], s56 offen sc1
  s_add_u32 s56, s54, 9216
  buffer_load_dwordx4 v[188:191], v2, s[32:35], s56 offen sc1
  s_waitcnt vmcnt(18)
  ds_read_b64_tr_b16 v[24:25], v4 offset:6144
  ds_read_b64_tr_b16 v[26:27], v4 offset:7168
  ds_read_b64_tr_b16 v[28:29], v5 offset:6144
  ds_read_b64_tr_b16 v[30:31], v5 offset:7168
  s_waitcnt lgkmcnt(6)
  v_mfma_f32_32x32x16_bf16 v[48:63], v[16:19], v[128:131], v[48:63]
  s_waitcnt lgkmcnt(4)
  v_mfma_f32_32x32x16_bf16 v[64:79], v[20:23], v[128:131], v[64:79]
  v_mfma_f32_32x32x16_bf16 v[80:95], v[16:19], v[132:135], v[80:95]
  v_mfma_f32_32x32x16_bf16 v[96:111], v[20:23], v[132:135], v[96:111]
  s_add_u32 m0, s51, 2048
  s_add_u32 s56, s49, 163840
  buffer_load_dwordx4 v3, s[36:39], s56 offen lds
  s_add_u32 m0, s51, 3072
  s_add_u32 s56, s49, 172032
  buffer_load_dwordx4 v3, s[36:39], s56 offen lds
  s_add_u32 s56, s48, 10240
  buffer_load_dwordx4 v[192:195], v2, s[32:35], s56 offen sc1
  s_add_u32 s56, s54, 10240
  buffer_load_dwordx4 v[196:199], v2, s[32:35], s56 offen sc1
  s_waitcnt vmcnt(20)
  ds_read_b64_tr_b16 v[16:17], v4 offset:8192
  ds_read_b64_tr_b16 v[18:19], v4 offset:9216
  ds_read_b64_tr_b16 v[20:21], v5 offset:8192
  ds_read_b64_tr_b16 v[22:23], v5 offset:9216
  s_waitcnt lgkmcnt(6)
  v_mfma_f32_32x32x16_bf16 v[48:63], v[24:27], v[136:139], v[48:63]
  s_waitcnt lgkmcnt(4)
  v_mfma_f32_32x32x16_bf16 v[64:79], v[28:31], v[136:139], v[64:79]
  v_mfma_f32_32x32x16_bf16 v[80:95], v[24:27], v[140:143], v[80:95]
  v_mfma_f32_32x32x16_bf16 v[96:111], v[28:31], v[140:143], v[96:111]
  s_add_u32 m0, s51, 4096
  s_add_u32 s56, s49, 180224
  buffer_load_dwordx4 v3, s[36:39], s56 offen lds
  s_add_u32 m0, s51, 5120
  s_add_u32 s56, s49, 188416
  buffer_load_dwordx4 v3, s[36:39], s56 offen lds
  s_add_u32 s56, s48, 11264
  buffer_load_dwordx4 v[200:203], v2, s[32:35], s56 offen sc1
  s_add_u32 s56, s54, 11264
  buffer_load_dwordx4 v[204:207], v2, s[32:35], s56 offen sc1
  s_waitcnt vmcnt(22)
  ds_read_b64_tr_b16 v[24:25], v4 offset:10240
  ds_read_b64_tr_b16 v[26:27], v4 offset:11264
  ds_read_b64_tr_b16 v[28:29], v5 offset:10240
  ds_read_b64_tr_b16 v[30:31], v5 offset:11264
  s_waitcnt lgkmcnt(6)
  v_mfma_f32_32x32x16_bf16 v[48:63], v[16:19], v[144:147], v[48:63]
  s_waitcnt lgkmcnt(4)
  v_mfma_f32_32x32x16_bf16 v[64:79], v[20:23], v[144:147], v[64:79]
  v_mfma_f32_32x32x16_bf16 v[80:95], v[16:19], v[148:151], v[80:95]
  v_mfma_f32_32x32x16_bf16 v[96:111], v[20:23], v[148:151], v[96:111]
  s_add_u32 m0, s51, 6144
  s_add_u32 s56, s49, 196608
  buffer_load_dwordx4 v3, s[36:39], s56 offen lds
  s_add_u32 m0, s51, 7168
  s_add_u32 s56, s49, 204800
  buffer_load_dwordx4 v3, s[36:39], s56 offen lds
  s_add_u32 s56, s48, 12288
  buffer_load_dwordx4 v[112:115], v2, s[32:35], s56 offen sc1
  s_add_u32 s56, s54, 12288
  buffer_load_dwordx4 v[116:119], v2, s[32:35], s56 offen sc1
  s_waitcnt vmcnt(24)
  ds_read_b64_tr_b16 v[16:17], v4 offset:12288
  ds_read_b64_tr_b16 v[18:19], v4 offset:13312
  ds_read_b64_tr_b16 v[20:21], v5 offset:12288
  ds_read_b64_tr_b16 v[22:23], v5 offset:13312
  s_waitcnt lgkmcnt(6)
  v_mfma_f32_32x32x16_bf16 v[48:63], v[24:27], v[152:155], v[48:63]
  s_waitcnt lgkmcnt(4)
  v_mfma_f32_32x32x16_bf16 v[64:79], v[28:31], v[152:155], v[64:79]
  v_mfma_f32_32x32x16_bf16 v[80:95], v[24:27], v[156:159], v[80:95]
  v_mfma_f32_32x32x16_bf16 v[96:111], v[28:31], v[156:159], v[96:111]
  s_add_u32 m0, s51, 8192
  s_add_u32 s56, s49, 212992
  buffer_load_dwordx4 v3, s[36:39], s56 offen lds
  s_add_u32 m0, s51, 9216
  s_add_u32 s56, s49, 221184
  buffer_load_dwordx4 v3, s[36:39], s56 offen lds
  s_add_u32 s56, s48, 13312
  buffer_load_dwordx4 v[120:123], v2, s[32:35], s56 offen sc1
  s_add_u32 s56, s54, 13312
  buffer_load_dwordx4 v[124:127], v2, s[32:35], s56 offen sc1
  s_waitcnt vmcnt(26)
  ds_read_b64_tr_b16 v[24:25], v4 offset:14336
  ds_read_b64_tr_b16 v[26:27], v4 offset:15360
  ds_read_b64_tr_b16 v[28:29], v5 offset:14336
  ds_read_b64_tr_b16 v[30:31], v5 offset:15360
  s_waitcnt lgkmcnt(6)
  v_mfma_f32_32x32x16_bf16 v[48:63], v[16:19], v[160:163], v[48:63]
  s_waitcnt lgkmcnt(4)
  v_mfma_f32_32x32x16_bf16 v[64:79], v[20:23], v[160:163], v[64:79]
  v_mfma_f32_32x32x16_bf16 v[80:95], v[16:19], v[164:167], v[80:95]
  v_mfma_f32_32x32x16_bf16 v[96:111], v[20:23], v[164:167], v[96:111]
  s_add_u32 m0, s51, 10240
  s_add_u32 s56, s49, 229376
  buffer_load_dwordx4 v3, s[36:39], s56 offen lds
  s_add_u32 m0, s51, 11264
  s_add_u32 s56, s49, 237568
  buffer_load_dwordx4 v3, s[36:39], s56 offen lds
  s_add_u32 s56, s48, 14336
  buffer_load_dwordx4 v[128:131], v2, s[32:35], s56 offen sc1
  s_add_u32 s56, s54, 14336
  buffer_load_dwordx4 v[132:135], v2, s[32:35], s56 offen sc1
  s_waitcnt vmcnt(26)
  ds_read_b64_tr_b16 v[16:17], v4 offset:16384
  ds_read_b64_tr_b16 v[18:19], v4 offset:17408
  ds_read_b64_tr_b16 v[20:21], v5 offset:16384
  ds_read_b64_tr_b16 v[22:23], v5 offset:17408
  s_waitcnt lgkmcnt(6)
  v_mfma_f32_32x32x16_bf16 v[48:63], v[24:27], v[168:171], v[48:63]
  s_waitcnt lgkmcnt(4)
  v_mfma_f32_32x32x16_bf16 v[64:79], v[28:31], v[168:171], v[64:79]
  v_mfma_f32_32x32x16_bf16 v[80:95], v[24:27], v[172:175], v[80:95]
  v_mfma_f32_32x32x16_bf16 v[96:111], v[28:31], v[172:175], v[96:111]
  s_add_u32 m0, s51, 12288
  s_add_u32 s56, s49, 245760
  buffer_load_dwordx4 v3, s[36:39], s56 offen lds
  s_add_u32 m0, s51, 13312
  s_add_u32 s56, s49, 253952
  buffer_load_dwordx4 v3, s[36:39], s56 offen lds
  s_add_u32 s56, s48, 15360
  buffer_load_dwordx4 v[136:139], v2, s[32:35], s56 offen sc1
  s_add_u32 s56, s54, 15360
  buffer_load_dwordx4 v[140:143], v2, s[32:35], s56 offen sc1
  s_waitcnt vmcnt(26)
  ds_read_b64_tr_b16 v[24:25], v4 offset:0
  ds_read_b64_tr_b16 v[26:27], v4 offset:1024
  ds_read_b64_tr_b16 v[28:29], v5 offset:0
  ds_read_b64_tr_b16 v[30:31], v5 offset:1024
  s_waitcnt lgkmcnt(6)
  v_mfma_f32_32x32x16_bf16 v[48:63], v[16:19], v[176:179], v[48:63]
  s_waitcnt lgkmcnt(4)
  v_mfma_f32_32x32x16_bf16 v[64:79], v[20:23], v[176:179], v[64:79]
  v_mfma_f32_32x32x16_bf16 v[80:95], v[16:19], v[180:183], v[80:95]
  v_mfma_f32_32x32x16_bf16 v[96:111], v[20:23], v[180:183], v[96:111]
  s_add_u32 m0, s51, 14336
  s_add_u32 s56, s49, 262144
  buffer_load_dwordx4 v3, s[36:39], s56 offen lds
  s_add_u32 m0, s51, 15360
  s_add_u32 s56, s49, 270336
  buffer_load_dwordx4 v3, s[36:39], s56 offen lds
  s_add_u32 s56, s48, 16384
  buffer_load_dwordx4 v[144:147], v2, s[32:35], s56 offen sc1
  s_add_u32 s56, s54, 16384
  buffer_load_dwordx4 v[148:151], v2, s[32:35], s56 offen sc1
  s_waitcnt vmcnt(26)
  ds_read_b64_tr_b16 v[16:17], v4 offset:2048
  ds_read_b64_tr_b16 v[18:19], v4 offset:3072
  ds_read_b64_tr_b16 v[20:21], v5 offset:2048
  ds_read_b64_tr_b16 v[22:23], v5 offset:3072
  s_waitcnt lgkmcnt(6)
  v_mfma_f32_32x32x16_bf16 v[48:63], v[24:27], v[184:187], v[48:63]
  s_waitcnt lgkmcnt(4)
  v_mfma_f32_32x32x16_bf16 v[64:79], v[28:31], v[184:187], v[64:79]
  v_mfma_f32_32x32x16_bf16 v[80:95], v[24:27], v[188:191], v[80:95]
  v_mfma_f32_32x32x16_bf16 v[96:111], v[28:31], v[188:191], v[96:111]
  s_add_u32 m0, s51, 16384
  s_add_u32 s56, s49, 278528
  buffer_load_dwordx4 v3, s[36:39], s56 offen lds
  s_add_u32 m0, s51, 17408
  s_add_u32 s56, s49, 286720
  buffer_load_dwordx4 v3, s[36:39], s56 offen lds
  s_add_u32 s56, s48, 17408
  buffer_load_dwordx4 v[152:155], v2, s[32:35], s56 offen sc1
  s_add_u32 s56, s54, 17408
  buffer_load_dwordx4 v[156:159], v2, s[32:35], s56 offen sc1
  s_waitcnt vmcnt(26)
  ds_read_b64_tr_b16 v[24:25], v4 offset:4096
  ds_read_b64_tr_b16 v[26:27], v4 offset:5120
  ds_read_b64_tr_b16 v[28:29], v5 offset:4096
  ds_read_b64_tr_b16 v[30:31], v5 offset:5120
  s_waitcnt lgkmcnt(6)
  v_mfma_f32_32x32x16_bf16 v[48:63], v[16:19], v[192:195], v[48:63]
  s_waitcnt lgkmcnt(4)
  v_mfma_f32_32x32x16_bf16 v[64:79], v[20:23], v[192:195], v[64:79]
  v_mfma_f32_32x32x16_bf16 v[80:95], v[16:19], v[196:199], v[80:95]
  v_mfma_f32_32x32x16_bf16 v[96:111], v[20:23], v[196:199], v[96:111]
  s_add_u32 m0, s51, 0
  s_add_u32 s56, s49, 294912
  buffer_load_dwordx4 v3, s[36:39], s56 offen lds
  s_add_u32 m0, s51, 1024
  s_add_u32 s56, s49, 303104
  buffer_load_dwordx4 v3, s[36:39], s56 offen lds
  s_add_u32 s56, s48, 18432
  buffer_load_dwordx4 v[160:163], v2, s[32:35], s56 offen sc1
  s_add_u32 s56, s54, 18432
  buffer_load_dwordx4 v[164:167], v2, s[32:35], s56 offen sc1
  s_waitcnt vmcnt(26)
  ds_read_b64_tr_b16 v[16:17], v4 offset:6144
  ds_read_b64_tr_b16 v[18:19], v4 offset:7168
  ds_read_b64_tr_b16 v[20:21], v5 offset:6144
  ds_read_b64_tr_b16 v[22:23], v5 offset:7168
  s_waitcnt lgkmcnt(6)
  v_mfma_f32_32x32x16_bf16 v[48:63], v[24:27], v[200:203], v[48:63]
  s_waitcnt lgkmcnt(4)
  v_mfma_f32_32x32x16_bf16 v[64:79], v[28:31], v[200:203], v[64:79]
  v_mfma_f32_32x32x16_bf16 v[80:95], v[24:27], v[204:207], v[80:95]
  v_mfma_f32_32x32x16_bf16 v[96:111], v[28:31], v[204:207], v[96:111]
  s_add_u32 m0, s51, 2048
  s_add_u32 s56, s49, 311296
  buffer_load_dwordx4 v3, s[36:39], s56 offen lds
  s_add_u32 m0, s51, 3072
  s_add_u32 s56, s49, 319488
  buffer_load_dwordx4 v3, s[36:39], s56 offen lds
  s_add_u32 s56, s48, 19456
  buffer_load_dwordx4 v[168:171], v2, s[32:35], s56 offen sc1
  s_add_u32 s56, s54, 19456
  buffer_load_dwordx4 v[172:175], v2, s[32:35], s56 offen sc1
  s_waitcnt vmcnt(26)
  ds_read_b64_tr_b16 v[24:25], v4 offset:8192
  ds_read_b64_tr_b16 v[26:27], v4 offset:9216
  ds_read_b64_tr_b16 v[28:29], v5 offset:8192
  ds_read_b64_tr_b16 v[30:31], v5 offset:9216
  s_waitcnt lgkmcnt(6)
  v_mfma_f32_32x32x16_bf16 v[48:63], v[16:19], v[112:115], v[48:63]
  s_waitcnt lgkmcnt(4)
  v_mfma_f32_32x32x16_bf16 v[64:79], v[20:23], v[112:115], v[64:79]
  v_mfma_f32_32x32x16_bf16 v[80:95], v[16:19], v[116:119], v[80:95]
  v_mfma_f32_32x32x16_bf16 v[96:111], v[20:23], v[116:119], v[96:111]
  s_add_u32 m0, s51, 4096
  s_add_u32 s56, s49, 327680
  buffer_load_dwordx4 v3, s[36:39], s56 offen lds
  s_add_u32 m0, s51, 5120
  s_add_u32 s56, s49, 335872
  buffer_load_dwordx4 v3, s[36:39], s56 offen lds
  s_add_u32 s56, s48, 20480
  buffer_load_dwordx4 v[176:179], v2, s[32:35], s56 offen sc1
  s_add_u32 s56, s54, 20480
  buffer_load_dwordx4 v[180:183], v2, s[32:35], s56 offen sc1
  s_waitcnt vmcnt(26)
  ds_read_b64_tr_b16 v[16:17], v4 offset:10240
  ds_read_b64_tr_b16 v[18:19], v4 offset:11264
  ds_read_b64_tr_b16 v[20:21], v5 offset:10240
  ds_read_b64_tr_b16 v[22:23], v5 offset:11264
  s_waitcnt lgkmcnt(6)
  v_mfma_f32_32x32x16_bf16 v[48:63], v[24:27], v[120:123], v[48:63]
  s_waitcnt lgkmcnt(4)
  v_mfma_f32_32x32x16_bf16 v[64:79], v[28:31], v[120:123], v[64:79]
  v_mfma_f32_32x32x16_bf16 v[80:95], v[24:27], v[124:127], v[80:95]
  v_mfma_f32_32x32x16_bf16 v[96:111], v[28:31], v[124:127], v[96:111]
  s_cmp_le_u32 s50, 21
  s_cbranch_scc1 g_40
  s_add_u32 m0, s51, 6144
  s_add_u32 s56, s49, 344064
  buffer_load_dwordx4 v3, s[36:39], s56 offen lds
  s_add_u32 m0, s51, 7168
  s_add_u32 s56, s49, 352256
  buffer_load_dwordx4 v3, s[36:39], s56 offen lds
g_40:
  s_cmp_le_u32 s50, 21
  s_cbranch_scc1 g_41
  s_add_u32 s56, s48, 21504
  buffer_load_dwordx4 v[184:187], v2, s[32:35], s56 offen sc1
  s_add_u32 s56, s54, 21504
  buffer_load_dwordx4 v[188:191], v2, s[32:35], s56 offen sc1
g_41:
  s_waitcnt vmcnt(22)
  ds_read_b64_tr_b16 v[24:25], v4 offset:12288
  ds_read_b64_tr_b16 v[26:27], v4 offset:13312
  ds_read_b64_tr_b16 v[28:29], v5 offset:12288
  ds_read_b64_tr_b16 v[30:31], v5 offset:13312
  s_waitcnt lgkmcnt(6)
  v_mfma_f32_32x32x16_bf16 v[48:63], v[16:19], v[128:131], v[48:63]
  s_waitcnt lgkmcnt(4)
  v_mfma_f32_32x32x16_bf16 v[64:79], v[20:23], v[128:131], v[64:79]
  v_mfma_f32_32x32x16_bf16 v[80:95], v[16:19], v[132:135], v[80:95]
  v_mfma_f32_32x32x16_bf16 v[96:111], v[20:23], v[132:135], v[96:111]
  s_waitcnt vmcnt(18)
  ds_read_b64_tr_b16 v[16:17], v4 offset:14336
  ds_read_b64_tr_b16 v[18:19], v4 offset:15360
  ds_read_b64_tr_b16 v[20:21], v5 offset:14336
  ds_read_b64_tr_b16 v[22:23], v5 offset:15360
  s_waitcnt lgkmcnt(6)
  v_mfma_f32_32x32x16_bf16 v[48:63], v[24:27], v[136:139], v[48:63]
  s_waitcnt lgkmcnt(4)
  v_mfma_f32_32x32x16_bf16 v[64:79], v[28:31], v[136:139], v[64:79]
  v_mfma_f32_32x32x16_bf16 v[80:95], v[24:27], v[140:143], v[80:95]
  v_mfma_f32_32x32x16_bf16 v[96:111], v[28:31], v[140:143], v[96:111]
  s_waitcnt vmcnt(14)
  ds_read_b64_tr_b16 v[24:25], v4 offset:16384
  ds_read_b64_tr_b16 v[26:27], v4 offset:17408
  ds_read_b64_tr_b16 v[28:29], v5 offset:16384
  ds_read_b64_tr_b16 v[30:31], v5 offset:17408
  s_waitcnt lgkmcnt(6)
  v_mfma_f32_32x32x16_bf16 v[48:63], v[16:19], v[144:147], v[48:63]
  s_waitcnt lgkmcnt(4)
  v_mfma_f32_32x32x16_bf16 v[64:79], v[20:23], v[144:147], v[64:79]
  v_mfma_f32_32x32x16_bf16 v[80:95], v[16:19], v[148:151], v[80:95]
  v_mfma_f32_32x32x16_bf16 v[96:111], v[20:23], v[148:151], v[96:111]
  s_waitcnt vmcnt(10)
  ds_read_b64_tr_b16 v[16:17], v4 offset:0
  ds_read_b64_tr_b16 v[18:19], v4 offset:1024
  ds_read_b64_tr_b16 v[20:21], v5 offset:0
  ds_read_b64_tr_b16 v[22:23], v5 offset:1024
  s_waitcnt lgkmcnt(6)
  v_mfma_f32_32x32x16_bf16 v[48:63], v[24:27], v[152:155], v[48:63]
  s_waitcnt lgkmcnt(4)
  v_mfma_f32_32x32x16_bf16 v[64:79], v[28:31], v[152:155], v[64:79]
  v_mfma_f32_32x32x16_bf16 v[80:95], v[24:27], v[156:159], v[80:95]
  v_mfma_f32_32x32x16_bf16 v[96:111], v[28:31], v[156:159], v[96:111]
  s_waitcnt vmcnt(6)
  ds_read_b64_tr_b16 v[24:25], v4 offset:2048
  ds_read_b64_tr_b16 v[26:27], v4 offset:3072
  ds_read_b64_tr_b16 v[28:29], v5 offset:2048
  ds_read_b64_tr_b16 v[30:31], v5 offset:3072
  s_waitcnt lgkmcnt(6)
  v_mfma_f32_32x32x16_bf16 v[48:63], v[16:19], v[160:163], v[48:63]
  s_waitcnt lgkmcnt(4)
  v_mfma_f32_32x32x16_bf16 v[64:79], v[20:23], v[160:163], v[64:79]
  v_mfma_f32_32x32x16_bf16 v[80:95], v[16:19], v[164:167], v[80:95]
  v_mfma_f32_32x32x16_bf16 v[96:111], v[20:23], v[164:167], v[96:111]
  s_waitcnt vmcnt(2)
  ds_read_b64_tr_b16 v[16:17], v4 offset:4096
  ds_read_b64_tr_b16 v[18:19], v4 offset:5120
  ds_read_b64_tr_b16 v[20:21], v5 offset:4096
  ds_read_b64_tr_b16 v[22:23], v5 offset:5120
  s_waitcnt lgkmcnt(6)
  v_mfma_f32_32x32x16_bf16 v[48:63], v[24:27], v[168:171], v[48:63]
  s_waitcnt lgkmcnt(4)
  v_mfma_f32_32x32x16_bf16 v[64:79], v[28:31], v[168:171], v[64:79]
  v_mfma_f32_32x32x16_bf16 v[80:95], v[24:27], v[172:175], v[80:95]
  v_mfma_f32_32x32x16_bf16 v[96:111], v[28:31], v[172:175], v[96:111]
  s_waitcnt vmcnt(0)
  ds_read_b64_tr_b16 v[24:25], v4 offset:6144
  ds_read_b64_tr_b16 v[26:27], v4 offset:7168
  ds_read_b64_tr_b16 v[28:29], v5 offset:6144
  ds_read_b64_tr_b16 v[30:31], v5 offset:7168
  s_waitcnt lgkmcnt(6)
  v_mfma_f32_32x32x16_bf16 v[48:63], v[16:19], v[176:179], v[48:63]
  s_waitcnt lgkmcnt(4)
  v_mfma_f32_32x32x16_bf16 v[64:79], v[20:23], v[176:179], v[64:79]
  v_mfma_f32_32x32x16_bf16 v[80:95], v[16:19], v[180:183], v[80:95]
  v_mfma_f32_32x32x16_bf16 v[96:111], v[20:23], v[180:183], v[96:111]
  s_cmp_le_u32 s50, 21
  s_cbranch_scc1 p3_done
  s_waitcnt vmcnt(0)
  s_waitcnt lgkmcnt(2)
  v_mfma_f32_32x32x16_bf16 v[48:63], v[24:27], v[184:187], v[48:63]
  s_waitcnt lgkmcnt(0)
  v_mfma_f32_32x32x16_bf16 v[64:79], v[28:31], v[184:187], v[64:79]
  v_mfma_f32_32x32x16_bf16 v[80:95], v[24:27], v[188:191], v[80:95]
  v_mfma_f32_32x32x16_bf16 v[96:111], v[28:31], v[188:191], v[96:111]
p3_done:
  s_waitcnt lgkmcnt(0)
  s_nop 7
  s_nop 7
  v_add_u32 v6, s51, v2
  ds_write_b128 v6, v[48:51] offset:0
  ds_write_b128 v6, v[52:55] offset:1024
  ds_write_b128 v6, v[56:59] offset:2048
  ds_write_b128 v6, v[60:63] offset:3072
  ds_write_b128 v6, v[64:67] offset:4096
  ds_write_b128 v6, v[68:71] offset:5120
  ds_write_b128 v6, v[72:75] offset:6144
  ds_write_b128 v6, v[76:79] offset:7168
  ds_write_b128 v6, v[80:83] offset:8192
  ds_write_b128 v6, v[84:87] offset:9216
  ds_write_b128 v6, v[88:91] offset:10240
  ds_write_b128 v6, v[92:95] offset:11264
  ds_write_b128 v6, v[96:99] offset:12288
  ds_write_b128 v6, v[100:103] offset:13312
  ds_write_b128 v6, v[104:107] offset:14336
  ds_write_b128 v6, v[108:111] offset:15360
  s_waitcnt lgkmcnt(0)
  s_barrier
  s_branch p3_end
p3_p2:
  s_setprio 3
  s_sub_u32 s4, s3, 4
  s_mov_b32 s68, s14
  s_mov_b32 s69, s15
  s_mov_b32 s70, 524288
  s_mov_b32 s71, 0x00020000
  s_lshl_b32 s57, s4, 17
  s_lshl_b32 s56, s7, 7
  s_add_u32 s57, s57, s56
  s_lshl_b32 s58, s4, 14
  s_add_u32 s58, s58, 73728
  s_lshl_b32 s55, s6, 1
  s_lshr_b32 s47, s4, 1
  s_add_u32 s55, s55, s47
  s_lshl_b32 s55, s55, 15
  s_add_u32 s55, s55, 8388608
  s_and_b32 s47, s4, 1
  s_lshl_b32 s47, s47, 14
  s_add_u32 s55, s55, s47
  s_add_u32 m0, s58, 0
  s_add_u32 s56, s57, 0
  buffer_load_dwordx4 v3, s[68:71], s56 offen lds
  s_add_u32 m0, s58, 1024
  s_add_u32 s56, s57, 8192
  buffer_load_dwordx4 v3, s[68:71], s56 offen lds
  s_add_u32 m0, s58, 2048
  s_add_u32 s56, s57, 16384
  buffer_load_dwordx4 v3, s[68:71], s56 offen lds
  s_add_u32 m0, s58, 3072
  s_add_u32 s56, s57, 24576
  buffer_load_dwordx4 v3, s[68:71], s56 offen lds
  s_add_u32 m0, s58, 4096
  s_add_u32 s56, s57, 32768
  buffer_load_dwordx4 v3, s[68:71], s56 offen lds
  s_add_u32 m0, s58, 5120
  s_add_u32 s56, s57, 40960
  buffer_load_dwordx4 v3, s[68:71], s56 offen lds
  s_add_u32 m0, s58, 6144
  s_add_u32 s56, s57, 49152
  buffer_load_dwordx4 v3, s[68:71], s56 offen lds
  s_add_u32 m0, s58, 7168
  s_add_u32 s56, s57, 57344
  buffer_load_dwordx4 v3, s[68:71], s56 offen lds
  s_add_u32 m0, s58, 8192
  s_add_u32 s56, s57, 65536
  buffer_load_dwordx4 v3, s[68:71], s56 offen lds
  s_add_u32 m0, s58, 9216
  s_add_u32 s56, s57, 73728
  buffer_load_dwordx4 v3, s[68:71], s56 offen lds
  s_add_u32 m0, s58, 10240
  s_add_u32 s56, s57, 81920
  buffer_load_dwordx4 v3, s[68:71], s56 offen lds
  s_add_u32 m0, s58, 11264
  s_add_u32 s56, s57, 90112
  buffer_load_dwordx4 v3, s[68:71], s56 offen lds
  s_add_u32 m0, s58, 12288
  s_add_u32 s56, s57, 98304
  buffer_load_dwordx4 v3, s[68:71], s56 offen lds
  s_add_u32 m0, s58, 13312
  s_add_u32 s56, s57, 106496
  buffer_load_dwordx4 v3, s[68:71], s56 offen lds
  s_add_u32 m0, s58, 14336
  s_add_u32 s56, s57, 114688
  buffer_load_dwordx4 v3, s[68:71], s56 offen lds
  s_add_u32 m0, s58, 15360
  s_add_u32 s56, s57, 122880
  buffer_load_dwordx4 v3, s[68:71], s56 offen lds
  s_and_b32 s56, s4, 1
  s_lshl_b32 s56, s56, 15
  s_add_u32 s56, s56, 73728
  v_lshrrev_b32 v6, 5, v1
  v_bfe_u32 v7, v1, 2, 2
  v_lshl_add_u32 v8, v6, 2, v7
  v_lshlrev_b32 v8, 7, v8
  v_bfe_u32 v9, v1, 4, 1
  v_lshlrev_b32 v9, 1, v9
  v_bfe_u32 v10, v1, 1, 1
  v_add_u32 v9, v9, v10
  v_lshrrev_b32 v10, 1, v7
  v_lshlrev_b32 v10, 2, v10
  v_xor_b32 v9, v9, v10
  v_lshl_add_u32 v8, v9, 4, v8
  v_and_b32 v10, 1, v1
  v_lshl_add_u32 v8, v10, 3, v8
  v_add_u32 v4, s56, v8
  v_xor_b32 v8, 64, v4
  v_and_b32 v10, 31, v1
  v_lshlrev_b32 v10, 10, v10
  v_lshrrev_b32 v11, 5, v1
  v_lshl_add_u32 v5, v11, 3, v10
  s_mov_b32 s40, s8
  s_mov_b32 s41, s9
  s_mov_b32 s42, 0x200000
  s_mov_b32 s43, 0x00020000
  s_mov_b32 s44, s24
  s_mov_b32 s45, s25
  s_mov_b32 s46, 0x200000
  s_mov_b32 s47, 0x00020000
  s_lshl_b32 s56, s6, 16
  s_lshr_b32 s57, s4, 1
  s_lshl_b32 s57, s57, 15
  s_add_u32 s56, s56, s57
  s_lshl_b32 s57, s7, 7
  s_add_u32 s56, s56, s57
  s_and_b32 s57, s4, 1
  s_lshl_b32 s57, s57, 6
  s_add_u32 s52, s56, s57
  buffer_load_dwordx2 v[192:193], v5, s[40:43], s52 offen offset:0
  buffer_load_dwordx2 v[194:195], v5, s[40:43], s52 offen offset:16
  buffer_load_dwordx2 v[196:197], v5, s[40:43], s52 offen offset:32
  buffer_load_dwordx2 v[198:199], v5, s[40:43], s52 offen offset:48
  s_waitcnt vmcnt(0)
  v_mov_b32 v6, 155648
  v_mov_b32 v7, 1
  s_mov_b64 exec, 1
  ds_add_u32 v6, v7
  s_mov_b64 exec, -1
p3_spin:
  ds_read_b32 v7, v6
  s_waitcnt lgkmcnt(0)
  v_readfirstlane_b32 s56, v7
  s_cmp_ge_u32 s56, 4
  s_cbranch_scc1 p3_spun
  s_sleep 1
  s_branch p3_spin
p3_spun:
  s_lshr_b32 s56, s6, 1
  s_lshl_b32 s56, s56, 13
  s_add_u32 s56, s56, 24903680
  v_lshlrev_b32 v6, 7, v1
p3_pollo:
  buffer_load_dword v7, v6, s[32:35], s56 offen sc1
  s_waitcnt vmcnt(0)
  v_cmp_ne_u32 vcc, s72, v7
  s_nop 1
  s_cbranch_vccz p3_pollo_ok
  s_sleep 3
  s_branch p3_pollo
p3_pollo_ok:
  buffer_load_dwordx4 v[64:67], v2, s[32:35], s55 offen offset:0 sc1
  buffer_load_dwordx4 v[68:71], v2, s[32:35], s55 offen offset:1024 sc1
  buffer_load_dwordx4 v[72:75], v2, s[32:35], s55 offen offset:2048 sc1
  buffer_load_dwordx4 v[76:79], v2, s[32:35], s55 offen offset:3072 sc1
  s_add_u32 s55, s55, 4096
  buffer_load_dwordx4 v[80:83], v2, s[32:35], s55 offen offset:0 sc1
  buffer_load_dwordx4 v[84:87], v2, s[32:35], s55 offen offset:1024 sc1
  buffer_load_dwordx4 v[88:91], v2, s[32:35], s55 offen offset:2048 sc1
  buffer_load_dwordx4 v[92:95], v2, s[32:35], s55 offen offset:3072 sc1
  s_add_u32 s55, s55, 4096
  buffer_load_dwordx4 v[96:99], v2, s[32:35], s55 offen offset:0 sc1
  buffer_load_dwordx4 v[100:103], v2, s[32:35], s55 offen offset:1024 sc1
  buffer_load_dwordx4 v[104:107], v2, s[32:35], s55 offen offset:2048 sc1
  buffer_load_dwordx4 v[108:111], v2, s[32:35], s55 offen offset:3072 sc1
  s_add_u32 s55, s55, 4096
  buffer_load_dwordx4 v[112:115], v2, s[32:35], s55 offen offset:0 sc1
  buffer_load_dwordx4 v[116:119], v2, s[32:35], s55 offen offset:1024 sc1
  buffer_load_dwordx4 v[120:123], v2, s[32:35], s55 offen offset:2048 sc1
  buffer_load_dwordx4 v[124:127], v2, s[32:35], s55 offen offset:3072 sc1
  s_add_u32 s55, s55, 4096
  ds_read_b64_tr_b16 v[16:17], v4 offset:0
  ds_read_b64_tr_b16 v[18:19], v4 offset:1024
  ds_read_b64_tr_b16 v[20:21], v8 offset:0
  ds_read_b64_tr_b16 v[22:23], v8 offset:1024
  ds_read_b64_tr_b16 v[24:25], v4 offset:2048
  ds_read_b64_tr_b16 v[26:27], v4 offset:3072
  ds_read_b64_tr_b16 v[28:29], v8 offset:2048
  ds_read_b64_tr_b16 v[30:31], v8 offset:3072
  s_waitcnt vmcnt(15)
  s_waitcnt lgkmcnt(6)
  v_mfma_f32_32x32x16_bf16 v[48:63], v[16:19], v[64:67], 0
  s_waitcnt lgkmcnt(4)
  v_mfma_f32_32x32x16_bf16 v[200:215], v[20:23], v[64:67], 0
  ds_read_b64_tr_b16 v[16:17], v4 offset:4096
  ds_read_b64_tr_b16 v[18:19], v4 offset:5120
  ds_read_b64_tr_b16 v[20:21], v8 offset:4096
  ds_read_b64_tr_b16 v[22:23], v8 offset:5120
  s_waitcnt vmcnt(14)
  s_waitcnt lgkmcnt(6)
  v_mfma_f32_32x32x16_bf16 v[48:63], v[24:27], v[68:71], v[48:63]
  s_waitcnt lgkmcnt(4)
  v_mfma_f32_32x32x16_bf16 v[200:215], v[28:31], v[68:71], v[200:215]
  ds_read_b64_tr_b16 v[24:25], v4 offset:6144
  ds_read_b64_tr_b16 v[26:27], v4 offset:7168
  ds_read_b64_tr_b16 v[28:29], v8 offset:6144
  ds_read_b64_tr_b16 v[30:31], v8 offset:7168
  s_waitcnt vmcnt(13)
  s_waitcnt lgkmcnt(6)
  v_mfma_f32_32x32x16_bf16 v[48:63], v[16:19], v[72:75], v[48:63]
  s_waitcnt lgkmcnt(4)
  v_mfma_f32_32x32x16_bf16 v[200:215], v[20:23], v[72:75], v[200:215]
  ds_read_b64_tr_b16 v[16:17], v4 offset:8192
  ds_read_b64_tr_b16 v[18:19], v4 offset:9216
  ds_read_b64_tr_b16 v[20:21], v8 offset:8192
  ds_read_b64_tr_b16 v[22:23], v8 offset:9216
  s_waitcnt vmcnt(12)
  s_waitcnt lgkmcnt(6)
  v_mfma_f32_32x32x16_bf16 v[48:63], v[24:27], v[76:79], v[48:63]
  s_waitcnt lgkmcnt(4)
  v_mfma_f32_32x32x16_bf16 v[200:215], v[28:31], v[76:79], v[200:215]
  ds_read_b64_tr_b16 v[24:25], v4 offset:10240
  ds_read_b64_tr_b16 v[26:27], v4 offset:11264
  ds_read_b64_tr_b16 v[28:29], v8 offset:10240
  ds_read_b64_tr_b16 v[30:31], v8 offset:11264
  s_waitcnt vmcnt(11)
  s_waitcnt lgkmcnt(6)
  v_mfma_f32_32x32x16_bf16 v[48:63], v[16:19], v[80:83], v[48:63]
  s_waitcnt lgkmcnt(4)
  v_mfma_f32_32x32x16_bf16 v[200:215], v[20:23], v[80:83], v[200:215]
  ds_read_b64_tr_b16 v[16:17], v4 offset:12288
  ds_read_b64_tr_b16 v[18:19], v4 offset:13312
  ds_read_b64_tr_b16 v[20:21], v8 offset:12288
  ds_read_b64_tr_b16 v[22:23], v8 offset:13312
  s_waitcnt vmcnt(10)
  s_waitcnt lgkmcnt(6)
  v_mfma_f32_32x32x16_bf16 v[48:63], v[24:27], v[84:87], v[48:63]
  s_waitcnt lgkmcnt(4)
  v_mfma_f32_32x32x16_bf16 v[200:215], v[28:31], v[84:87], v[200:215]
  ds_read_b64_tr_b16 v[24:25], v4 offset:14336
  ds_read_b64_tr_b16 v[26:27], v4 offset:15360
  ds_read_b64_tr_b16 v[28:29], v8 offset:14336
  ds_read_b64_tr_b16 v[30:31], v8 offset:15360
  s_waitcnt vmcnt(9)
  s_waitcnt lgkmcnt(6)
  v_mfma_f32_32x32x16_bf16 v[48:63], v[16:19], v[88:91], v[48:63]
  s_waitcnt lgkmcnt(4)
  v_mfma_f32_32x32x16_bf16 v[200:215], v[20:23], v[88:91], v[200:215]
  ds_read_b64_tr_b16 v[16:17], v4 offset:16384
  ds_read_b64_tr_b16 v[18:19], v4 offset:17408
  ds_read_b64_tr_b16 v[20:21], v8 offset:16384
  ds_read_b64_tr_b16 v[22:23], v8 offset:17408
  s_waitcnt vmcnt(8)
  s_waitcnt lgkmcnt(6)
  v_mfma_f32_32x32x16_bf16 v[48:63], v[24:27], v[92:95], v[48:63]
  s_waitcnt lgkmcnt(4)
  v_mfma_f32_32x32x16_bf16 v[200:215], v[28:31], v[92:95], v[200:215]
  ds_read_b64_tr_b16 v[24:25], v4 offset:18432
  ds_read_b64_tr_b16 v[26:27], v4 offset:19456
  ds_read_b64_tr_b16 v[28:29], v8 offset:18432
  ds_read_b64_tr_b16 v[30:31], v8 offset:19456
  s_waitcnt vmcnt(7)
  s_waitcnt lgkmcnt(6)
  v_mfma_f32_32x32x16_bf16 v[48:63], v[16:19], v[96:99], v[48:63]
  s_waitcnt lgkmcnt(4)
  v_mfma_f32_32x32x16_bf16 v[200:215], v[20:23], v[96:99], v[200:215]
  ds_read_b64_tr_b16 v[16:17], v4 offset:20480
  ds_read_b64_tr_b16 v[18:19], v4 offset:21504
  ds_read_b64_tr_b16 v[20:21], v8 offset:20480
  ds_read_b64_tr_b16 v[22:23], v8 offset:21504
  s_waitcnt vmcnt(6)
  s_waitcnt lgkmcnt(6)
  v_mfma_f32_32x32x16_bf16 v[48:63], v[24:27], v[100:103], v[48:63]
  s_waitcnt lgkmcnt(4)
  v_mfma_f32_32x32x16_bf16 v[200:215], v[28:31], v[100:103], v[200:215]
  ds_read_b64_tr_b16 v[24:25], v4 offset:22528
  ds_read_b64_tr_b16 v[26:27], v4 offset:23552
  ds_read_b64_tr_b16 v[28:29], v8 offset:22528
  ds_read_b64_tr_b16 v[30:31], v8 offset:23552
  s_waitcnt vmcnt(5)
  s_waitcnt lgkmcnt(6)
  v_mfma_f32_32x32x16_bf16 v[48:63], v[16:19], v[104:107], v[48:63]
  s_waitcnt lgkmcnt(4)
  v_mfma_f32_32x32x16_bf16 v[200:215], v[20:23], v[104:107], v[200:215]
  ds_read_b64_tr_b16 v[16:17], v4 offset:24576
  ds_read_b64_tr_b16 v[18:19], v4 offset:25600
  ds_read_b64_tr_b16 v[20:21], v8 offset:24576
  ds_read_b64_tr_b16 v[22:23], v8 offset:25600
  s_waitcnt vmcnt(4)
  s_waitcnt lgkmcnt(6)
  v_mfma_f32_32x32x16_bf16 v[48:63], v[24:27], v[108:111], v[48:63]
  s_waitcnt lgkmcnt(4)
  v_mfma_f32_32x32x16_bf16 v[200:215], v[28:31], v[108:111], v[200:215]
  ds_read_b64_tr_b16 v[24:25], v4 offset:26624
  ds_read_b64_tr_b16 v[26:27], v4 offset:27648
  ds_read_b64_tr_b16 v[28:29], v8 offset:26624
  ds_read_b64_tr_b16 v[30:31], v8 offset:27648
  s_waitcnt vmcnt(3)
  s_waitcnt lgkmcnt(6)
  v_mfma_f32_32x32x16_bf16 v[48:63], v[16:19], v[112:115], v[48:63]
  s_waitcnt lgkmcnt(4)
  v_mfma_f32_32x32x16_bf16 v[200:215], v[20:23], v[112:115], v[200:215]
  ds_read_b64_tr_b16 v[16:17], v4 offset:28672
  ds_read_b64_tr_b16 v[18:19], v4 offset:29696
  ds_read_b64_tr_b16 v[20:21], v8 offset:28672
  ds_read_b64_tr_b16 v[22:23], v8 offset:29696
  s_waitcnt vmcnt(2)
  s_waitcnt lgkmcnt(6)
  v_mfma_f32_32x32x16_bf16 v[48:63], v[24:27], v[116:119], v[48:63]
  s_waitcnt lgkmcnt(4)
  v_mfma_f32_32x32x16_bf16 v[200:215], v[28:31], v[116:119], v[200:215]
  ds_read_b64_tr_b16 v[24:25], v4 offset:30720
  ds_read_b64_tr_b16 v[26:27], v4 offset:31744
  ds_read_b64_tr_b16 v[28:29], v8 offset:30720
  ds_read_b64_tr_b16 v[30:31], v8 offset:31744
  s_waitcnt vmcnt(1)
  s_waitcnt lgkmcnt(6)
  v_mfma_f32_32x32x16_bf16 v[48:63], v[16:19], v[120:123], v[48:63]
  s_waitcnt lgkmcnt(4)
  v_mfma_f32_32x32x16_bf16 v[200:215], v[20:23], v[120:123], v[200:215]
  s_waitcnt vmcnt(0)
  s_waitcnt lgkmcnt(2)
  v_mfma_f32_32x32x16_bf16 v[48:63], v[24:27], v[124:127], v[48:63]
  s_waitcnt lgkmcnt(0)
  v_mfma_f32_32x32x16_bf16 v[200:215], v[28:31], v[124:127], v[200:215]
  s_nop 7
  s_nop 7
  s_lshl_b32 s56, s4, 12
  s_add_u32 s56, s56, 139264
  v_add_u32 v6, s56, v2
  s_bitcmp1_b32 s4, 0
  s_cbranch_scc1 p3_x1
  ds_write_b128 v6, v[200:203] offset:0
  ds_write_b128 v6, v[204:207] offset:1024
  ds_write_b128 v6, v[208:211] offset:2048
  ds_write_b128 v6, v[212:215] offset:3072
  s_branch p3_x2
p3_x1:
  ds_write_b128 v6, v[48:51] offset:0
  ds_write_b128 v6, v[52:55] offset:1024
  ds_write_b128 v6, v[56:59] offset:2048
  ds_write_b128 v6, v[60:63] offset:3072
  v_mov_b32 v48, v200
  v_mov_b32 v49, v201
  v_mov_b32 v50, v202
  v_mov_b32 v51, v203
  v_mov_b32 v52, v204
  v_mov_b32 v53, v205
  v_mov_b32 v54, v206
  v_mov_b32 v55, v207
  v_mov_b32 v56, v208
  v_mov_b32 v57, v209
  v_mov_b32 v58, v210
  v_mov_b32 v59, v211
  v_mov_b32 v60, v212
  v_mov_b32 v61, v213
  v_mov_b32 v62, v214
  v_mov_b32 v63, v215
p3_x2:
  s_waitcnt lgkmcnt(0)
  s_barrier
  s_lshl_b32 s56, s4, 12
  v_add_u32 v6, s56, v2
  s_xor_b32 s56, s4, 1
  s_lshl_b32 s56, s56, 12
  s_add_u32 s56, s56, 139264
  v_add_u32 v7, s56, v2
  ds_read_b128 v[64:67], v6 offset:0
  ds_read_b128 v[68:71], v6 offset:1024
  ds_read_b128 v[72:75], v6 offset:2048
  ds_read_b128 v[76:79], v6 offset:3072
  ds_read_b128 v[80:83], v6 offset:18432
  ds_read_b128 v[84:87], v6 offset:19456
  ds_read_b128 v[88:91], v6 offset:20480
  ds_read_b128 v[92:95], v6 offset:21504
  ds_read_b128 v[96:99], v6 offset:36864
  ds_read_b128 v[100:103], v6 offset:37888
  ds_read_b128 v[104:107], v6 offset:38912
  ds_read_b128 v[108:111], v6 offset:39936
  ds_read_b128 v[112:115], v6 offset:55296
  ds_read_b128 v[116:119], v6 offset:56320
  ds_read_b128 v[120:123], v6 offset:57344
  ds_read_b128 v[124:127], v6 offset:58368
  ds_read_b128 v[128:131], v7 offset:0
  ds_read_b128 v[132:135], v7 offset:1024
  ds_read_b128 v[136:139], v7 offset:2048
  ds_read_b128 v[140:143], v7 offset:3072
  s_waitcnt lgkmcnt(12)
  v_add_f32 v64, v64, v80
  v_add_f32 v65, v65, v81
  v_add_f32 v66, v66, v82
  v_add_f32 v67, v67, v83
  v_add_f32 v68, v68, v84
  v_add_f32 v69, v69, v85
  v_add_f32 v70, v70, v86
  v_add_f32 v71, v71, v87
  v_add_f32 v72, v72, v88
  v_add_f32 v73, v73, v89
  v_add_f32 v74, v74, v90
  v_add_f32 v75, v75, v91
  v_add_f32 v76, v76, v92
  v_add_f32 v77, v77, v93
  v_add_f32 v78, v78, v94
  v_add_f32 v79, v79, v95
  s_waitcnt lgkmcnt(4)
  v_add_f32 v96, v96, v112
  v_add_f32 v97, v97, v113
  v_add_f32 v98, v98, v114
  v_add_f32 v99, v99, v115
  v_add_f32 v100, v100, v116
  v_add_f32 v101, v101, v117
  v_add_f32 v102, v102, v118
  v_add_f32 v103, v103, v119
  v_add_f32 v104, v104, v120
  v_add_f32 v105, v105, v121
  v_add_f32 v106, v106, v122
  v_add_f32 v107, v107, v123
  v_add_f32 v108, v108, v124
  v_add_f32 v109, v109, v125
  v_add_f32 v110, v110, v126
  v_add_f32 v111, v111, v127
  v_add_f32 v64, v64, v96
  v_add_f32 v65, v65, v97
  v_add_f32 v66, v66, v98
  v_add_f32 v67, v67, v99
  v_add_f32 v68, v68, v100
  v_add_f32 v69, v69, v101
  v_add_f32 v70, v70, v102
  v_add_f32 v71, v71, v103
  v_add_f32 v72, v72, v104
  v_add_f32 v73, v73, v105
  v_add_f32 v74, v74, v106
  v_add_f32 v75, v75, v107
  v_add_f32 v76, v76, v108
  v_add_f32 v77, v77, v109
  v_add_f32 v78, v78, v110
  v_add_f32 v79, v79, v111
  v_mul_f32 v80, 0xbfb8aa3b, v64
  v_mul_f32 v81, 0xbfb8aa3b, v65
  v_mul_f32 v82, 0xbfb8aa3b, v66
  v_mul_f32 v83, 0xbfb8aa3b, v67
  v_mul_f32 v84, 0xbfb8aa3b, v68
  v_mul_f32 v85, 0xbfb8aa3b, v69
  v_mul_f32 v86, 0xbfb8aa3b, v70
  v_mul_f32 v87, 0xbfb8aa3b, v71
  v_mul_f32 v88, 0xbfb8aa3b, v72
  v_mul_f32 v89, 0xbfb8aa3b, v73
  v_mul_f32 v90, 0xbfb8aa3b, v74
  v_mul_f32 v91, 0xbfb8aa3b, v75
  v_mul_f32 v92, 0xbfb8aa3b, v76
  v_mul_f32 v93, 0xbfb8aa3b, v77
  v_mul_f32 v94, 0xbfb8aa3b, v78
  v_mul_f32 v95, 0xbfb8aa3b, v79
  v_exp_f32 v80, v80
  v_exp_f32 v81, v81
  v_exp_f32 v82, v82
  v_exp_f32 v83, v83
  v_exp_f32 v84, v84
  v_exp_f32 v85, v85
  v_exp_f32 v86, v86
  v_exp_f32 v87, v87
  v_exp_f32 v88, v88
  v_exp_f32 v89, v89
  v_exp_f32 v90, v90
  v_exp_f32 v91, v91
  v_exp_f32 v92, v92
  v_exp_f32 v93, v93
  v_exp_f32 v94, v94
  v_exp_f32 v95, v95
  s_waitcnt lgkmcnt(0)
  v_add_f32 v48, v48, v128
  v_add_f32 v49, v49, v129
  v_add_f32 v50, v50, v130
  v_add_f32 v51, v51, v131
  v_add_f32 v52, v52, v132
  v_add_f32 v53, v53, v133
  v_add_f32 v54, v54, v134
  v_add_f32 v55, v55, v135
  v_add_f32 v56, v56, v136
  v_add_f32 v57, v57, v137
  v_add_f32 v58, v58, v138
  v_add_f32 v59, v59, v139
  v_add_f32 v60, v60, v140
  v_add_f32 v61, v61, v141
  v_add_f32 v62, v62, v142
  v_add_f32 v63, v63, v143
  v_mul_f32 v64, v64, v48
  v_mul_f32 v65, v65, v49
  v_mul_f32 v66, v66, v50
  v_mul_f32 v67, v67, v51
  v_mul_f32 v68, v68, v52
  v_mul_f32 v69, v69, v53
  v_mul_f32 v70, v70, v54
  v_mul_f32 v71, v71, v55
  v_mul_f32 v72, v72, v56
  v_mul_f32 v73, v73, v57
  v_mul_f32 v74, v74, v58
  v_mul_f32 v75, v75, v59
  v_mul_f32 v76, v76, v60
  v_mul_f32 v77, v77, v61
  v_mul_f32 v78, v78, v62
  v_mul_f32 v79, v79, v63
  v_add_f32 v80, 1.0, v80
  v_add_f32 v81, 1.0, v81
  v_add_f32 v82, 1.0, v82
  v_add_f32 v83, 1.0, v83
  v_add_f32 v84, 1.0, v84
  v_add_f32 v85, 1.0, v85
  v_add_f32 v86, 1.0, v86
  v_add_f32 v87, 1.0, v87
  v_add_f32 v88, 1.0, v88
  v_add_f32 v89, 1.0, v89
  v_add_f32 v90, 1.0, v90
  v_add_f32 v91, 1.0, v91
  v_add_f32 v92, 1.0, v92
  v_add_f32 v93, 1.0, v93
  v_add_f32 v94, 1.0, v94
  v_add_f32 v95, 1.0, v95
  v_rcp_f32 v80, v80
  v_rcp_f32 v81, v81
  v_rcp_f32 v82, v82
  v_rcp_f32 v83, v83
  v_rcp_f32 v84, v84
  v_rcp_f32 v85, v85
  v_rcp_f32 v86, v86
  v_rcp_f32 v87, v87
  v_rcp_f32 v88, v88
  v_rcp_f32 v89, v89
  v_rcp_f32 v90, v90
  v_rcp_f32 v91, v91
  v_rcp_f32 v92, v92
  v_rcp_f32 v93, v93
  v_rcp_f32 v94, v94
  v_rcp_f32 v95, v95
  v_lshlrev_b32 v96, 16, v192
  v_and_b32 v97, 0xffff0000, v192
  v_lshlrev_b32 v98, 16, v193
  v_and_b32 v99, 0xffff0000, v193
  v_lshlrev_b32 v100, 16, v194
  v_and_b32 v101, 0xffff0000, v194
  v_lshlrev_b32 v102, 16, v195
  v_and_b32 v103, 0xffff0000, v195
  v_lshlrev_b32 v104, 16, v196
  v_and_b32 v105, 0xffff0000, v196
  v_lshlrev_b32 v106, 16, v197
  v_and_b32 v107, 0xffff0000, v197
  v_lshlrev_b32 v108, 16, v198
  v_and_b32 v109, 0xffff0000, v198
  v_lshlrev_b32 v110, 16, v199
  v_and_b32 v111, 0xffff0000, v199
  v_fma_f32 v64, v64, v80, v96
  v_fma_f32 v65, v65, v81, v97
  v_fma_f32 v66, v66, v82, v98
  v_fma_f32 v67, v67, v83, v99
  v_fma_f32 v68, v68, v84, v100
  v_fma_f32 v69, v69, v85, v101
  v_fma_f32 v70, v70, v86, v102
  v_fma_f32 v71, v71, v87, v103
  v_fma_f32 v72, v72, v88, v104
  v_fma_f32 v73, v73, v89, v105
  v_fma_f32 v74, v74, v90, v106
  v_fma_f32 v75, v75, v91, v107
  v_fma_f32 v76, v76, v92, v108
  v_fma_f32 v77, v77, v93, v109
  v_fma_f32 v78, v78, v94, v110
  v_fma_f32 v79, v79, v95, v111
  v_cvt_pk_bf16_f32 v80, v64, v65
  v_cvt_pk_bf16_f32 v81, v66, v67
  v_cvt_pk_bf16_f32 v82, v68, v69
  v_cvt_pk_bf16_f32 v83, v70, v71
  v_cvt_pk_bf16_f32 v84, v72, v73
  v_cvt_pk_bf16_f32 v85, v74, v75
  v_cvt_pk_bf16_f32 v86, v76, v77
  v_cvt_pk_bf16_f32 v87, v78, v79
  buffer_store_dwordx2 v[80:81], v5, s[44:47], s52 offen offset:0
  buffer_store_dwordx2 v[82:83], v5, s[44:47], s52 offen offset:16
  buffer_store_dwordx2 v[84:85], v5, s[44:47], s52 offen offset:32
  buffer_store_dwordx2 v[86:87], v5, s[44:47], s52 offen offset:48
p3_end:
  s_endpgm

.section .rodata,"a"

.p2align 6
.amdhsa_kernel recurrent_scan__linear_kernel_hedgehog__geglu_ffn__prompt_kernel
  .amdhsa_next_free_vgpr 256
  .amdhsa_next_free_sgpr 102
  .amdhsa_accum_offset 256
  .amdhsa_group_segment_fixed_size 0
  .amdhsa_kernarg_size 88
  .amdhsa_user_sgpr_count 2
  .amdhsa_user_sgpr_kernarg_segment_ptr 1
  .amdhsa_system_sgpr_workgroup_id_x 1
.end_amdhsa_kernel
```
